```python
import torch

def _softmax(x, axis=-1):
    return torch.softmax(x, dim=axis)
def _gelu(x):
    return torch.nn.functional.gelu(x, approximate="tanh")
def _silu(x):
    return torch.nn.functional.silu(x)
def _sigmoid(x):
    return torch.sigmoid(x)
def _layernorm(x, axis=-1, eps=1e-5):
    m = x.mean(dim=axis, keepdim=True)
    v = x.var(dim=axis, keepdim=True, unbiased=False)
    return (x - m) / torch.sqrt(v + eps)
def _scatter_add(tgt, idx, src, axis=0):
    return tgt.clone().index_add_(axis, idx, src)
def _segment_sum(src, seg, n):
    out = torch.zeros((n,) + src.shape[1:], dtype=src.dtype)
    return out.index_add_(0, seg, src)
def _pad(x, pw):
    flat = tuple(v for pair in reversed(pw) for v in pair)
    return torch.nn.functional.pad(x, flat)

kernel_name = 'sequential_preLN__linear_kernel_hedgehog__geglu_ffn__prompt'

def setup_inputs():

    _w = (lambda a: (lambda t: t.to(torch.bfloat16) if t.is_floating_point() else t)(torch.as_tensor(a)))
    def _A_setup():
        B, S, D, H = 1, 2048, 576, 32
        Dh = D // H
        return {
            "x": _w((lambda *s: torch.randn(*s, dtype=torch.bfloat16) * 0.05)(B, S, D)),
            "wqkv": _w((lambda *s: torch.randn(*s, dtype=torch.bfloat16) * 0.2)(D, 3 * D)),
            "w_phi": _w((lambda *s: torch.randn(*s, dtype=torch.bfloat16) * 0.2)(H, Dh, Dh) * (Dh ** -0.5)),
            "wo": _w((lambda *s: torch.randn(*s, dtype=torch.bfloat16) * 0.05)(D, D)),
        }
    _A_in = _A_setup()

    def _B_setup():
        B, S, D, F = 1, 2048, 576, 4608
        return {
            "x": _w((lambda *s: torch.randn(*s, dtype=torch.bfloat16) * 0.05)(B, S, D)),
            "w_gate": _w((lambda *s: torch.randn(*s, dtype=torch.bfloat16) * 0.05)(D, F)),
            "w_up": _w((lambda *s: torch.randn(*s, dtype=torch.bfloat16) * 0.05)(D, F)),
            "w_down": _w((lambda *s: torch.randn(*s, dtype=torch.bfloat16) * 0.05)(F, D)),
        }
    _B_in = _B_setup()

    return {
        "A_x": _A_in["x"],
        "A_wqkv": _A_in["wqkv"],
        "A_w_phi": _A_in["w_phi"],
        "A_wo": _A_in["wo"],
        "B_x": _B_in["x"],
        "B_w_gate": _B_in["w_gate"],
        "B_w_up": _B_in["w_up"],
        "B_w_down": _B_in["w_down"],
    }

def reference(A_x, A_wqkv, A_w_phi, A_wo, B_x, B_w_gate, B_w_up, B_w_down):
    def _A_ref(x, wqkv, w_phi, wo):
        B, S, D = x.shape
        H = 32; Dh = D // H
        qkv = (lambda x, *d: x.permute(*d))((x @ wqkv).reshape(B, S, 3, H, Dh), 2, 0, 3, 1, 4)
        q, k, v = qkv[0], qkv[1], qkv[2]
        pq = torch.einsum("bhsd,hdf->bhsf", q, w_phi)
        pk = torch.einsum("bhsd,hdf->bhsf", k, w_phi)
        phi_q = torch.concatenate([_softmax(pq, axis=-1), _softmax(-pq, axis=-1)], axis=-1)
        phi_k = torch.concatenate([_softmax(pk, axis=-1), _softmax(-pk, axis=-1)], axis=-1)
        kv = torch.einsum("bhsf,bhsd->bhfd", phi_k, v)
        z  = torch.einsum("bhsf->bhf", phi_k)
        num = torch.einsum("bhqf,bhfd->bhqd", phi_q, kv)
        den = torch.einsum("bhqf,bhf->bhq", phi_q, z)[..., None] + 1e-6
        o = num / den
        return (lambda x, *d: x.permute(*d))(o, 0, 2, 1, 3).reshape(B, S, D) @ wo

    def _B_ref(x, w_gate, w_up, w_down):
        return (_gelu(x @ w_gate) * (x @ w_up)) @ w_down

    x = A_x
    h = x + _A_ref(_layernorm(x, axis=-1), A_wqkv, A_w_phi, A_wo)
    h2 = h + _B_ref(_layernorm(h, axis=-1), B_w_gate, B_w_up, B_w_down)
    return h2
```

```asm
; @launch grid=(256,1,1) block=(512,1,1) lds=147712
.amdgcn_target "amdgcn-amd-amdhsa--gfx950"
.text
.globl sequential_preLN__linear_kernel_hedgehog__geglu_ffn__prompt_kernel
.p2align 8
.type sequential_preLN__linear_kernel_hedgehog__geglu_ffn__prompt_kernel,@function
sequential_preLN__linear_kernel_hedgehog__geglu_ffn__prompt_kernel:
    s_cmp_ge_u32 s2, 256
    s_cbranch_scc1 k_done
    s_load_dwordx8 s[4:11], s[0:1], 0
    s_load_dwordx8 s[12:19], s[0:1], 32
    s_load_dwordx4 s[20:23], s[0:1], 64
    s_load_dwordx2 s[24:25], s[0:1], 80
    v_lshrrev_b32 v4, 6, v0
    v_and_b32 v1, 63, v0
    v_readfirstlane_b32 s26, v4
    v_lshlrev_b32 v2, 4, v1
    v_lshlrev_b32 v3, 2, v1
    s_mov_b32 s28, 2000000
    v_mov_b32 v4, 147472
    v_mov_b32 v5, 0
    v_mov_b32 v6, 0
    ds_write2_b32 v4, v5, v6 offset0:0 offset1:1
    ds_write2_b32 v4, v5, v6 offset0:2 offset1:3
    s_waitcnt lgkmcnt(0)
    s_barrier
    s_add_u32 s30, s24, 0x3500000
    s_addc_u32 s31, s25, 0
    s_cmp_lg_u32 s26, 0
    s_cbranch_scc1 notag
    s_load_dword s27, s[30:31], 0
notag:
    s_movk_i32 s92, 9999
    s_movk_i32 s93, 9999
    s_cmp_eq_u32 s26, 0
    s_cbranch_scc0 p0_n0
    s_mov_b32 s36, s4
    s_mov_b32 s37, s5
    s_mov_b32 s38, 0x240000
    s_mov_b32 s39, 0x20000
    s_add_u32 s40, s24, 0x2600000
    s_addc_u32 s41, s25, 0
    s_mov_b32 s42, 0x240000
    s_mov_b32 s43, 0x20000
    v_lshrrev_b32 v4, 3, v1
    v_and_b32 v5, 7, v1
    v_mul_u32_u24 v6, 1152, v4
    v_lshl_add_u32 v6, v5, 4, v6
    s_mul_i32 s52, s2, 9216
    buffer_load_dwordx4 v[16:19], v6, s[36:39], s52 offen offset:0
    buffer_load_dwordx4 v[20:23], v6, s[36:39], s52 offen offset:128
    buffer_load_dwordx4 v[24:27], v6, s[36:39], s52 offen offset:256
    buffer_load_dwordx4 v[28:31], v6, s[36:39], s52 offen offset:384
    buffer_load_dwordx4 v[32:35], v6, s[36:39], s52 offen offset:512
    buffer_load_dwordx4 v[36:39], v6, s[36:39], s52 offen offset:640
    buffer_load_dwordx4 v[40:43], v6, s[36:39], s52 offen offset:768
    buffer_load_dwordx4 v[44:47], v6, s[36:39], s52 offen offset:896
    buffer_load_dwordx4 v[48:51], v6, s[36:39], s52 offen offset:1024
    s_cmp_ge_u32 s2, 90
    s_cbranch_scc1 p0_nokv
    s_add_u32 s44, s24, 0x2d00000
    s_addc_u32 s45, s25, 0
    s_mov_b32 s46, 0x16800
    s_mov_b32 s47, 0x20000
    v_mov_b32 v72, 0
    v_mov_b32 v73, 0
    v_mov_b32 v74, 0
    v_mov_b32 v75, 0
    s_lshl_b32 s53, s2, 10
    buffer_store_dwordx4 v[72:75], v2, s[44:47], s53 offen sc0 sc1
p0_nokv:
    v_lshrrev_b32 v7, 1, v5
    v_lshlrev_b32 v7, 10, v7
    v_and_b32 v8, 1, v5
    v_lshl_add_u32 v7, v8, 9, v7
    s_and_b32 s53, s2, 3
    s_lshl_b32 s53, s53, 3
    v_add_u32 v8, s53, v4
    v_lshl_add_u32 v7, v8, 4, v7
    s_lshr_b32 s53, s2, 2
    s_mul_i32 s53, s53, 36864
    s_waitcnt vmcnt(0)
    v_mov_b32 v56, 0
    v_mov_b32 v57, 0
    v_mov_b32 v58, 0
    v_mov_b32 v59, 0
    v_mov_b32 v60, 0x3f803f80
    v_dot2c_f32_bf16 v56, v16, v60
    v_dot2c_f32_bf16 v58, v16, v16
    v_dot2c_f32_bf16 v57, v17, v60
    v_dot2c_f32_bf16 v59, v17, v17
    v_dot2c_f32_bf16 v56, v18, v60
    v_dot2c_f32_bf16 v58, v18, v18
    v_dot2c_f32_bf16 v57, v19, v60
    v_dot2c_f32_bf16 v59, v19, v19
    v_dot2c_f32_bf16 v56, v20, v60
    v_dot2c_f32_bf16 v58, v20, v20
    v_dot2c_f32_bf16 v57, v21, v60
    v_dot2c_f32_bf16 v59, v21, v21
    v_dot2c_f32_bf16 v56, v22, v60
    v_dot2c_f32_bf16 v58, v22, v22
    v_dot2c_f32_bf16 v57, v23, v60
    v_dot2c_f32_bf16 v59, v23, v23
    v_dot2c_f32_bf16 v56, v24, v60
    v_dot2c_f32_bf16 v58, v24, v24
    v_dot2c_f32_bf16 v57, v25, v60
    v_dot2c_f32_bf16 v59, v25, v25
    v_dot2c_f32_bf16 v56, v26, v60
    v_dot2c_f32_bf16 v58, v26, v26
    v_dot2c_f32_bf16 v57, v27, v60
    v_dot2c_f32_bf16 v59, v27, v27
    v_dot2c_f32_bf16 v56, v28, v60
    v_dot2c_f32_bf16 v58, v28, v28
    v_dot2c_f32_bf16 v57, v29, v60
    v_dot2c_f32_bf16 v59, v29, v29
    v_dot2c_f32_bf16 v56, v30, v60
    v_dot2c_f32_bf16 v58, v30, v30
    v_dot2c_f32_bf16 v57, v31, v60
    v_dot2c_f32_bf16 v59, v31, v31
    v_dot2c_f32_bf16 v56, v32, v60
    v_dot2c_f32_bf16 v58, v32, v32
    v_dot2c_f32_bf16 v57, v33, v60
    v_dot2c_f32_bf16 v59, v33, v33
    v_dot2c_f32_bf16 v56, v34, v60
    v_dot2c_f32_bf16 v58, v34, v34
    v_dot2c_f32_bf16 v57, v35, v60
    v_dot2c_f32_bf16 v59, v35, v35
    v_dot2c_f32_bf16 v56, v36, v60
    v_dot2c_f32_bf16 v58, v36, v36
    v_dot2c_f32_bf16 v57, v37, v60
    v_dot2c_f32_bf16 v59, v37, v37
    v_dot2c_f32_bf16 v56, v38, v60
    v_dot2c_f32_bf16 v58, v38, v38
    v_dot2c_f32_bf16 v57, v39, v60
    v_dot2c_f32_bf16 v59, v39, v39
    v_dot2c_f32_bf16 v56, v40, v60
    v_dot2c_f32_bf16 v58, v40, v40
    v_dot2c_f32_bf16 v57, v41, v60
    v_dot2c_f32_bf16 v59, v41, v41
    v_dot2c_f32_bf16 v56, v42, v60
    v_dot2c_f32_bf16 v58, v42, v42
    v_dot2c_f32_bf16 v57, v43, v60
    v_dot2c_f32_bf16 v59, v43, v43
    v_dot2c_f32_bf16 v56, v44, v60
    v_dot2c_f32_bf16 v58, v44, v44
    v_dot2c_f32_bf16 v57, v45, v60
    v_dot2c_f32_bf16 v59, v45, v45
    v_dot2c_f32_bf16 v56, v46, v60
    v_dot2c_f32_bf16 v58, v46, v46
    v_dot2c_f32_bf16 v57, v47, v60
    v_dot2c_f32_bf16 v59, v47, v47
    v_dot2c_f32_bf16 v56, v48, v60
    v_dot2c_f32_bf16 v58, v48, v48
    v_dot2c_f32_bf16 v57, v49, v60
    v_dot2c_f32_bf16 v59, v49, v49
    v_dot2c_f32_bf16 v56, v50, v60
    v_dot2c_f32_bf16 v58, v50, v50
    v_dot2c_f32_bf16 v57, v51, v60
    v_dot2c_f32_bf16 v59, v51, v51
    s_nop 3
    v_add_f32 v56, v56, v57
    v_add_f32 v58, v58, v59
    s_nop 1
    v_add_f32_dpp v56, v56, v56 quad_perm:[1,0,3,2] row_mask:0xf bank_mask:0xf
    v_add_f32_dpp v58, v58, v58 quad_perm:[1,0,3,2] row_mask:0xf bank_mask:0xf
    s_nop 1
    v_add_f32_dpp v56, v56, v56 quad_perm:[2,3,0,1] row_mask:0xf bank_mask:0xf
    v_add_f32_dpp v58, v58, v58 quad_perm:[2,3,0,1] row_mask:0xf bank_mask:0xf
    s_nop 1
    v_add_f32_dpp v56, v56, v56 row_half_mirror row_mask:0xf bank_mask:0xf
    v_add_f32_dpp v58, v58, v58 row_half_mirror row_mask:0xf bank_mask:0xf
    v_mul_f32 v56, 0x3ae38e39, v56
    v_mul_f32 v58, 0x3ae38e39, v58
    v_fma_f32 v58, -v56, v56, v58
    v_max_f32 v58, 0, v58
    v_add_f32 v58, 0x3727c5ac, v58
    v_rsq_f32 v58, v58
    s_nop 0
    v_mul_f32 v56, v56, v58
    v_sub_f32 v56, 0, v56
    v_lshlrev_b32 v64, 16, v16
    v_and_b32 v65, 0xffff0000, v16
    v_lshlrev_b32 v66, 16, v17
    v_and_b32 v67, 0xffff0000, v17
    v_lshlrev_b32 v68, 16, v18
    v_and_b32 v69, 0xffff0000, v18
    v_lshlrev_b32 v70, 16, v19
    v_and_b32 v71, 0xffff0000, v19
    v_fma_f32 v64, v64, v58, v56
    v_fma_f32 v65, v65, v58, v56
    v_fma_f32 v66, v66, v58, v56
    v_fma_f32 v67, v67, v58, v56
    v_fma_f32 v68, v68, v58, v56
    v_fma_f32 v69, v69, v58, v56
    v_fma_f32 v70, v70, v58, v56
    v_fma_f32 v71, v71, v58, v56
    v_cvt_pk_bf16_f32 v16, v64, v65
    v_cvt_pk_bf16_f32 v17, v66, v67
    v_cvt_pk_bf16_f32 v18, v68, v69
    v_cvt_pk_bf16_f32 v19, v70, v71
    v_lshlrev_b32 v64, 16, v20
    v_and_b32 v65, 0xffff0000, v20
    v_lshlrev_b32 v66, 16, v21
    v_and_b32 v67, 0xffff0000, v21
    v_lshlrev_b32 v68, 16, v22
    v_and_b32 v69, 0xffff0000, v22
    v_lshlrev_b32 v70, 16, v23
    v_and_b32 v71, 0xffff0000, v23
    v_fma_f32 v64, v64, v58, v56
    v_fma_f32 v65, v65, v58, v56
    v_fma_f32 v66, v66, v58, v56
    v_fma_f32 v67, v67, v58, v56
    v_fma_f32 v68, v68, v58, v56
    v_fma_f32 v69, v69, v58, v56
    v_fma_f32 v70, v70, v58, v56
    v_fma_f32 v71, v71, v58, v56
    v_cvt_pk_bf16_f32 v20, v64, v65
    v_cvt_pk_bf16_f32 v21, v66, v67
    v_cvt_pk_bf16_f32 v22, v68, v69
    v_cvt_pk_bf16_f32 v23, v70, v71
    v_lshlrev_b32 v64, 16, v24
    v_and_b32 v65, 0xffff0000, v24
    v_lshlrev_b32 v66, 16, v25
    v_and_b32 v67, 0xffff0000, v25
    v_lshlrev_b32 v68, 16, v26
    v_and_b32 v69, 0xffff0000, v26
    v_lshlrev_b32 v70, 16, v27
    v_and_b32 v71, 0xffff0000, v27
    v_fma_f32 v64, v64, v58, v56
    v_fma_f32 v65, v65, v58, v56
    v_fma_f32 v66, v66, v58, v56
    v_fma_f32 v67, v67, v58, v56
    v_fma_f32 v68, v68, v58, v56
    v_fma_f32 v69, v69, v58, v56
    v_fma_f32 v70, v70, v58, v56
    v_fma_f32 v71, v71, v58, v56
    v_cvt_pk_bf16_f32 v24, v64, v65
    v_cvt_pk_bf16_f32 v25, v66, v67
    v_cvt_pk_bf16_f32 v26, v68, v69
    v_cvt_pk_bf16_f32 v27, v70, v71
    v_lshlrev_b32 v64, 16, v28
    v_and_b32 v65, 0xffff0000, v28
    v_lshlrev_b32 v66, 16, v29
    v_and_b32 v67, 0xffff0000, v29
    v_lshlrev_b32 v68, 16, v30
    v_and_b32 v69, 0xffff0000, v30
    v_lshlrev_b32 v70, 16, v31
    v_and_b32 v71, 0xffff0000, v31
    v_fma_f32 v64, v64, v58, v56
    v_fma_f32 v65, v65, v58, v56
    v_fma_f32 v66, v66, v58, v56
    v_fma_f32 v67, v67, v58, v56
    v_fma_f32 v68, v68, v58, v56
    v_fma_f32 v69, v69, v58, v56
    v_fma_f32 v70, v70, v58, v56
    v_fma_f32 v71, v71, v58, v56
    v_cvt_pk_bf16_f32 v28, v64, v65
    v_cvt_pk_bf16_f32 v29, v66, v67
    v_cvt_pk_bf16_f32 v30, v68, v69
    v_cvt_pk_bf16_f32 v31, v70, v71
    v_lshlrev_b32 v64, 16, v32
    v_and_b32 v65, 0xffff0000, v32
    v_lshlrev_b32 v66, 16, v33
    v_and_b32 v67, 0xffff0000, v33
    v_lshlrev_b32 v68, 16, v34
    v_and_b32 v69, 0xffff0000, v34
    v_lshlrev_b32 v70, 16, v35
    v_and_b32 v71, 0xffff0000, v35
    v_fma_f32 v64, v64, v58, v56
    v_fma_f32 v65, v65, v58, v56
    v_fma_f32 v66, v66, v58, v56
    v_fma_f32 v67, v67, v58, v56
    v_fma_f32 v68, v68, v58, v56
    v_fma_f32 v69, v69, v58, v56
    v_fma_f32 v70, v70, v58, v56
    v_fma_f32 v71, v71, v58, v56
    v_cvt_pk_bf16_f32 v32, v64, v65
    v_cvt_pk_bf16_f32 v33, v66, v67
    v_cvt_pk_bf16_f32 v34, v68, v69
    v_cvt_pk_bf16_f32 v35, v70, v71
    v_lshlrev_b32 v64, 16, v36
    v_and_b32 v65, 0xffff0000, v36
    v_lshlrev_b32 v66, 16, v37
    v_and_b32 v67, 0xffff0000, v37
    v_lshlrev_b32 v68, 16, v38
    v_and_b32 v69, 0xffff0000, v38
    v_lshlrev_b32 v70, 16, v39
    v_and_b32 v71, 0xffff0000, v39
    v_fma_f32 v64, v64, v58, v56
    v_fma_f32 v65, v65, v58, v56
    v_fma_f32 v66, v66, v58, v56
    v_fma_f32 v67, v67, v58, v56
    v_fma_f32 v68, v68, v58, v56
    v_fma_f32 v69, v69, v58, v56
    v_fma_f32 v70, v70, v58, v56
    v_fma_f32 v71, v71, v58, v56
    v_cvt_pk_bf16_f32 v36, v64, v65
    v_cvt_pk_bf16_f32 v37, v66, v67
    v_cvt_pk_bf16_f32 v38, v68, v69
    v_cvt_pk_bf16_f32 v39, v70, v71
    v_lshlrev_b32 v64, 16, v40
    v_and_b32 v65, 0xffff0000, v40
    v_lshlrev_b32 v66, 16, v41
    v_and_b32 v67, 0xffff0000, v41
    v_lshlrev_b32 v68, 16, v42
    v_and_b32 v69, 0xffff0000, v42
    v_lshlrev_b32 v70, 16, v43
    v_and_b32 v71, 0xffff0000, v43
    v_fma_f32 v64, v64, v58, v56
    v_fma_f32 v65, v65, v58, v56
    v_fma_f32 v66, v66, v58, v56
    v_fma_f32 v67, v67, v58, v56
    v_fma_f32 v68, v68, v58, v56
    v_fma_f32 v69, v69, v58, v56
    v_fma_f32 v70, v70, v58, v56
    v_fma_f32 v71, v71, v58, v56
    v_cvt_pk_bf16_f32 v40, v64, v65
    v_cvt_pk_bf16_f32 v41, v66, v67
    v_cvt_pk_bf16_f32 v42, v68, v69
    v_cvt_pk_bf16_f32 v43, v70, v71
    v_lshlrev_b32 v64, 16, v44
    v_and_b32 v65, 0xffff0000, v44
    v_lshlrev_b32 v66, 16, v45
    v_and_b32 v67, 0xffff0000, v45
    v_lshlrev_b32 v68, 16, v46
    v_and_b32 v69, 0xffff0000, v46
    v_lshlrev_b32 v70, 16, v47
    v_and_b32 v71, 0xffff0000, v47
    v_fma_f32 v64, v64, v58, v56
    v_fma_f32 v65, v65, v58, v56
    v_fma_f32 v66, v66, v58, v56
    v_fma_f32 v67, v67, v58, v56
    v_fma_f32 v68, v68, v58, v56
    v_fma_f32 v69, v69, v58, v56
    v_fma_f32 v70, v70, v58, v56
    v_fma_f32 v71, v71, v58, v56
    v_cvt_pk_bf16_f32 v44, v64, v65
    v_cvt_pk_bf16_f32 v45, v66, v67
    v_cvt_pk_bf16_f32 v46, v68, v69
    v_cvt_pk_bf16_f32 v47, v70, v71
    v_lshlrev_b32 v64, 16, v48
    v_and_b32 v65, 0xffff0000, v48
    v_lshlrev_b32 v66, 16, v49
    v_and_b32 v67, 0xffff0000, v49
    v_lshlrev_b32 v68, 16, v50
    v_and_b32 v69, 0xffff0000, v50
    v_lshlrev_b32 v70, 16, v51
    v_and_b32 v71, 0xffff0000, v51
    v_fma_f32 v64, v64, v58, v56
    v_fma_f32 v65, v65, v58, v56
    v_fma_f32 v66, v66, v58, v56
    v_fma_f32 v67, v67, v58, v56
    v_fma_f32 v68, v68, v58, v56
    v_fma_f32 v69, v69, v58, v56
    v_fma_f32 v70, v70, v58, v56
    v_fma_f32 v71, v71, v58, v56
    v_cvt_pk_bf16_f32 v48, v64, v65
    v_cvt_pk_bf16_f32 v49, v66, v67
    v_cvt_pk_bf16_f32 v50, v68, v69
    v_cvt_pk_bf16_f32 v51, v70, v71
    buffer_store_dwordx4 v[16:19], v7, s[40:43], s53 offen sc0 sc1
    s_add_u32 s53, s53, 4096
    buffer_store_dwordx4 v[20:23], v7, s[40:43], s53 offen sc0 sc1
    s_add_u32 s53, s53, 4096
    buffer_store_dwordx4 v[24:27], v7, s[40:43], s53 offen sc0 sc1
    s_add_u32 s53, s53, 4096
    buffer_store_dwordx4 v[28:31], v7, s[40:43], s53 offen sc0 sc1
    s_add_u32 s53, s53, 4096
    buffer_store_dwordx4 v[32:35], v7, s[40:43], s53 offen sc0 sc1
    s_add_u32 s53, s53, 4096
    buffer_store_dwordx4 v[36:39], v7, s[40:43], s53 offen sc0 sc1
    s_add_u32 s53, s53, 4096
    buffer_store_dwordx4 v[40:43], v7, s[40:43], s53 offen sc0 sc1
    s_add_u32 s53, s53, 4096
    buffer_store_dwordx4 v[44:47], v7, s[40:43], s53 offen sc0 sc1
    s_add_u32 s53, s53, 4096
    buffer_store_dwordx4 v[48:51], v7, s[40:43], s53 offen sc0 sc1
    s_branch p0_crit
p0_n0:
    s_and_b32 s52, s2, 7
    s_lshr_b32 s53, s2, 3
    s_cmp_ge_u32 s26, 3
    s_cbranch_scc1 p0_n2
    s_sub_u32 s56, s26, 1
    s_lshl_b32 s56, s56, 5
    s_add_u32 s56, s56, s53
    s_mul_i32 s52, s52, 72
    s_add_u32 s56, s56, s52
    s_branch p0_fold
p0_n2:
    s_cmp_eq_u32 s26, 3
    s_cbranch_scc0 p0_n3
    s_cmp_lt_u32 s53, 8
    s_cbranch_scc0 p0_n2b
    s_mul_i32 s52, s52, 72
    s_add_u32 s56, s52, s53
    s_add_u32 s56, s56, 64
    s_branch p0_fold
p0_n2b:
    s_mul_i32 s52, s52, 27
    s_add_u32 s56, s52, s53
    s_sub_u32 s56, s56, 8
    s_branch p0_wo
p0_n3:
    s_cmp_eq_u32 s26, 4
    s_cbranch_scc0 p0_n4
    s_mul_i32 s52, s52, 27
    s_add_u32 s56, s52, s53
    s_add_u32 s56, s56, 24
    s_cmp_lt_u32 s2, 24
    s_cbranch_scc1 p0_wo
    s_sub_u32 s56, s2, 24
    s_movk_i32 s57, 232
    s_branch p0_pack
p0_n4:
    s_sub_u32 s56, s26, 5
    s_lshl_b32 s56, s56, 8
    s_add_u32 s56, s56, s2
    s_add_u32 s56, s56, 464
    s_movk_i32 s57, 768
p0_pack:
    s_add_u32 s57, s56, s57
    s_cmp_ge_u32 s56, 2592
    s_cbranch_scc1 pi0_end
    s_cmp_ge_u32 s56, 1296
    s_cbranch_scc1 pi0_w2
    s_mul_hi_u32 s80, s56, 0x1948b10
    s_mul_i32 s83, s80, 162
    s_sub_u32 s83, s56, s83
    s_mul_hi_u32 s81, s83, 0xe38e38f
    s_mul_i32 s84, s81, 18
    s_sub_u32 s82, s83, s84
    s_mul_i32 s83, s82, 294912
    s_mul_i32 s84, s80, 1152
    s_add_u32 s83, s83, s84
    s_lshl_b32 s84, s81, 7
    s_add_u32 s83, s83, s84
    v_lshrrev_b32 v146, 4, v1
    v_mul_u32_u24 v146, 0x12000, v146
    v_bfe_u32 v147, v1, 2, 2
    v_lshlrev_b32 v147, 5, v147
    v_and_b32 v148, 1, v1
    v_lshlrev_b32 v148, 4, v148
    v_add3_u32 v146, v146, v147, v148
    v_add_u32 v146, s83, v146
    v_and_b32 v147, 2, v1
    v_cmp_eq_u32 vcc, 0, v147
    v_mov_b32 v148, s16
    v_mov_b32 v149, s14
    v_cndmask_b32 v144, v148, v149, vcc
    v_mov_b32 v148, s17
    v_mov_b32 v149, s15
    v_cndmask_b32 v145, v148, v149, vcc
    v_add_co_u32 v144, vcc, v144, v146
    s_mov_b32 s88, 9216
    s_mov_b32 s89, 0
    v_addc_co_u32 v145, vcc, 0, v145, vcc
    global_load_dwordx4 v[16:19], v[144:145], off nt
    v_lshl_add_u64 v[144:145], v[144:145], 0, s[88:89]
    global_load_dwordx4 v[20:23], v[144:145], off nt
    v_lshl_add_u64 v[144:145], v[144:145], 0, s[88:89]
    global_load_dwordx4 v[24:27], v[144:145], off nt
    v_lshl_add_u64 v[144:145], v[144:145], 0, s[88:89]
    global_load_dwordx4 v[28:31], v[144:145], off nt
    v_lshl_add_u64 v[144:145], v[144:145], 0, s[88:89]
    global_load_dwordx4 v[32:35], v[144:145], off nt
    v_lshl_add_u64 v[144:145], v[144:145], 0, s[88:89]
    global_load_dwordx4 v[36:39], v[144:145], off nt
    v_lshl_add_u64 v[144:145], v[144:145], 0, s[88:89]
    global_load_dwordx4 v[40:43], v[144:145], off nt
    v_lshl_add_u64 v[144:145], v[144:145], 0, s[88:89]
    global_load_dwordx4 v[44:47], v[144:145], off nt
    s_branch pi0_end
pi0_w2:
    s_sub_u32 s47, s56, 1296
    s_mul_hi_u32 s46, s47, 0x1948b10
    s_mul_i32 s48, s46, 162
    s_sub_u32 s47, s47, s48
    s_mov_b32 s40, s18
    s_mov_b32 s41, s19
    s_mov_b32 s42, 0x510000
    s_mov_b32 s43, 0x20000
    s_mul_hi_u32 s85, s47, 0x1c71c71d
    s_mul_i32 s87, s85, 9
    s_sub_u32 s84, s47, s87
    v_lshrrev_b32 v152, 4, v1
    s_lshl_b32 s86, s85, 2
    v_add_u32 v152, s86, v152
    v_mul_u32_u24 v153, 57, v152
    v_lshrrev_b32 v153, 9, v153
    v_mul_u32_u24 v154, 9, v153
    v_sub_u32 v152, v152, v154
    v_lshlrev_b32 v154, 2, v153
    v_cmp_gt_u32 vcc, 4, v152
    v_mov_b32 v156, 256
    v_mov_b32 v155, 512
    v_cndmask_b32 v156, v156, 0, vcc
    v_cmp_eq_u32 s[44:45], 8, v152
    v_add_u32 v155, v155, v153
    v_and_b32 v152, 3, v152
    v_lshlrev_b32 v152, 4, v152
    v_add_u32 v156, v156, v152
    s_mul_i32 s86, s46, 663552
    s_lshl_b32 s87, s84, 7
    s_add_u32 s86, s86, s87
    v_and_b32 v157, 15, v1
    v_lshlrev_b32 v157, 3, v157
    v_add_u32 v157, s86, v157
    s_movk_i32 s88, 1152
    v_add_u32 v153, 0, v154
    v_lshrrev_b32 v144, 3, v153
    v_lshlrev_b32 v144, 6, v144
    v_and_b32 v153, 7, v153
    v_add3_u32 v144, v144, v153, v156
    v_add_u32 v153, 0, v155
    v_cndmask_b32 v144, v144, v153, s[44:45]
    v_add_u32 v145, 8, v144
    v_mad_u32_u24 v144, v144, s88, v157
    buffer_load_dwordx2 v[16:17], v144, s[40:43], 0 offen nt
    v_mad_u32_u24 v145, v145, s88, v157
    buffer_load_dwordx2 v[18:19], v145, s[40:43], 0 offen nt
    v_add_u32 v153, 1, v154
    v_lshrrev_b32 v146, 3, v153
    v_lshlrev_b32 v146, 6, v146
    v_and_b32 v153, 7, v153
    v_add3_u32 v146, v146, v153, v156
    v_add_u32 v153, 16, v155
    v_cndmask_b32 v146, v146, v153, s[44:45]
    v_add_u32 v147, 8, v146
    v_mad_u32_u24 v146, v146, s88, v157
    buffer_load_dwordx2 v[20:21], v146, s[40:43], 0 offen nt
    v_mad_u32_u24 v147, v147, s88, v157
    buffer_load_dwordx2 v[22:23], v147, s[40:43], 0 offen nt
    v_add_u32 v153, 2, v154
    v_lshrrev_b32 v148, 3, v153
    v_lshlrev_b32 v148, 6, v148
    v_and_b32 v153, 7, v153
    v_add3_u32 v148, v148, v153, v156
    v_add_u32 v153, 32, v155
    v_cndmask_b32 v148, v148, v153, s[44:45]
    v_add_u32 v149, 8, v148
    v_mad_u32_u24 v148, v148, s88, v157
    buffer_load_dwordx2 v[24:25], v148, s[40:43], 0 offen nt
    v_mad_u32_u24 v149, v149, s88, v157
    buffer_load_dwordx2 v[26:27], v149, s[40:43], 0 offen nt
    v_add_u32 v153, 3, v154
    v_lshrrev_b32 v150, 3, v153
    v_lshlrev_b32 v150, 6, v150
    v_and_b32 v153, 7, v153
    v_add3_u32 v150, v150, v153, v156
    v_add_u32 v153, 48, v155
    v_cndmask_b32 v150, v150, v153, s[44:45]
    v_add_u32 v151, 8, v150
    v_mad_u32_u24 v150, v150, s88, v157
    buffer_load_dwordx2 v[28:29], v150, s[40:43], 0 offen nt
    v_mad_u32_u24 v151, v151, s88, v157
    buffer_load_dwordx2 v[30:31], v151, s[40:43], 0 offen nt
pi0_end:
    s_cmp_ge_u32 s57, 2592
    s_cbranch_scc1 pi1_end
    s_cmp_ge_u32 s57, 1296
    s_cbranch_scc1 pi1_w2
    s_mul_hi_u32 s80, s57, 0x1948b10
    s_mul_i32 s83, s80, 162
    s_sub_u32 s83, s57, s83
    s_mul_hi_u32 s81, s83, 0xe38e38f
    s_mul_i32 s84, s81, 18
    s_sub_u32 s82, s83, s84
    s_mul_i32 s83, s82, 294912
    s_mul_i32 s84, s80, 1152
    s_add_u32 s83, s83, s84
    s_lshl_b32 s84, s81, 7
    s_add_u32 s83, s83, s84
    v_lshrrev_b32 v146, 4, v1
    v_mul_u32_u24 v146, 0x12000, v146
    v_bfe_u32 v147, v1, 2, 2
    v_lshlrev_b32 v147, 5, v147
    v_and_b32 v148, 1, v1
    v_lshlrev_b32 v148, 4, v148
    v_add3_u32 v146, v146, v147, v148
    v_add_u32 v146, s83, v146
    v_and_b32 v147, 2, v1
    v_cmp_eq_u32 vcc, 0, v147
    v_mov_b32 v148, s16
    v_mov_b32 v149, s14
    v_cndmask_b32 v144, v148, v149, vcc
    v_mov_b32 v148, s17
    v_mov_b32 v149, s15
    v_cndmask_b32 v145, v148, v149, vcc
    v_add_co_u32 v144, vcc, v144, v146
    s_mov_b32 s88, 9216
    s_mov_b32 s89, 0
    v_addc_co_u32 v145, vcc, 0, v145, vcc
    global_load_dwordx4 v[48:51], v[144:145], off nt
    v_lshl_add_u64 v[144:145], v[144:145], 0, s[88:89]
    global_load_dwordx4 v[52:55], v[144:145], off nt
    v_lshl_add_u64 v[144:145], v[144:145], 0, s[88:89]
    global_load_dwordx4 v[56:59], v[144:145], off nt
    v_lshl_add_u64 v[144:145], v[144:145], 0, s[88:89]
    global_load_dwordx4 v[60:63], v[144:145], off nt
    v_lshl_add_u64 v[144:145], v[144:145], 0, s[88:89]
    global_load_dwordx4 v[64:67], v[144:145], off nt
    v_lshl_add_u64 v[144:145], v[144:145], 0, s[88:89]
    global_load_dwordx4 v[68:71], v[144:145], off nt
    v_lshl_add_u64 v[144:145], v[144:145], 0, s[88:89]
    global_load_dwordx4 v[72:75], v[144:145], off nt
    v_lshl_add_u64 v[144:145], v[144:145], 0, s[88:89]
    global_load_dwordx4 v[76:79], v[144:145], off nt
    s_branch pi1_end
pi1_w2:
    s_sub_u32 s47, s57, 1296
    s_mul_hi_u32 s46, s47, 0x1948b10
    s_mul_i32 s48, s46, 162
    s_sub_u32 s47, s47, s48
    s_mov_b32 s40, s18
    s_mov_b32 s41, s19
    s_mov_b32 s42, 0x510000
    s_mov_b32 s43, 0x20000
    s_mul_hi_u32 s85, s47, 0x1c71c71d
    s_mul_i32 s87, s85, 9
    s_sub_u32 s84, s47, s87
    v_lshrrev_b32 v152, 4, v1
    s_lshl_b32 s86, s85, 2
    v_add_u32 v152, s86, v152
    v_mul_u32_u24 v153, 57, v152
    v_lshrrev_b32 v153, 9, v153
    v_mul_u32_u24 v154, 9, v153
    v_sub_u32 v152, v152, v154
    v_lshlrev_b32 v154, 2, v153
    v_cmp_gt_u32 vcc, 4, v152
    v_mov_b32 v156, 256
    v_mov_b32 v155, 512
    v_cndmask_b32 v156, v156, 0, vcc
    v_cmp_eq_u32 s[44:45], 8, v152
    v_add_u32 v155, v155, v153
    v_and_b32 v152, 3, v152
    v_lshlrev_b32 v152, 4, v152
    v_add_u32 v156, v156, v152
    s_mul_i32 s86, s46, 663552
    s_lshl_b32 s87, s84, 7
    s_add_u32 s86, s86, s87
    v_and_b32 v157, 15, v1
    v_lshlrev_b32 v157, 3, v157
    v_add_u32 v157, s86, v157
    s_movk_i32 s88, 1152
    v_add_u32 v153, 0, v154
    v_lshrrev_b32 v144, 3, v153
    v_lshlrev_b32 v144, 6, v144
    v_and_b32 v153, 7, v153
    v_add3_u32 v144, v144, v153, v156
    v_add_u32 v153, 0, v155
    v_cndmask_b32 v144, v144, v153, s[44:45]
    v_add_u32 v145, 8, v144
    v_mad_u32_u24 v144, v144, s88, v157
    buffer_load_dwordx2 v[48:49], v144, s[40:43], 0 offen nt
    v_mad_u32_u24 v145, v145, s88, v157
    buffer_load_dwordx2 v[50:51], v145, s[40:43], 0 offen nt
    v_add_u32 v153, 1, v154
    v_lshrrev_b32 v146, 3, v153
    v_lshlrev_b32 v146, 6, v146
    v_and_b32 v153, 7, v153
    v_add3_u32 v146, v146, v153, v156
    v_add_u32 v153, 16, v155
    v_cndmask_b32 v146, v146, v153, s[44:45]
    v_add_u32 v147, 8, v146
    v_mad_u32_u24 v146, v146, s88, v157
    buffer_load_dwordx2 v[52:53], v146, s[40:43], 0 offen nt
    v_mad_u32_u24 v147, v147, s88, v157
    buffer_load_dwordx2 v[54:55], v147, s[40:43], 0 offen nt
    v_add_u32 v153, 2, v154
    v_lshrrev_b32 v148, 3, v153
    v_lshlrev_b32 v148, 6, v148
    v_and_b32 v153, 7, v153
    v_add3_u32 v148, v148, v153, v156
    v_add_u32 v153, 32, v155
    v_cndmask_b32 v148, v148, v153, s[44:45]
    v_add_u32 v149, 8, v148
    v_mad_u32_u24 v148, v148, s88, v157
    buffer_load_dwordx2 v[56:57], v148, s[40:43], 0 offen nt
    v_mad_u32_u24 v149, v149, s88, v157
    buffer_load_dwordx2 v[58:59], v149, s[40:43], 0 offen nt
    v_add_u32 v153, 3, v154
    v_lshrrev_b32 v150, 3, v153
    v_lshlrev_b32 v150, 6, v150
    v_and_b32 v153, 7, v153
    v_add3_u32 v150, v150, v153, v156
    v_add_u32 v153, 48, v155
    v_cndmask_b32 v150, v150, v153, s[44:45]
    v_add_u32 v151, 8, v150
    v_mad_u32_u24 v150, v150, s88, v157
    buffer_load_dwordx2 v[60:61], v150, s[40:43], 0 offen nt
    v_mad_u32_u24 v151, v151, s88, v157
    buffer_load_dwordx2 v[62:63], v151, s[40:43], 0 offen nt
pi1_end:
    s_waitcnt vmcnt(0)
    s_cmp_ge_u32 s56, 2592
    s_cbranch_scc1 pf0_end
    s_cmp_ge_u32 s56, 1296
    s_cbranch_scc1 pf0_w2
    s_add_u32 s36, s24, 0x0
    s_addc_u32 s37, s25, 0
    s_mov_b32 s38, 0xf30000
    s_mov_b32 s39, 0x20000
    s_mul_hi_u32 s80, s56, 0x1948b10
    s_mul_i32 s83, s80, 162
    s_sub_u32 s83, s56, s83
    s_mul_hi_u32 s81, s83, 0xe38e38f
    s_mul_i32 s84, s81, 18
    s_sub_u32 s82, s83, s84
    s_mov_b32 s90, 0x05040100
    s_mov_b32 s91, 0x07060302
    s_mul_i32 s86, s80, 1990656
    v_perm_b32 v80, v20, v16, s90
    v_perm_b32 v81, v28, v24, s90
    v_perm_b32 v82, v36, v32, s90
    v_perm_b32 v83, v44, v40, s90
    v_perm_b32 v84, v20, v16, s91
    v_perm_b32 v85, v28, v24, s91
    v_perm_b32 v86, v36, v32, s91
    v_perm_b32 v87, v44, v40, s91
    v_perm_b32 v88, v21, v17, s90
    v_perm_b32 v89, v29, v25, s90
    v_perm_b32 v90, v37, v33, s90
    v_perm_b32 v91, v45, v41, s90
    v_perm_b32 v92, v21, v17, s91
    v_perm_b32 v93, v29, v25, s91
    v_perm_b32 v94, v37, v33, s91
    v_perm_b32 v95, v45, v41, s91
    v_perm_b32 v96, v22, v18, s90
    v_perm_b32 v97, v30, v26, s90
    v_perm_b32 v98, v38, v34, s90
    v_perm_b32 v99, v46, v42, s90
    v_perm_b32 v100, v22, v18, s91
    v_perm_b32 v101, v30, v26, s91
    v_perm_b32 v102, v38, v34, s91
    v_perm_b32 v103, v46, v42, s91
    v_perm_b32 v104, v23, v19, s90
    v_perm_b32 v105, v31, v27, s90
    v_perm_b32 v106, v39, v35, s90
    v_perm_b32 v107, v47, v43, s90
    v_perm_b32 v108, v23, v19, s91
    v_perm_b32 v109, v31, v27, s91
    v_perm_b32 v110, v39, v35, s91
    v_perm_b32 v111, v47, v43, s91
    s_and_b32 s83, s81, 3
    s_lshl_b32 s83, s83, 3
    s_add_u32 s83, s83, 0
    s_lshr_b32 s84, s83, 2
    s_and_b32 s83, s83, 3
    s_mul_i32 s87, s82, 4
    s_mul_i32 s88, s82, 5
    s_add_u32 s88, s88, 72
    s_cmp_lt_u32 s81, 4
    s_cselect_b32 s87, s87, s88
    s_add_u32 s83, s83, s87
    s_mul_i32 s87, s82, 5
    s_add_u32 s87, s87, 76
    s_cmp_eq_u32 s81, 8
    s_cselect_b32 s84, 0, s84
    s_cselect_b32 s83, s87, s83
    s_mul_i32 s85, s84, 234
    s_add_u32 s85, s85, 72
    s_cmp_lt_u32 s84, 4
    s_mul_i32 s84, s84, 252
    s_cselect_b32 s85, s84, s85
    s_add_u32 s83, s83, s85
    s_lshl_b32 s83, s83, 10
    s_add_u32 s83, s83, s86
    buffer_store_dwordx4 v[80:83], v2, s[36:39], s83 offen sc0 sc1
    s_and_b32 s83, s81, 3
    s_lshl_b32 s83, s83, 3
    s_add_u32 s83, s83, 1
    s_lshr_b32 s84, s83, 2
    s_and_b32 s83, s83, 3
    s_mul_i32 s87, s82, 4
    s_mul_i32 s88, s82, 5
    s_add_u32 s88, s88, 72
    s_cmp_lt_u32 s81, 4
    s_cselect_b32 s87, s87, s88
    s_add_u32 s83, s83, s87
    s_mul_i32 s87, s82, 5
    s_add_u32 s87, s87, 76
    s_cmp_eq_u32 s81, 8
    s_cselect_b32 s84, 1, s84
    s_cselect_b32 s83, s87, s83
    s_mul_i32 s85, s84, 234
    s_add_u32 s85, s85, 72
    s_cmp_lt_u32 s84, 4
    s_mul_i32 s84, s84, 252
    s_cselect_b32 s85, s84, s85
    s_add_u32 s83, s83, s85
    s_lshl_b32 s83, s83, 10
    s_add_u32 s83, s83, s86
    buffer_store_dwordx4 v[84:87], v2, s[36:39], s83 offen sc0 sc1
    s_and_b32 s83, s81, 3
    s_lshl_b32 s83, s83, 3
    s_add_u32 s83, s83, 2
    s_lshr_b32 s84, s83, 2
    s_and_b32 s83, s83, 3
    s_mul_i32 s87, s82, 4
    s_mul_i32 s88, s82, 5
    s_add_u32 s88, s88, 72
    s_cmp_lt_u32 s81, 4
    s_cselect_b32 s87, s87, s88
    s_add_u32 s83, s83, s87
    s_mul_i32 s87, s82, 5
    s_add_u32 s87, s87, 76
    s_cmp_eq_u32 s81, 8
    s_cselect_b32 s84, 2, s84
    s_cselect_b32 s83, s87, s83
    s_mul_i32 s85, s84, 234
    s_add_u32 s85, s85, 72
    s_cmp_lt_u32 s84, 4
    s_mul_i32 s84, s84, 252
    s_cselect_b32 s85, s84, s85
    s_add_u32 s83, s83, s85
    s_lshl_b32 s83, s83, 10
    s_add_u32 s83, s83, s86
    buffer_store_dwordx4 v[88:91], v2, s[36:39], s83 offen sc0 sc1
    s_and_b32 s83, s81, 3
    s_lshl_b32 s83, s83, 3
    s_add_u32 s83, s83, 3
    s_lshr_b32 s84, s83, 2
    s_and_b32 s83, s83, 3
    s_mul_i32 s87, s82, 4
    s_mul_i32 s88, s82, 5
    s_add_u32 s88, s88, 72
    s_cmp_lt_u32 s81, 4
    s_cselect_b32 s87, s87, s88
    s_add_u32 s83, s83, s87
    s_mul_i32 s87, s82, 5
    s_add_u32 s87, s87, 76
    s_cmp_eq_u32 s81, 8
    s_cselect_b32 s84, 3, s84
    s_cselect_b32 s83, s87, s83
    s_mul_i32 s85, s84, 234
    s_add_u32 s85, s85, 72
    s_cmp_lt_u32 s84, 4
    s_mul_i32 s84, s84, 252
    s_cselect_b32 s85, s84, s85
    s_add_u32 s83, s83, s85
    s_lshl_b32 s83, s83, 10
    s_add_u32 s83, s83, s86
    buffer_store_dwordx4 v[92:95], v2, s[36:39], s83 offen sc0 sc1
    s_and_b32 s83, s81, 3
    s_lshl_b32 s83, s83, 3
    s_add_u32 s83, s83, 4
    s_lshr_b32 s84, s83, 2
    s_and_b32 s83, s83, 3
    s_mul_i32 s87, s82, 4
    s_mul_i32 s88, s82, 5
    s_add_u32 s88, s88, 72
    s_cmp_lt_u32 s81, 4
    s_cselect_b32 s87, s87, s88
    s_add_u32 s83, s83, s87
    s_mul_i32 s87, s82, 5
    s_add_u32 s87, s87, 76
    s_cmp_eq_u32 s81, 8
    s_cselect_b32 s84, 4, s84
    s_cselect_b32 s83, s87, s83
    s_mul_i32 s85, s84, 234
    s_add_u32 s85, s85, 72
    s_cmp_lt_u32 s84, 4
    s_mul_i32 s84, s84, 252
    s_cselect_b32 s85, s84, s85
    s_add_u32 s83, s83, s85
    s_lshl_b32 s83, s83, 10
    s_add_u32 s83, s83, s86
    buffer_store_dwordx4 v[96:99], v2, s[36:39], s83 offen sc0 sc1
    s_and_b32 s83, s81, 3
    s_lshl_b32 s83, s83, 3
    s_add_u32 s83, s83, 5
    s_lshr_b32 s84, s83, 2
    s_and_b32 s83, s83, 3
    s_mul_i32 s87, s82, 4
    s_mul_i32 s88, s82, 5
    s_add_u32 s88, s88, 72
    s_cmp_lt_u32 s81, 4
    s_cselect_b32 s87, s87, s88
    s_add_u32 s83, s83, s87
    s_mul_i32 s87, s82, 5
    s_add_u32 s87, s87, 76
    s_cmp_eq_u32 s81, 8
    s_cselect_b32 s84, 5, s84
    s_cselect_b32 s83, s87, s83
    s_mul_i32 s85, s84, 234
    s_add_u32 s85, s85, 72
    s_cmp_lt_u32 s84, 4
    s_mul_i32 s84, s84, 252
    s_cselect_b32 s85, s84, s85
    s_add_u32 s83, s83, s85
    s_lshl_b32 s83, s83, 10
    s_add_u32 s83, s83, s86
    buffer_store_dwordx4 v[100:103], v2, s[36:39], s83 offen sc0 sc1
    s_and_b32 s83, s81, 3
    s_lshl_b32 s83, s83, 3
    s_add_u32 s83, s83, 6
    s_lshr_b32 s84, s83, 2
    s_and_b32 s83, s83, 3
    s_mul_i32 s87, s82, 4
    s_mul_i32 s88, s82, 5
    s_add_u32 s88, s88, 72
    s_cmp_lt_u32 s81, 4
    s_cselect_b32 s87, s87, s88
    s_add_u32 s83, s83, s87
    s_mul_i32 s87, s82, 5
    s_add_u32 s87, s87, 76
    s_cmp_eq_u32 s81, 8
    s_cselect_b32 s84, 6, s84
    s_cselect_b32 s83, s87, s83
    s_mul_i32 s85, s84, 234
    s_add_u32 s85, s85, 72
    s_cmp_lt_u32 s84, 4
    s_mul_i32 s84, s84, 252
    s_cselect_b32 s85, s84, s85
    s_add_u32 s83, s83, s85
    s_lshl_b32 s83, s83, 10
    s_add_u32 s83, s83, s86
    buffer_store_dwordx4 v[104:107], v2, s[36:39], s83 offen sc0 sc1
    s_and_b32 s83, s81, 3
    s_lshl_b32 s83, s83, 3
    s_add_u32 s83, s83, 7
    s_lshr_b32 s84, s83, 2
    s_and_b32 s83, s83, 3
    s_mul_i32 s87, s82, 4
    s_mul_i32 s88, s82, 5
    s_add_u32 s88, s88, 72
    s_cmp_lt_u32 s81, 4
    s_cselect_b32 s87, s87, s88
    s_add_u32 s83, s83, s87
    s_mul_i32 s87, s82, 5
    s_add_u32 s87, s87, 76
    s_cmp_eq_u32 s81, 8
    s_cselect_b32 s84, 7, s84
    s_cselect_b32 s83, s87, s83
    s_mul_i32 s85, s84, 234
    s_add_u32 s85, s85, 72
    s_cmp_lt_u32 s84, 4
    s_mul_i32 s84, s84, 252
    s_cselect_b32 s85, s84, s85
    s_add_u32 s83, s83, s85
    s_lshl_b32 s83, s83, 10
    s_add_u32 s83, s83, s86
    buffer_store_dwordx4 v[108:111], v2, s[36:39], s83 offen sc0 sc1
    s_branch pf0_end
pf0_w2:
    s_sub_u32 s47, s56, 1296
    s_mul_hi_u32 s46, s47, 0x1948b10
    s_mul_i32 s48, s46, 162
    s_sub_u32 s47, s47, s48
    s_add_u32 s40, s24, 0x0
    s_addc_u32 s41, s25, 0
    s_mov_b32 s42, 0xf30000
    s_mov_b32 s43, 0x20000
    s_mul_hi_u32 s82, s47, 0x1c71c71d
    s_mul_i32 s84, s82, 9
    s_sub_u32 s81, s47, s84
    s_mov_b32 s90, 0x05040100
    s_mov_b32 s91, 0x07060302
    s_mul_i32 s86, s46, 1990656
    v_perm_b32 v80, v18, v16, s90
    v_perm_b32 v81, v22, v20, s90
    v_perm_b32 v82, v26, v24, s90
    v_perm_b32 v83, v30, v28, s90
    v_perm_b32 v84, v18, v16, s91
    v_perm_b32 v85, v22, v20, s91
    v_perm_b32 v86, v26, v24, s91
    v_perm_b32 v87, v30, v28, s91
    v_perm_b32 v88, v19, v17, s90
    v_perm_b32 v89, v23, v21, s90
    v_perm_b32 v90, v27, v25, s90
    v_perm_b32 v91, v31, v29, s90
    v_perm_b32 v92, v19, v17, s91
    v_perm_b32 v93, v23, v21, s91
    v_perm_b32 v94, v27, v25, s91
    v_perm_b32 v95, v31, v29, s91
    s_cmp_lt_u32 s81, 8
    s_cselect_b32 s84, s81, 0
    s_cselect_b32 s83, 0, 4
    s_mul_i32 s85, s84, 234
    s_add_u32 s85, s85, 72
    s_cmp_lt_u32 s84, 4
    s_mul_i32 s84, s84, 252
    s_cselect_b32 s85, s84, s85
    s_cselect_b32 s84, 3, 2
    s_mul_i32 s87, s84, s82
    s_lshl_b32 s88, s82, 1
    s_mul_i32 s89, s84, 9
    s_add_u32 s89, s89, s88
    s_cmp_lt_u32 s82, 9
    s_cselect_b32 s88, s88, s89
    s_add_u32 s88, s88, 162
    s_add_u32 s89, s87, 36
    s_add_u32 s87, s87, 18
    s_cmp_lt_u32 s82, 9
    s_cselect_b32 s87, s87, s89
    s_add_u32 s87, s87, 160
    s_cmp_lt_u32 s83, 2
    s_cselect_b32 s84, s88, s87
    s_add_u32 s84, s84, s83
    s_add_u32 s84, s84, s85
    s_lshl_b32 s84, s84, 10
    s_add_u32 s84, s84, s86
    buffer_store_dwordx4 v[80:83], v2, s[40:43], s84 offen sc0 sc1
    s_cmp_lt_u32 s81, 8
    s_cselect_b32 s84, s81, 1
    s_cselect_b32 s83, 1, 4
    s_mul_i32 s85, s84, 234
    s_add_u32 s85, s85, 72
    s_cmp_lt_u32 s84, 4
    s_mul_i32 s84, s84, 252
    s_cselect_b32 s85, s84, s85
    s_cselect_b32 s84, 3, 2
    s_mul_i32 s87, s84, s82
    s_lshl_b32 s88, s82, 1
    s_mul_i32 s89, s84, 9
    s_add_u32 s89, s89, s88
    s_cmp_lt_u32 s82, 9
    s_cselect_b32 s88, s88, s89
    s_add_u32 s88, s88, 162
    s_add_u32 s89, s87, 36
    s_add_u32 s87, s87, 18
    s_cmp_lt_u32 s82, 9
    s_cselect_b32 s87, s87, s89
    s_add_u32 s87, s87, 160
    s_cmp_lt_u32 s83, 2
    s_cselect_b32 s84, s88, s87
    s_add_u32 s84, s84, s83
    s_add_u32 s84, s84, s85
    s_lshl_b32 s84, s84, 10
    s_add_u32 s84, s84, s86
    buffer_store_dwordx4 v[84:87], v2, s[40:43], s84 offen sc0 sc1
    s_cmp_lt_u32 s81, 8
    s_cselect_b32 s84, s81, 2
    s_cselect_b32 s83, 2, 4
    s_mul_i32 s85, s84, 234
    s_add_u32 s85, s85, 72
    s_cmp_lt_u32 s84, 4
    s_mul_i32 s84, s84, 252
    s_cselect_b32 s85, s84, s85
    s_cselect_b32 s84, 3, 2
    s_mul_i32 s87, s84, s82
    s_lshl_b32 s88, s82, 1
    s_mul_i32 s89, s84, 9
    s_add_u32 s89, s89, s88
    s_cmp_lt_u32 s82, 9
    s_cselect_b32 s88, s88, s89
    s_add_u32 s88, s88, 162
    s_add_u32 s89, s87, 36
    s_add_u32 s87, s87, 18
    s_cmp_lt_u32 s82, 9
    s_cselect_b32 s87, s87, s89
    s_add_u32 s87, s87, 160
    s_cmp_lt_u32 s83, 2
    s_cselect_b32 s84, s88, s87
    s_add_u32 s84, s84, s83
    s_add_u32 s84, s84, s85
    s_lshl_b32 s84, s84, 10
    s_add_u32 s84, s84, s86
    buffer_store_dwordx4 v[88:91], v2, s[40:43], s84 offen sc0 sc1
    s_cmp_lt_u32 s81, 8
    s_cselect_b32 s84, s81, 3
    s_cselect_b32 s83, 3, 4
    s_mul_i32 s85, s84, 234
    s_add_u32 s85, s85, 72
    s_cmp_lt_u32 s84, 4
    s_mul_i32 s84, s84, 252
    s_cselect_b32 s85, s84, s85
    s_cselect_b32 s84, 3, 2
    s_mul_i32 s87, s84, s82
    s_lshl_b32 s88, s82, 1
    s_mul_i32 s89, s84, 9
    s_add_u32 s89, s89, s88
    s_cmp_lt_u32 s82, 9
    s_cselect_b32 s88, s88, s89
    s_add_u32 s88, s88, 162
    s_add_u32 s89, s87, 36
    s_add_u32 s87, s87, 18
    s_cmp_lt_u32 s82, 9
    s_cselect_b32 s87, s87, s89
    s_add_u32 s87, s87, 160
    s_cmp_lt_u32 s83, 2
    s_cselect_b32 s84, s88, s87
    s_add_u32 s84, s84, s83
    s_add_u32 s84, s84, s85
    s_lshl_b32 s84, s84, 10
    s_add_u32 s84, s84, s86
    buffer_store_dwordx4 v[92:95], v2, s[40:43], s84 offen sc0 sc1
pf0_end:
    s_cmp_ge_u32 s57, 2592
    s_cbranch_scc1 pf1_end
    s_cmp_ge_u32 s57, 1296
    s_cbranch_scc1 pf1_w2
    s_add_u32 s36, s24, 0x0
    s_addc_u32 s37, s25, 0
    s_mov_b32 s38, 0xf30000
    s_mov_b32 s39, 0x20000
    s_mul_hi_u32 s80, s57, 0x1948b10
    s_mul_i32 s83, s80, 162
    s_sub_u32 s83, s57, s83
    s_mul_hi_u32 s81, s83, 0xe38e38f
    s_mul_i32 s84, s81, 18
    s_sub_u32 s82, s83, s84
    s_mov_b32 s90, 0x05040100
    s_mov_b32 s91, 0x07060302
    s_mul_i32 s86, s80, 1990656
    v_perm_b32 v112, v52, v48, s90
    v_perm_b32 v113, v60, v56, s90
    v_perm_b32 v114, v68, v64, s90
    v_perm_b32 v115, v76, v72, s90
    v_perm_b32 v116, v52, v48, s91
    v_perm_b32 v117, v60, v56, s91
    v_perm_b32 v118, v68, v64, s91
    v_perm_b32 v119, v76, v72, s91
    v_perm_b32 v120, v53, v49, s90
    v_perm_b32 v121, v61, v57, s90
    v_perm_b32 v122, v69, v65, s90
    v_perm_b32 v123, v77, v73, s90
    v_perm_b32 v124, v53, v49, s91
    v_perm_b32 v125, v61, v57, s91
    v_perm_b32 v126, v69, v65, s91
    v_perm_b32 v127, v77, v73, s91
    v_perm_b32 v128, v54, v50, s90
    v_perm_b32 v129, v62, v58, s90
    v_perm_b32 v130, v70, v66, s90
    v_perm_b32 v131, v78, v74, s90
    v_perm_b32 v132, v54, v50, s91
    v_perm_b32 v133, v62, v58, s91
    v_perm_b32 v134, v70, v66, s91
    v_perm_b32 v135, v78, v74, s91
    v_perm_b32 v136, v55, v51, s90
    v_perm_b32 v137, v63, v59, s90
    v_perm_b32 v138, v71, v67, s90
    v_perm_b32 v139, v79, v75, s90
    v_perm_b32 v140, v55, v51, s91
    v_perm_b32 v141, v63, v59, s91
    v_perm_b32 v142, v71, v67, s91
    v_perm_b32 v143, v79, v75, s91
    s_and_b32 s83, s81, 3
    s_lshl_b32 s83, s83, 3
    s_add_u32 s83, s83, 0
    s_lshr_b32 s84, s83, 2
    s_and_b32 s83, s83, 3
    s_mul_i32 s87, s82, 4
    s_mul_i32 s88, s82, 5
    s_add_u32 s88, s88, 72
    s_cmp_lt_u32 s81, 4
    s_cselect_b32 s87, s87, s88
    s_add_u32 s83, s83, s87
    s_mul_i32 s87, s82, 5
    s_add_u32 s87, s87, 76
    s_cmp_eq_u32 s81, 8
    s_cselect_b32 s84, 0, s84
    s_cselect_b32 s83, s87, s83
    s_mul_i32 s85, s84, 234
    s_add_u32 s85, s85, 72
    s_cmp_lt_u32 s84, 4
    s_mul_i32 s84, s84, 252
    s_cselect_b32 s85, s84, s85
    s_add_u32 s83, s83, s85
    s_lshl_b32 s83, s83, 10
    s_add_u32 s83, s83, s86
    buffer_store_dwordx4 v[112:115], v2, s[36:39], s83 offen sc0 sc1
    s_and_b32 s83, s81, 3
    s_lshl_b32 s83, s83, 3
    s_add_u32 s83, s83, 1
    s_lshr_b32 s84, s83, 2
    s_and_b32 s83, s83, 3
    s_mul_i32 s87, s82, 4
    s_mul_i32 s88, s82, 5
    s_add_u32 s88, s88, 72
    s_cmp_lt_u32 s81, 4
    s_cselect_b32 s87, s87, s88
    s_add_u32 s83, s83, s87
    s_mul_i32 s87, s82, 5
    s_add_u32 s87, s87, 76
    s_cmp_eq_u32 s81, 8
    s_cselect_b32 s84, 1, s84
    s_cselect_b32 s83, s87, s83
    s_mul_i32 s85, s84, 234
    s_add_u32 s85, s85, 72
    s_cmp_lt_u32 s84, 4
    s_mul_i32 s84, s84, 252
    s_cselect_b32 s85, s84, s85
    s_add_u32 s83, s83, s85
    s_lshl_b32 s83, s83, 10
    s_add_u32 s83, s83, s86
    buffer_store_dwordx4 v[116:119], v2, s[36:39], s83 offen sc0 sc1
    s_and_b32 s83, s81, 3
    s_lshl_b32 s83, s83, 3
    s_add_u32 s83, s83, 2
    s_lshr_b32 s84, s83, 2
    s_and_b32 s83, s83, 3
    s_mul_i32 s87, s82, 4
    s_mul_i32 s88, s82, 5
    s_add_u32 s88, s88, 72
    s_cmp_lt_u32 s81, 4
    s_cselect_b32 s87, s87, s88
    s_add_u32 s83, s83, s87
    s_mul_i32 s87, s82, 5
    s_add_u32 s87, s87, 76
    s_cmp_eq_u32 s81, 8
    s_cselect_b32 s84, 2, s84
    s_cselect_b32 s83, s87, s83
    s_mul_i32 s85, s84, 234
    s_add_u32 s85, s85, 72
    s_cmp_lt_u32 s84, 4
    s_mul_i32 s84, s84, 252
    s_cselect_b32 s85, s84, s85
    s_add_u32 s83, s83, s85
    s_lshl_b32 s83, s83, 10
    s_add_u32 s83, s83, s86
    buffer_store_dwordx4 v[120:123], v2, s[36:39], s83 offen sc0 sc1
    s_and_b32 s83, s81, 3
    s_lshl_b32 s83, s83, 3
    s_add_u32 s83, s83, 3
    s_lshr_b32 s84, s83, 2
    s_and_b32 s83, s83, 3
    s_mul_i32 s87, s82, 4
    s_mul_i32 s88, s82, 5
    s_add_u32 s88, s88, 72
    s_cmp_lt_u32 s81, 4
    s_cselect_b32 s87, s87, s88
    s_add_u32 s83, s83, s87
    s_mul_i32 s87, s82, 5
    s_add_u32 s87, s87, 76
    s_cmp_eq_u32 s81, 8
    s_cselect_b32 s84, 3, s84
    s_cselect_b32 s83, s87, s83
    s_mul_i32 s85, s84, 234
    s_add_u32 s85, s85, 72
    s_cmp_lt_u32 s84, 4
    s_mul_i32 s84, s84, 252
    s_cselect_b32 s85, s84, s85
    s_add_u32 s83, s83, s85
    s_lshl_b32 s83, s83, 10
    s_add_u32 s83, s83, s86
    buffer_store_dwordx4 v[124:127], v2, s[36:39], s83 offen sc0 sc1
    s_and_b32 s83, s81, 3
    s_lshl_b32 s83, s83, 3
    s_add_u32 s83, s83, 4
    s_lshr_b32 s84, s83, 2
    s_and_b32 s83, s83, 3
    s_mul_i32 s87, s82, 4
    s_mul_i32 s88, s82, 5
    s_add_u32 s88, s88, 72
    s_cmp_lt_u32 s81, 4
    s_cselect_b32 s87, s87, s88
    s_add_u32 s83, s83, s87
    s_mul_i32 s87, s82, 5
    s_add_u32 s87, s87, 76
    s_cmp_eq_u32 s81, 8
    s_cselect_b32 s84, 4, s84
    s_cselect_b32 s83, s87, s83
    s_mul_i32 s85, s84, 234
    s_add_u32 s85, s85, 72
    s_cmp_lt_u32 s84, 4
    s_mul_i32 s84, s84, 252
    s_cselect_b32 s85, s84, s85
    s_add_u32 s83, s83, s85
    s_lshl_b32 s83, s83, 10
    s_add_u32 s83, s83, s86
    buffer_store_dwordx4 v[128:131], v2, s[36:39], s83 offen sc0 sc1
    s_and_b32 s83, s81, 3
    s_lshl_b32 s83, s83, 3
    s_add_u32 s83, s83, 5
    s_lshr_b32 s84, s83, 2
    s_and_b32 s83, s83, 3
    s_mul_i32 s87, s82, 4
    s_mul_i32 s88, s82, 5
    s_add_u32 s88, s88, 72
    s_cmp_lt_u32 s81, 4
    s_cselect_b32 s87, s87, s88
    s_add_u32 s83, s83, s87
    s_mul_i32 s87, s82, 5
    s_add_u32 s87, s87, 76
    s_cmp_eq_u32 s81, 8
    s_cselect_b32 s84, 5, s84
    s_cselect_b32 s83, s87, s83
    s_mul_i32 s85, s84, 234
    s_add_u32 s85, s85, 72
    s_cmp_lt_u32 s84, 4
    s_mul_i32 s84, s84, 252
    s_cselect_b32 s85, s84, s85
    s_add_u32 s83, s83, s85
    s_lshl_b32 s83, s83, 10
    s_add_u32 s83, s83, s86
    buffer_store_dwordx4 v[132:135], v2, s[36:39], s83 offen sc0 sc1
    s_and_b32 s83, s81, 3
    s_lshl_b32 s83, s83, 3
    s_add_u32 s83, s83, 6
    s_lshr_b32 s84, s83, 2
    s_and_b32 s83, s83, 3
    s_mul_i32 s87, s82, 4
    s_mul_i32 s88, s82, 5
    s_add_u32 s88, s88, 72
    s_cmp_lt_u32 s81, 4
    s_cselect_b32 s87, s87, s88
    s_add_u32 s83, s83, s87
    s_mul_i32 s87, s82, 5
    s_add_u32 s87, s87, 76
    s_cmp_eq_u32 s81, 8
    s_cselect_b32 s84, 6, s84
    s_cselect_b32 s83, s87, s83
    s_mul_i32 s85, s84, 234
    s_add_u32 s85, s85, 72
    s_cmp_lt_u32 s84, 4
    s_mul_i32 s84, s84, 252
    s_cselect_b32 s85, s84, s85
    s_add_u32 s83, s83, s85
    s_lshl_b32 s83, s83, 10
    s_add_u32 s83, s83, s86
    buffer_store_dwordx4 v[136:139], v2, s[36:39], s83 offen sc0 sc1
    s_and_b32 s83, s81, 3
    s_lshl_b32 s83, s83, 3
    s_add_u32 s83, s83, 7
    s_lshr_b32 s84, s83, 2
    s_and_b32 s83, s83, 3
    s_mul_i32 s87, s82, 4
    s_mul_i32 s88, s82, 5
    s_add_u32 s88, s88, 72
    s_cmp_lt_u32 s81, 4
    s_cselect_b32 s87, s87, s88
    s_add_u32 s83, s83, s87
    s_mul_i32 s87, s82, 5
    s_add_u32 s87, s87, 76
    s_cmp_eq_u32 s81, 8
    s_cselect_b32 s84, 7, s84
    s_cselect_b32 s83, s87, s83
    s_mul_i32 s85, s84, 234
    s_add_u32 s85, s85, 72
    s_cmp_lt_u32 s84, 4
    s_mul_i32 s84, s84, 252
    s_cselect_b32 s85, s84, s85
    s_add_u32 s83, s83, s85
    s_lshl_b32 s83, s83, 10
    s_add_u32 s83, s83, s86
    buffer_store_dwordx4 v[140:143], v2, s[36:39], s83 offen sc0 sc1
    s_branch pf1_end
pf1_w2:
    s_sub_u32 s47, s57, 1296
    s_mul_hi_u32 s46, s47, 0x1948b10
    s_mul_i32 s48, s46, 162
    s_sub_u32 s47, s47, s48
    s_add_u32 s40, s24, 0x0
    s_addc_u32 s41, s25, 0
    s_mov_b32 s42, 0xf30000
    s_mov_b32 s43, 0x20000
    s_mul_hi_u32 s82, s47, 0x1c71c71d
    s_mul_i32 s84, s82, 9
    s_sub_u32 s81, s47, s84
    s_mov_b32 s90, 0x05040100
    s_mov_b32 s91, 0x07060302
    s_mul_i32 s86, s46, 1990656
    v_perm_b32 v112, v50, v48, s90
    v_perm_b32 v113, v54, v52, s90
    v_perm_b32 v114, v58, v56, s90
    v_perm_b32 v115, v62, v60, s90
    v_perm_b32 v116, v50, v48, s91
    v_perm_b32 v117, v54, v52, s91
    v_perm_b32 v118, v58, v56, s91
    v_perm_b32 v119, v62, v60, s91
    v_perm_b32 v120, v51, v49, s90
    v_perm_b32 v121, v55, v53, s90
    v_perm_b32 v122, v59, v57, s90
    v_perm_b32 v123, v63, v61, s90
    v_perm_b32 v124, v51, v49, s91
    v_perm_b32 v125, v55, v53, s91
    v_perm_b32 v126, v59, v57, s91
    v_perm_b32 v127, v63, v61, s91
    s_cmp_lt_u32 s81, 8
    s_cselect_b32 s84, s81, 0
    s_cselect_b32 s83, 0, 4
    s_mul_i32 s85, s84, 234
    s_add_u32 s85, s85, 72
    s_cmp_lt_u32 s84, 4
    s_mul_i32 s84, s84, 252
    s_cselect_b32 s85, s84, s85
    s_cselect_b32 s84, 3, 2
    s_mul_i32 s87, s84, s82
    s_lshl_b32 s88, s82, 1
    s_mul_i32 s89, s84, 9
    s_add_u32 s89, s89, s88
    s_cmp_lt_u32 s82, 9
    s_cselect_b32 s88, s88, s89
    s_add_u32 s88, s88, 162
    s_add_u32 s89, s87, 36
    s_add_u32 s87, s87, 18
    s_cmp_lt_u32 s82, 9
    s_cselect_b32 s87, s87, s89
    s_add_u32 s87, s87, 160
    s_cmp_lt_u32 s83, 2
    s_cselect_b32 s84, s88, s87
    s_add_u32 s84, s84, s83
    s_add_u32 s84, s84, s85
    s_lshl_b32 s84, s84, 10
    s_add_u32 s84, s84, s86
    buffer_store_dwordx4 v[112:115], v2, s[40:43], s84 offen sc0 sc1
    s_cmp_lt_u32 s81, 8
    s_cselect_b32 s84, s81, 1
    s_cselect_b32 s83, 1, 4
    s_mul_i32 s85, s84, 234
    s_add_u32 s85, s85, 72
    s_cmp_lt_u32 s84, 4
    s_mul_i32 s84, s84, 252
    s_cselect_b32 s85, s84, s85
    s_cselect_b32 s84, 3, 2
    s_mul_i32 s87, s84, s82
    s_lshl_b32 s88, s82, 1
    s_mul_i32 s89, s84, 9
    s_add_u32 s89, s89, s88
    s_cmp_lt_u32 s82, 9
    s_cselect_b32 s88, s88, s89
    s_add_u32 s88, s88, 162
    s_add_u32 s89, s87, 36
    s_add_u32 s87, s87, 18
    s_cmp_lt_u32 s82, 9
    s_cselect_b32 s87, s87, s89
    s_add_u32 s87, s87, 160
    s_cmp_lt_u32 s83, 2
    s_cselect_b32 s84, s88, s87
    s_add_u32 s84, s84, s83
    s_add_u32 s84, s84, s85
    s_lshl_b32 s84, s84, 10
    s_add_u32 s84, s84, s86
    buffer_store_dwordx4 v[116:119], v2, s[40:43], s84 offen sc0 sc1
    s_cmp_lt_u32 s81, 8
    s_cselect_b32 s84, s81, 2
    s_cselect_b32 s83, 2, 4
    s_mul_i32 s85, s84, 234
    s_add_u32 s85, s85, 72
    s_cmp_lt_u32 s84, 4
    s_mul_i32 s84, s84, 252
    s_cselect_b32 s85, s84, s85
    s_cselect_b32 s84, 3, 2
    s_mul_i32 s87, s84, s82
    s_lshl_b32 s88, s82, 1
    s_mul_i32 s89, s84, 9
    s_add_u32 s89, s89, s88
    s_cmp_lt_u32 s82, 9
    s_cselect_b32 s88, s88, s89
    s_add_u32 s88, s88, 162
    s_add_u32 s89, s87, 36
    s_add_u32 s87, s87, 18
    s_cmp_lt_u32 s82, 9
    s_cselect_b32 s87, s87, s89
    s_add_u32 s87, s87, 160
    s_cmp_lt_u32 s83, 2
    s_cselect_b32 s84, s88, s87
    s_add_u32 s84, s84, s83
    s_add_u32 s84, s84, s85
    s_lshl_b32 s84, s84, 10
    s_add_u32 s84, s84, s86
    buffer_store_dwordx4 v[120:123], v2, s[40:43], s84 offen sc0 sc1
    s_cmp_lt_u32 s81, 8
    s_cselect_b32 s84, s81, 3
    s_cselect_b32 s83, 3, 4
    s_mul_i32 s85, s84, 234
    s_add_u32 s85, s85, 72
    s_cmp_lt_u32 s84, 4
    s_mul_i32 s84, s84, 252
    s_cselect_b32 s85, s84, s85
    s_cselect_b32 s84, 3, 2
    s_mul_i32 s87, s84, s82
    s_lshl_b32 s88, s82, 1
    s_mul_i32 s89, s84, 9
    s_add_u32 s89, s89, s88
    s_cmp_lt_u32 s82, 9
    s_cselect_b32 s88, s88, s89
    s_add_u32 s88, s88, 162
    s_add_u32 s89, s87, 36
    s_add_u32 s87, s87, 18
    s_cmp_lt_u32 s82, 9
    s_cselect_b32 s87, s87, s89
    s_add_u32 s87, s87, 160
    s_cmp_lt_u32 s83, 2
    s_cselect_b32 s84, s88, s87
    s_add_u32 s84, s84, s83
    s_add_u32 s84, s84, s85
    s_lshl_b32 s84, s84, 10
    s_add_u32 s84, s84, s86
    buffer_store_dwordx4 v[124:127], v2, s[40:43], s84 offen sc0 sc1
pf1_end:
    s_branch b0_join
p0_fold:
    s_mul_hi_u32 s52, s56, 0xe38e38f
    s_mul_i32 s53, s52, 18
    s_sub_u32 s53, s56, s53
    s_mov_b32 s36, s6
    s_mov_b32 s37, s7
    s_mov_b32 s38, 0x1e6000
    s_mov_b32 s39, 0x20000
    s_mov_b32 s40, s8
    s_mov_b32 s41, s9
    s_mov_b32 s42, 0x5100
    s_mov_b32 s43, 0x20000
    s_add_u32 s44, s24, 0x2900000
    s_addc_u32 s45, s25, 0
    s_mov_b32 s46, 0x240000
    s_mov_b32 s47, 0x20000
    v_and_b32 v13, 31, v1
    v_lshrrev_b32 v4, 5, v1
    v_mul_u32_u24 v5, 3456, v13
    v_lshl_add_u32 v6, v4, 4, v5
    s_mul_i32 s54, s53, 110592
    s_mul_i32 s55, s52, 36
    s_add_u32 s54, s54, s55
    buffer_load_dwordx4 v[16:19], v6, s[36:39], s54 offen
    buffer_load_dwordx4 v[20:23], v6, s[36:39], s54 offen offset:1152
    buffer_load_dwordx4 v[24:27], v6, s[36:39], s54 offen offset:2304
    buffer_load_dword v28, v5, s[36:39], s54 offen offset:32
    buffer_load_dword v32, v5, s[36:39], s54 offen offset:1184
    buffer_load_dword v29, v5, s[36:39], s54 offen offset:2336
    v_bfe_u32 v7, v13, 2, 1
    v_lshrrev_b32 v36, 3, v13
    v_and_b32 v37, 3, v13
    v_lshl_add_u32 v36, v36, 2, v37
    v_mul_u32_u24 v37, 9, v7
    v_add_u32 v38, v37, v36
    v_lshlrev_b32 v39, 1, v38
    v_mov_b32 v40, 0x40000000
    v_cmp_gt_u32 vcc, 9, v36
    s_mul_i32 s55, s52, 648
    s_nop 0
    v_cndmask_b32 v39, v40, v39, vcc
    v_mul_u32_u24 v41, 288, v4
    v_add_u32 v41, v41, v39
    buffer_load_ushort v112, v41, s[40:43], s55 offen offset:0
    buffer_load_ushort v113, v41, s[40:43], s55 offen offset:36
    buffer_load_ushort v114, v41, s[40:43], s55 offen offset:72
    buffer_load_ushort v115, v41, s[40:43], s55 offen offset:108
    buffer_load_ushort v116, v41, s[40:43], s55 offen offset:144
    buffer_load_ushort v117, v41, s[40:43], s55 offen offset:180
    buffer_load_ushort v118, v41, s[40:43], s55 offen offset:216
    buffer_load_ushort v119, v41, s[40:43], s55 offen offset:252
    v_cmp_eq_u32 vcc, 0, v4
    s_nop 1
    v_cndmask_b32 v42, v40, v39, vcc
    buffer_load_ushort v120, v42, s[40:43], s55 offen offset:576
    buffer_load_ushort v121, v42, s[40:43], s55 offen offset:612
    v_add_u32 v64, -9, v38
    v_mov_b32 v65, -100
    v_cmp_lt_u32 vcc, 8, v36
    s_nop 1
    v_cndmask_b32 v66, v65, v64, vcc
    v_add_u32 v64, 7, v64
    v_add_u32 v67, -9, v36
    v_cmp_gt_u32 vcc, 2, v67
    s_nop 1
    v_cndmask_b32 v67, v65, v64, vcc
    v_lshlrev_b32 v68, 3, v4
    v_mov_b32 v69, 0x3f80
    v_sub_u32 v70, v66, v68
    v_and_b32 v71, 1, v70
    v_lshlrev_b32 v71, 4, v71
    v_lshlrev_b32 v71, v71, v69
    v_ashrrev_i32 v70, 1, v70
    v_cmp_eq_u32 vcc, 0, v70
    s_nop 1
    v_cndmask_b32 v56, 0, v71, vcc
    v_cmp_eq_u32 vcc, 1, v70
    s_nop 1
    v_cndmask_b32 v57, 0, v71, vcc
    v_cmp_eq_u32 vcc, 2, v70
    s_nop 1
    v_cndmask_b32 v58, 0, v71, vcc
    v_cmp_eq_u32 vcc, 3, v70
    s_nop 1
    v_cndmask_b32 v59, 0, v71, vcc
    v_add_u32 v70, -16, v66
    v_and_b32 v71, 1, v70
    v_lshlrev_b32 v71, 4, v71
    v_lshlrev_b32 v71, v71, v69
    v_ashrrev_i32 v70, 1, v70
    v_or_b32 v70, v70, v4
    v_cmp_eq_u32 vcc, 0, v70
    s_nop 1
    v_cndmask_b32 v49, 0, v71, vcc
    v_mov_b32 v50, 0
    v_mov_b32 v51, 0
    v_sub_u32 v70, v67, v68
    v_and_b32 v71, 1, v70
    v_lshlrev_b32 v71, 4, v71
    v_lshlrev_b32 v71, v71, v69
    v_ashrrev_i32 v70, 1, v70
    v_cmp_eq_u32 vcc, 0, v70
    s_nop 1
    v_cndmask_b32 v60, 0, v71, vcc
    v_cmp_eq_u32 vcc, 1, v70
    s_nop 1
    v_cndmask_b32 v61, 0, v71, vcc
    v_cmp_eq_u32 vcc, 2, v70
    s_nop 1
    v_cndmask_b32 v62, 0, v71, vcc
    v_cmp_eq_u32 vcc, 3, v70
    s_nop 1
    v_cndmask_b32 v63, 0, v71, vcc
    v_add_u32 v70, -16, v67
    v_and_b32 v71, 1, v70
    v_lshlrev_b32 v71, 4, v71
    v_lshlrev_b32 v71, v71, v69
    v_ashrrev_i32 v70, 1, v70
    v_or_b32 v70, v70, v4
    v_cmp_eq_u32 vcc, 0, v70
    s_nop 1
    v_cndmask_b32 v53, 0, v71, vcc
    v_mov_b32 v54, 0
    v_mov_b32 v55, 0
    s_waitcnt vmcnt(0)
    v_lshl_or_b32 v44, v113, 16, v112
    v_lshl_or_b32 v45, v115, 16, v114
    v_lshl_or_b32 v46, v117, 16, v116
    v_lshl_or_b32 v47, v119, 16, v118
    v_lshl_or_b32 v48, v121, 16, v120
    v_mov_b32 v52, v48
    v_cmp_eq_u32 vcc, 0, v4
    v_mov_b32 v33, v29
    s_nop 0
    v_cndmask_b32 v28, 0, v28, vcc
    v_cndmask_b32 v29, 0, v29, vcc
    v_cndmask_b32 v32, 0, v32, vcc
    v_cndmask_b32 v33, 0, v33, vcc
    v_mov_b32 v30, 0
    v_mov_b32 v31, 0
    v_mov_b32 v34, 0
    v_mov_b32 v35, 0
    s_nop 1
    v_mfma_f32_32x32x16_bf16 v[72:87], v[16:19], v[44:47], 0
    v_mfma_f32_32x32x16_bf16 v[88:103], v[20:23], v[44:47], 0
    v_mfma_f32_32x32x16_bf16 v[72:87], v[28:31], v[48:51], v[72:87]
    v_mfma_f32_32x32x16_bf16 v[88:103], v[32:35], v[52:55], v[88:103]
    v_mfma_f32_32x32x16_bf16 v[72:87], v[24:27], v[56:59], v[72:87]
    v_mfma_f32_32x32x16_bf16 v[88:103], v[24:27], v[60:63], v[88:103]
    s_mul_i32 s54, s52, 73728
    s_lshl_b32 s55, s53, 12
    s_add_u32 s54, s54, s55
    s_nop 15
    v_cvt_pk_bf16_f32 v124, v72, v73
    v_cvt_pk_bf16_f32 v125, v74, v75
    v_cvt_pk_bf16_f32 v126, v76, v77
    v_cvt_pk_bf16_f32 v127, v78, v79
    s_nop 1
    v_permlane32_swap_b32 v124, v126
    v_permlane32_swap_b32 v125, v127
    buffer_store_dwordx4 v[124:127], v2, s[44:47], s54 offen offset:0 sc0 sc1
    v_cvt_pk_bf16_f32 v128, v80, v81
    v_cvt_pk_bf16_f32 v129, v82, v83
    v_cvt_pk_bf16_f32 v130, v84, v85
    v_cvt_pk_bf16_f32 v131, v86, v87
    s_nop 1
    v_permlane32_swap_b32 v128, v130
    v_permlane32_swap_b32 v129, v131
    buffer_store_dwordx4 v[128:131], v2, s[44:47], s54 offen offset:2048 sc0 sc1
    v_cvt_pk_bf16_f32 v132, v88, v89
    v_cvt_pk_bf16_f32 v133, v90, v91
    v_cvt_pk_bf16_f32 v134, v92, v93
    v_cvt_pk_bf16_f32 v135, v94, v95
    s_nop 1
    v_permlane32_swap_b32 v132, v134
    v_permlane32_swap_b32 v133, v135
    buffer_store_dwordx4 v[132:135], v2, s[44:47], s54 offen offset:1024 sc0 sc1
    v_cvt_pk_bf16_f32 v136, v96, v97
    v_cvt_pk_bf16_f32 v137, v98, v99
    v_cvt_pk_bf16_f32 v138, v100, v101
    v_cvt_pk_bf16_f32 v139, v102, v103
    s_nop 1
    v_permlane32_swap_b32 v136, v138
    v_permlane32_swap_b32 v137, v139
    buffer_store_dwordx4 v[136:139], v2, s[44:47], s54 offen offset:3072 sc0 sc1
    s_branch p0_crit
p0_wo:
    s_mul_hi_u32 s52, s56, 0x2aaaaaab
    s_mul_i32 s53, s52, 6
    s_sub_u32 s53, s56, s53
    s_mov_b32 s36, s10
    s_mov_b32 s37, s11
    s_mov_b32 s38, 0xa2000
    s_mov_b32 s39, 0x20000
    s_add_u32 s40, s24, 0x2c00000
    s_addc_u32 s41, s25, 0
    s_mov_b32 s42, 0xa2000
    s_mov_b32 s43, 0x20000
    v_lshrrev_b32 v4, 4, v1
    v_and_b32 v5, 15, v1
    s_lshl_b32 s54, s52, 5
    v_lshlrev_b32 v5, 1, v5
    v_add_u32 v5, s54, v5
    s_movk_i32 s55, 1152
    s_mul_i32 s54, s53, 12
    v_add_u32 v6, s54, v4
    v_mul_u32_u24 v7, 57, v6
    v_lshrrev_b32 v7, 9, v7
    v_mul_u32_u24 v8, 9, v7
    v_sub_u32 v6, v6, v8
    v_mul_u32_u24 v7, 72, v7
    v_cmp_eq_u32 s[44:45], 8, v6
    v_and_b32 v8, 3, v6
    v_lshlrev_b32 v8, 2, v8
    v_lshrrev_b32 v9, 2, v6
    v_add_u32 v10, 0, v8
    v_mov_b32 v11, 16
    v_cndmask_b32 v10, v10, v11, s[44:45]
    v_mov_b32 v11, 0
    v_cndmask_b32 v11, v9, v11, s[44:45]
    v_cmp_lt_u32 vcc, 8, v10
    v_mad_u32_u24 v12, v11, 9, v7
    v_add_u32 v12, v12, v10
    v_add_u32 v13, 27, v12
    v_cndmask_b32 v12, v12, v13, vcc
    v_mad_u32_u24 v32, v12, s55, v5
    v_add_u32 v33, 20736, v32
    buffer_load_ushort v72, v32, s[36:39], 0 offen
    buffer_load_ushort v73, v33, s[36:39], 0 offen
    v_add_u32 v10, 1, v8
    v_mov_b32 v11, 17
    v_cndmask_b32 v10, v10, v11, s[44:45]
    v_mov_b32 v11, 0
    v_cndmask_b32 v11, v9, v11, s[44:45]
    v_cmp_lt_u32 vcc, 8, v10
    v_mad_u32_u24 v12, v11, 9, v7
    v_add_u32 v12, v12, v10
    v_add_u32 v13, 27, v12
    v_cndmask_b32 v12, v12, v13, vcc
    v_mad_u32_u24 v34, v12, s55, v5
    v_add_u32 v35, 20736, v34
    buffer_load_ushort v74, v34, s[36:39], 0 offen
    buffer_load_ushort v75, v35, s[36:39], 0 offen
    v_add_u32 v10, 2, v8
    v_mov_b32 v11, 16
    v_cndmask_b32 v10, v10, v11, s[44:45]
    v_mov_b32 v11, 1
    v_cndmask_b32 v11, v9, v11, s[44:45]
    v_cmp_lt_u32 vcc, 8, v10
    v_mad_u32_u24 v12, v11, 9, v7
    v_add_u32 v12, v12, v10
    v_add_u32 v13, 27, v12
    v_cndmask_b32 v12, v12, v13, vcc
    v_mad_u32_u24 v36, v12, s55, v5
    v_add_u32 v37, 20736, v36
    buffer_load_ushort v76, v36, s[36:39], 0 offen
    buffer_load_ushort v77, v37, s[36:39], 0 offen
    v_add_u32 v10, 3, v8
    v_mov_b32 v11, 17
    v_cndmask_b32 v10, v10, v11, s[44:45]
    v_mov_b32 v11, 1
    v_cndmask_b32 v11, v9, v11, s[44:45]
    v_cmp_lt_u32 vcc, 8, v10
    v_mad_u32_u24 v12, v11, 9, v7
    v_add_u32 v12, v12, v10
    v_add_u32 v13, 27, v12
    v_cndmask_b32 v12, v12, v13, vcc
    v_mad_u32_u24 v38, v12, s55, v5
    v_add_u32 v39, 20736, v38
    buffer_load_ushort v78, v38, s[36:39], 0 offen
    buffer_load_ushort v79, v39, s[36:39], 0 offen
    v_add_u32 v6, s54, v4
    v_add_u32 v6, 4, v6
    v_mul_u32_u24 v7, 57, v6
    v_lshrrev_b32 v7, 9, v7
    v_mul_u32_u24 v8, 9, v7
    v_sub_u32 v6, v6, v8
    v_mul_u32_u24 v7, 72, v7
    v_cmp_eq_u32 s[44:45], 8, v6
    v_and_b32 v8, 3, v6
    v_lshlrev_b32 v8, 2, v8
    v_lshrrev_b32 v9, 2, v6
    v_add_u32 v10, 0, v8
    v_mov_b32 v11, 16
    v_cndmask_b32 v10, v10, v11, s[44:45]
    v_mov_b32 v11, 0
    v_cndmask_b32 v11, v9, v11, s[44:45]
    v_cmp_lt_u32 vcc, 8, v10
    v_mad_u32_u24 v12, v11, 9, v7
    v_add_u32 v12, v12, v10
    v_add_u32 v13, 27, v12
    v_cndmask_b32 v12, v12, v13, vcc
    v_mad_u32_u24 v40, v12, s55, v5
    v_add_u32 v41, 20736, v40
    buffer_load_ushort v80, v40, s[36:39], 0 offen
    buffer_load_ushort v81, v41, s[36:39], 0 offen
    v_add_u32 v10, 1, v8
    v_mov_b32 v11, 17
    v_cndmask_b32 v10, v10, v11, s[44:45]
    v_mov_b32 v11, 0
    v_cndmask_b32 v11, v9, v11, s[44:45]
    v_cmp_lt_u32 vcc, 8, v10
    v_mad_u32_u24 v12, v11, 9, v7
    v_add_u32 v12, v12, v10
    v_add_u32 v13, 27, v12
    v_cndmask_b32 v12, v12, v13, vcc
    v_mad_u32_u24 v42, v12, s55, v5
    v_add_u32 v43, 20736, v42
    buffer_load_ushort v82, v42, s[36:39], 0 offen
    buffer_load_ushort v83, v43, s[36:39], 0 offen
    v_add_u32 v10, 2, v8
    v_mov_b32 v11, 16
    v_cndmask_b32 v10, v10, v11, s[44:45]
    v_mov_b32 v11, 1
    v_cndmask_b32 v11, v9, v11, s[44:45]
    v_cmp_lt_u32 vcc, 8, v10
    v_mad_u32_u24 v12, v11, 9, v7
    v_add_u32 v12, v12, v10
    v_add_u32 v13, 27, v12
    v_cndmask_b32 v12, v12, v13, vcc
    v_mad_u32_u24 v44, v12, s55, v5
    v_add_u32 v45, 20736, v44
    buffer_load_ushort v84, v44, s[36:39], 0 offen
    buffer_load_ushort v85, v45, s[36:39], 0 offen
    v_add_u32 v10, 3, v8
    v_mov_b32 v11, 17
    v_cndmask_b32 v10, v10, v11, s[44:45]
    v_mov_b32 v11, 1
    v_cndmask_b32 v11, v9, v11, s[44:45]
    v_cmp_lt_u32 vcc, 8, v10
    v_mad_u32_u24 v12, v11, 9, v7
    v_add_u32 v12, v12, v10
    v_add_u32 v13, 27, v12
    v_cndmask_b32 v12, v12, v13, vcc
    v_mad_u32_u24 v46, v12, s55, v5
    v_add_u32 v47, 20736, v46
    buffer_load_ushort v86, v46, s[36:39], 0 offen
    buffer_load_ushort v87, v47, s[36:39], 0 offen
    v_add_u32 v6, s54, v4
    v_add_u32 v6, 8, v6
    v_mul_u32_u24 v7, 57, v6
    v_lshrrev_b32 v7, 9, v7
    v_mul_u32_u24 v8, 9, v7
    v_sub_u32 v6, v6, v8
    v_mul_u32_u24 v7, 72, v7
    v_cmp_eq_u32 s[44:45], 8, v6
    v_and_b32 v8, 3, v6
    v_lshlrev_b32 v8, 2, v8
    v_lshrrev_b32 v9, 2, v6
    v_add_u32 v10, 0, v8
    v_mov_b32 v11, 16
    v_cndmask_b32 v10, v10, v11, s[44:45]
    v_mov_b32 v11, 0
    v_cndmask_b32 v11, v9, v11, s[44:45]
    v_cmp_lt_u32 vcc, 8, v10
    v_mad_u32_u24 v12, v11, 9, v7
    v_add_u32 v12, v12, v10
    v_add_u32 v13, 27, v12
    v_cndmask_b32 v12, v12, v13, vcc
    v_mad_u32_u24 v48, v12, s55, v5
    v_add_u32 v49, 20736, v48
    buffer_load_ushort v88, v48, s[36:39], 0 offen
    buffer_load_ushort v89, v49, s[36:39], 0 offen
    v_add_u32 v10, 1, v8
    v_mov_b32 v11, 17
    v_cndmask_b32 v10, v10, v11, s[44:45]
    v_mov_b32 v11, 0
    v_cndmask_b32 v11, v9, v11, s[44:45]
    v_cmp_lt_u32 vcc, 8, v10
    v_mad_u32_u24 v12, v11, 9, v7
    v_add_u32 v12, v12, v10
    v_add_u32 v13, 27, v12
    v_cndmask_b32 v12, v12, v13, vcc
    v_mad_u32_u24 v50, v12, s55, v5
    v_add_u32 v51, 20736, v50
    buffer_load_ushort v90, v50, s[36:39], 0 offen
    buffer_load_ushort v91, v51, s[36:39], 0 offen
    v_add_u32 v10, 2, v8
    v_mov_b32 v11, 16
    v_cndmask_b32 v10, v10, v11, s[44:45]
    v_mov_b32 v11, 1
    v_cndmask_b32 v11, v9, v11, s[44:45]
    v_cmp_lt_u32 vcc, 8, v10
    v_mad_u32_u24 v12, v11, 9, v7
    v_add_u32 v12, v12, v10
    v_add_u32 v13, 27, v12
    v_cndmask_b32 v12, v12, v13, vcc
    v_mad_u32_u24 v52, v12, s55, v5
    v_add_u32 v53, 20736, v52
    buffer_load_ushort v92, v52, s[36:39], 0 offen
    buffer_load_ushort v93, v53, s[36:39], 0 offen
    v_add_u32 v10, 3, v8
    v_mov_b32 v11, 17
    v_cndmask_b32 v10, v10, v11, s[44:45]
    v_mov_b32 v11, 1
    v_cndmask_b32 v11, v9, v11, s[44:45]
    v_cmp_lt_u32 vcc, 8, v10
    v_mad_u32_u24 v12, v11, 9, v7
    v_add_u32 v12, v12, v10
    v_add_u32 v13, 27, v12
    v_cndmask_b32 v12, v12, v13, vcc
    v_mad_u32_u24 v54, v12, s55, v5
    v_add_u32 v55, 20736, v54
    buffer_load_ushort v94, v54, s[36:39], 0 offen
    buffer_load_ushort v95, v55, s[36:39], 0 offen
    s_mul_i32 s54, s52, 18
    s_mul_i32 s55, s53, 3
    s_add_u32 s54, s54, s55
    s_lshl_b32 s54, s54, 10
    s_waitcnt vmcnt(0)
    v_lshl_or_b32 v56, v73, 16, v72
    v_lshl_or_b32 v57, v75, 16, v74
    v_lshl_or_b32 v58, v77, 16, v76
    v_lshl_or_b32 v59, v79, 16, v78
    buffer_store_dwordx4 v[56:59], v2, s[40:43], s54 offen offset:0 sc0 sc1
    v_lshl_or_b32 v60, v81, 16, v80
    v_lshl_or_b32 v61, v83, 16, v82
    v_lshl_or_b32 v62, v85, 16, v84
    v_lshl_or_b32 v63, v87, 16, v86
    buffer_store_dwordx4 v[60:63], v2, s[40:43], s54 offen offset:1024 sc0 sc1
    v_lshl_or_b32 v64, v89, 16, v88
    v_lshl_or_b32 v65, v91, 16, v90
    v_lshl_or_b32 v66, v93, 16, v92
    v_lshl_or_b32 v67, v95, 16, v94
    buffer_store_dwordx4 v[64:67], v2, s[40:43], s54 offen offset:2048 sc0 sc1
p0_crit:
    s_waitcnt vmcnt(0)
    v_mov_b32 v4, 147472
    v_mov_b32 v5, 1
    s_mov_b64 exec, 1
    ds_add_u32 v4, v5
    s_mov_b64 exec, -1
    s_cmp_eq_u32 s26, 0
    s_cbranch_scc1 p0_w0
p0_extra:
    s_sub_u32 s56, s26, 1
    s_lshl_b32 s56, s56, 8
    s_add_u32 s56, s56, s2
    s_add_u32 s56, s56, 2000
    s_cmp_ge_u32 s56, 2592
    s_cbranch_scc1 p0_drain
    s_cmp_ge_u32 s56, 1296
    s_cbranch_scc1 pk1_w2
    s_mul_hi_u32 s80, s56, 0x1948b10
    s_mul_i32 s83, s80, 162
    s_sub_u32 s83, s56, s83
    s_mul_hi_u32 s81, s83, 0xe38e38f
    s_mul_i32 s84, s81, 18
    s_sub_u32 s82, s83, s84
    s_mul_i32 s83, s82, 294912
    s_mul_i32 s84, s80, 1152
    s_add_u32 s83, s83, s84
    s_lshl_b32 s84, s81, 7
    s_add_u32 s83, s83, s84
    v_lshrrev_b32 v10, 4, v1
    v_mul_u32_u24 v10, 0x12000, v10
    v_bfe_u32 v11, v1, 2, 2
    v_lshlrev_b32 v11, 5, v11
    v_and_b32 v12, 1, v1
    v_lshlrev_b32 v12, 4, v12
    v_add3_u32 v10, v10, v11, v12
    v_add_u32 v10, s83, v10
    v_and_b32 v11, 2, v1
    v_cmp_eq_u32 vcc, 0, v11
    v_mov_b32 v12, s16
    v_mov_b32 v13, s14
    v_cndmask_b32 v8, v12, v13, vcc
    v_mov_b32 v12, s17
    v_mov_b32 v13, s15
    v_cndmask_b32 v9, v12, v13, vcc
    v_add_co_u32 v8, vcc, v8, v10
    s_mov_b32 s88, 9216
    s_mov_b32 s89, 0
    v_addc_co_u32 v9, vcc, 0, v9, vcc
    global_load_dwordx4 v[16:19], v[8:9], off nt
    v_lshl_add_u64 v[8:9], v[8:9], 0, s[88:89]
    global_load_dwordx4 v[20:23], v[8:9], off nt
    v_lshl_add_u64 v[8:9], v[8:9], 0, s[88:89]
    global_load_dwordx4 v[24:27], v[8:9], off nt
    v_lshl_add_u64 v[8:9], v[8:9], 0, s[88:89]
    global_load_dwordx4 v[28:31], v[8:9], off nt
    v_lshl_add_u64 v[8:9], v[8:9], 0, s[88:89]
    global_load_dwordx4 v[32:35], v[8:9], off nt
    v_lshl_add_u64 v[8:9], v[8:9], 0, s[88:89]
    global_load_dwordx4 v[36:39], v[8:9], off nt
    v_lshl_add_u64 v[8:9], v[8:9], 0, s[88:89]
    global_load_dwordx4 v[40:43], v[8:9], off nt
    v_lshl_add_u64 v[8:9], v[8:9], 0, s[88:89]
    global_load_dwordx4 v[44:47], v[8:9], off nt
    s_waitcnt vmcnt(0)
    s_add_u32 s36, s24, 0x0
    s_addc_u32 s37, s25, 0
    s_mov_b32 s38, 0xf30000
    s_mov_b32 s39, 0x20000
    s_mov_b32 s90, 0x05040100
    s_mov_b32 s91, 0x07060302
    s_mul_i32 s86, s80, 1990656
    v_perm_b32 v48, v20, v16, s90
    v_perm_b32 v49, v28, v24, s90
    v_perm_b32 v50, v36, v32, s90
    v_perm_b32 v51, v44, v40, s90
    v_perm_b32 v52, v20, v16, s91
    v_perm_b32 v53, v28, v24, s91
    v_perm_b32 v54, v36, v32, s91
    v_perm_b32 v55, v44, v40, s91
    v_perm_b32 v56, v21, v17, s90
    v_perm_b32 v57, v29, v25, s90
    v_perm_b32 v58, v37, v33, s90
    v_perm_b32 v59, v45, v41, s90
    v_perm_b32 v60, v21, v17, s91
    v_perm_b32 v61, v29, v25, s91
    v_perm_b32 v62, v37, v33, s91
    v_perm_b32 v63, v45, v41, s91
    v_perm_b32 v64, v22, v18, s90
    v_perm_b32 v65, v30, v26, s90
    v_perm_b32 v66, v38, v34, s90
    v_perm_b32 v67, v46, v42, s90
    v_perm_b32 v68, v22, v18, s91
    v_perm_b32 v69, v30, v26, s91
    v_perm_b32 v70, v38, v34, s91
    v_perm_b32 v71, v46, v42, s91
    v_perm_b32 v72, v23, v19, s90
    v_perm_b32 v73, v31, v27, s90
    v_perm_b32 v74, v39, v35, s90
    v_perm_b32 v75, v47, v43, s90
    v_perm_b32 v76, v23, v19, s91
    v_perm_b32 v77, v31, v27, s91
    v_perm_b32 v78, v39, v35, s91
    v_perm_b32 v79, v47, v43, s91
    s_and_b32 s83, s81, 3
    s_lshl_b32 s83, s83, 3
    s_add_u32 s83, s83, 0
    s_lshr_b32 s84, s83, 2
    s_and_b32 s83, s83, 3
    s_mul_i32 s87, s82, 4
    s_mul_i32 s88, s82, 5
    s_add_u32 s88, s88, 72
    s_cmp_lt_u32 s81, 4
    s_cselect_b32 s87, s87, s88
    s_add_u32 s83, s83, s87
    s_mul_i32 s87, s82, 5
    s_add_u32 s87, s87, 76
    s_cmp_eq_u32 s81, 8
    s_cselect_b32 s84, 0, s84
    s_cselect_b32 s83, s87, s83
    s_mul_i32 s85, s84, 234
    s_add_u32 s85, s85, 72
    s_cmp_lt_u32 s84, 4
    s_mul_i32 s84, s84, 252
    s_cselect_b32 s85, s84, s85
    s_add_u32 s83, s83, s85
    s_lshl_b32 s83, s83, 10
    s_add_u32 s83, s83, s86
    buffer_store_dwordx4 v[48:51], v2, s[36:39], s83 offen sc0 sc1
    s_and_b32 s83, s81, 3
    s_lshl_b32 s83, s83, 3
    s_add_u32 s83, s83, 1
    s_lshr_b32 s84, s83, 2
    s_and_b32 s83, s83, 3
    s_mul_i32 s87, s82, 4
    s_mul_i32 s88, s82, 5
    s_add_u32 s88, s88, 72
    s_cmp_lt_u32 s81, 4
    s_cselect_b32 s87, s87, s88
    s_add_u32 s83, s83, s87
    s_mul_i32 s87, s82, 5
    s_add_u32 s87, s87, 76
    s_cmp_eq_u32 s81, 8
    s_cselect_b32 s84, 1, s84
    s_cselect_b32 s83, s87, s83
    s_mul_i32 s85, s84, 234
    s_add_u32 s85, s85, 72
    s_cmp_lt_u32 s84, 4
    s_mul_i32 s84, s84, 252
    s_cselect_b32 s85, s84, s85
    s_add_u32 s83, s83, s85
    s_lshl_b32 s83, s83, 10
    s_add_u32 s83, s83, s86
    buffer_store_dwordx4 v[52:55], v2, s[36:39], s83 offen sc0 sc1
    s_and_b32 s83, s81, 3
    s_lshl_b32 s83, s83, 3
    s_add_u32 s83, s83, 2
    s_lshr_b32 s84, s83, 2
    s_and_b32 s83, s83, 3
    s_mul_i32 s87, s82, 4
    s_mul_i32 s88, s82, 5
    s_add_u32 s88, s88, 72
    s_cmp_lt_u32 s81, 4
    s_cselect_b32 s87, s87, s88
    s_add_u32 s83, s83, s87
    s_mul_i32 s87, s82, 5
    s_add_u32 s87, s87, 76
    s_cmp_eq_u32 s81, 8
    s_cselect_b32 s84, 2, s84
    s_cselect_b32 s83, s87, s83
    s_mul_i32 s85, s84, 234
    s_add_u32 s85, s85, 72
    s_cmp_lt_u32 s84, 4
    s_mul_i32 s84, s84, 252
    s_cselect_b32 s85, s84, s85
    s_add_u32 s83, s83, s85
    s_lshl_b32 s83, s83, 10
    s_add_u32 s83, s83, s86
    buffer_store_dwordx4 v[56:59], v2, s[36:39], s83 offen sc0 sc1
    s_and_b32 s83, s81, 3
    s_lshl_b32 s83, s83, 3
    s_add_u32 s83, s83, 3
    s_lshr_b32 s84, s83, 2
    s_and_b32 s83, s83, 3
    s_mul_i32 s87, s82, 4
    s_mul_i32 s88, s82, 5
    s_add_u32 s88, s88, 72
    s_cmp_lt_u32 s81, 4
    s_cselect_b32 s87, s87, s88
    s_add_u32 s83, s83, s87
    s_mul_i32 s87, s82, 5
    s_add_u32 s87, s87, 76
    s_cmp_eq_u32 s81, 8
    s_cselect_b32 s84, 3, s84
    s_cselect_b32 s83, s87, s83
    s_mul_i32 s85, s84, 234
    s_add_u32 s85, s85, 72
    s_cmp_lt_u32 s84, 4
    s_mul_i32 s84, s84, 252
    s_cselect_b32 s85, s84, s85
    s_add_u32 s83, s83, s85
    s_lshl_b32 s83, s83, 10
    s_add_u32 s83, s83, s86
    buffer_store_dwordx4 v[60:63], v2, s[36:39], s83 offen sc0 sc1
    s_and_b32 s83, s81, 3
    s_lshl_b32 s83, s83, 3
    s_add_u32 s83, s83, 4
    s_lshr_b32 s84, s83, 2
    s_and_b32 s83, s83, 3
    s_mul_i32 s87, s82, 4
    s_mul_i32 s88, s82, 5
    s_add_u32 s88, s88, 72
    s_cmp_lt_u32 s81, 4
    s_cselect_b32 s87, s87, s88
    s_add_u32 s83, s83, s87
    s_mul_i32 s87, s82, 5
    s_add_u32 s87, s87, 76
    s_cmp_eq_u32 s81, 8
    s_cselect_b32 s84, 4, s84
    s_cselect_b32 s83, s87, s83
    s_mul_i32 s85, s84, 234
    s_add_u32 s85, s85, 72
    s_cmp_lt_u32 s84, 4
    s_mul_i32 s84, s84, 252
    s_cselect_b32 s85, s84, s85
    s_add_u32 s83, s83, s85
    s_lshl_b32 s83, s83, 10
    s_add_u32 s83, s83, s86
    buffer_store_dwordx4 v[64:67], v2, s[36:39], s83 offen sc0 sc1
    s_and_b32 s83, s81, 3
    s_lshl_b32 s83, s83, 3
    s_add_u32 s83, s83, 5
    s_lshr_b32 s84, s83, 2
    s_and_b32 s83, s83, 3
    s_mul_i32 s87, s82, 4
    s_mul_i32 s88, s82, 5
    s_add_u32 s88, s88, 72
    s_cmp_lt_u32 s81, 4
    s_cselect_b32 s87, s87, s88
    s_add_u32 s83, s83, s87
    s_mul_i32 s87, s82, 5
    s_add_u32 s87, s87, 76
    s_cmp_eq_u32 s81, 8
    s_cselect_b32 s84, 5, s84
    s_cselect_b32 s83, s87, s83
    s_mul_i32 s85, s84, 234
    s_add_u32 s85, s85, 72
    s_cmp_lt_u32 s84, 4
    s_mul_i32 s84, s84, 252
    s_cselect_b32 s85, s84, s85
    s_add_u32 s83, s83, s85
    s_lshl_b32 s83, s83, 10
    s_add_u32 s83, s83, s86
    buffer_store_dwordx4 v[68:71], v2, s[36:39], s83 offen sc0 sc1
    s_and_b32 s83, s81, 3
    s_lshl_b32 s83, s83, 3
    s_add_u32 s83, s83, 6
    s_lshr_b32 s84, s83, 2
    s_and_b32 s83, s83, 3
    s_mul_i32 s87, s82, 4
    s_mul_i32 s88, s82, 5
    s_add_u32 s88, s88, 72
    s_cmp_lt_u32 s81, 4
    s_cselect_b32 s87, s87, s88
    s_add_u32 s83, s83, s87
    s_mul_i32 s87, s82, 5
    s_add_u32 s87, s87, 76
    s_cmp_eq_u32 s81, 8
    s_cselect_b32 s84, 6, s84
    s_cselect_b32 s83, s87, s83
    s_mul_i32 s85, s84, 234
    s_add_u32 s85, s85, 72
    s_cmp_lt_u32 s84, 4
    s_mul_i32 s84, s84, 252
    s_cselect_b32 s85, s84, s85
    s_add_u32 s83, s83, s85
    s_lshl_b32 s83, s83, 10
    s_add_u32 s83, s83, s86
    buffer_store_dwordx4 v[72:75], v2, s[36:39], s83 offen sc0 sc1
    s_and_b32 s83, s81, 3
    s_lshl_b32 s83, s83, 3
    s_add_u32 s83, s83, 7
    s_lshr_b32 s84, s83, 2
    s_and_b32 s83, s83, 3
    s_mul_i32 s87, s82, 4
    s_mul_i32 s88, s82, 5
    s_add_u32 s88, s88, 72
    s_cmp_lt_u32 s81, 4
    s_cselect_b32 s87, s87, s88
    s_add_u32 s83, s83, s87
    s_mul_i32 s87, s82, 5
    s_add_u32 s87, s87, 76
    s_cmp_eq_u32 s81, 8
    s_cselect_b32 s84, 7, s84
    s_cselect_b32 s83, s87, s83
    s_mul_i32 s85, s84, 234
    s_add_u32 s85, s85, 72
    s_cmp_lt_u32 s84, 4
    s_mul_i32 s84, s84, 252
    s_cselect_b32 s85, s84, s85
    s_add_u32 s83, s83, s85
    s_lshl_b32 s83, s83, 10
    s_add_u32 s83, s83, s86
    buffer_store_dwordx4 v[76:79], v2, s[36:39], s83 offen sc0 sc1
    s_branch pk1_end
pk1_w2:
    s_sub_u32 s47, s56, 1296
    s_mul_hi_u32 s46, s47, 0x1948b10
    s_mul_i32 s48, s46, 162
    s_sub_u32 s47, s47, s48
    s_mov_b32 s40, s18
    s_mov_b32 s41, s19
    s_mov_b32 s42, 0x510000
    s_mov_b32 s43, 0x20000
    s_mul_hi_u32 s85, s47, 0x1c71c71d
    s_mul_i32 s87, s85, 9
    s_sub_u32 s84, s47, s87
    v_lshrrev_b32 v72, 4, v1
    s_lshl_b32 s86, s85, 2
    v_add_u32 v72, s86, v72
    v_mul_u32_u24 v73, 57, v72
    v_lshrrev_b32 v73, 9, v73
    v_mul_u32_u24 v74, 9, v73
    v_sub_u32 v72, v72, v74
    v_lshlrev_b32 v74, 2, v73
    v_cmp_gt_u32 vcc, 4, v72
    v_mov_b32 v76, 256
    v_mov_b32 v75, 512
    v_cndmask_b32 v76, v76, 0, vcc
    v_cmp_eq_u32 s[44:45], 8, v72
    v_add_u32 v75, v75, v73
    v_and_b32 v72, 3, v72
    v_lshlrev_b32 v72, 4, v72
    v_add_u32 v76, v76, v72
    s_mul_i32 s86, s46, 663552
    s_lshl_b32 s87, s84, 7
    s_add_u32 s86, s86, s87
    v_and_b32 v77, 15, v1
    v_lshlrev_b32 v77, 3, v77
    v_add_u32 v77, s86, v77
    s_movk_i32 s88, 1152
    v_add_u32 v73, 0, v74
    v_lshrrev_b32 v64, 3, v73
    v_lshlrev_b32 v64, 6, v64
    v_and_b32 v73, 7, v73
    v_add3_u32 v64, v64, v73, v76
    v_add_u32 v73, 0, v75
    v_cndmask_b32 v64, v64, v73, s[44:45]
    v_add_u32 v65, 8, v64
    v_mad_u32_u24 v64, v64, s88, v77
    buffer_load_dwordx2 v[16:17], v64, s[40:43], 0 offen nt
    v_mad_u32_u24 v65, v65, s88, v77
    buffer_load_dwordx2 v[18:19], v65, s[40:43], 0 offen nt
    v_add_u32 v73, 1, v74
    v_lshrrev_b32 v66, 3, v73
    v_lshlrev_b32 v66, 6, v66
    v_and_b32 v73, 7, v73
    v_add3_u32 v66, v66, v73, v76
    v_add_u32 v73, 16, v75
    v_cndmask_b32 v66, v66, v73, s[44:45]
    v_add_u32 v67, 8, v66
    v_mad_u32_u24 v66, v66, s88, v77
    buffer_load_dwordx2 v[20:21], v66, s[40:43], 0 offen nt
    v_mad_u32_u24 v67, v67, s88, v77
    buffer_load_dwordx2 v[22:23], v67, s[40:43], 0 offen nt
    v_add_u32 v73, 2, v74
    v_lshrrev_b32 v68, 3, v73
    v_lshlrev_b32 v68, 6, v68
    v_and_b32 v73, 7, v73
    v_add3_u32 v68, v68, v73, v76
    v_add_u32 v73, 32, v75
    v_cndmask_b32 v68, v68, v73, s[44:45]
    v_add_u32 v69, 8, v68
    v_mad_u32_u24 v68, v68, s88, v77
    buffer_load_dwordx2 v[24:25], v68, s[40:43], 0 offen nt
    v_mad_u32_u24 v69, v69, s88, v77
    buffer_load_dwordx2 v[26:27], v69, s[40:43], 0 offen nt
    v_add_u32 v73, 3, v74
    v_lshrrev_b32 v70, 3, v73
    v_lshlrev_b32 v70, 6, v70
    v_and_b32 v73, 7, v73
    v_add3_u32 v70, v70, v73, v76
    v_add_u32 v73, 48, v75
    v_cndmask_b32 v70, v70, v73, s[44:45]
    v_add_u32 v71, 8, v70
    v_mad_u32_u24 v70, v70, s88, v77
    buffer_load_dwordx2 v[28:29], v70, s[40:43], 0 offen nt
    v_mad_u32_u24 v71, v71, s88, v77
    buffer_load_dwordx2 v[30:31], v71, s[40:43], 0 offen nt
    s_waitcnt vmcnt(0)
    s_add_u32 s40, s24, 0x0
    s_addc_u32 s41, s25, 0
    s_mov_b32 s42, 0xf30000
    s_mov_b32 s43, 0x20000
    s_mul_hi_u32 s82, s47, 0x1c71c71d
    s_mul_i32 s84, s82, 9
    s_sub_u32 s81, s47, s84
    s_mov_b32 s90, 0x05040100
    s_mov_b32 s91, 0x07060302
    s_mul_i32 s86, s46, 1990656
    v_perm_b32 v32, v18, v16, s90
    v_perm_b32 v33, v22, v20, s90
    v_perm_b32 v34, v26, v24, s90
    v_perm_b32 v35, v30, v28, s90
    v_perm_b32 v36, v18, v16, s91
    v_perm_b32 v37, v22, v20, s91
    v_perm_b32 v38, v26, v24, s91
    v_perm_b32 v39, v30, v28, s91
    v_perm_b32 v40, v19, v17, s90
    v_perm_b32 v41, v23, v21, s90
    v_perm_b32 v42, v27, v25, s90
    v_perm_b32 v43, v31, v29, s90
    v_perm_b32 v44, v19, v17, s91
    v_perm_b32 v45, v23, v21, s91
    v_perm_b32 v46, v27, v25, s91
    v_perm_b32 v47, v31, v29, s91
    s_cmp_lt_u32 s81, 8
    s_cselect_b32 s84, s81, 0
    s_cselect_b32 s83, 0, 4
    s_mul_i32 s85, s84, 234
    s_add_u32 s85, s85, 72
    s_cmp_lt_u32 s84, 4
    s_mul_i32 s84, s84, 252
    s_cselect_b32 s85, s84, s85
    s_cselect_b32 s84, 3, 2
    s_mul_i32 s87, s84, s82
    s_lshl_b32 s88, s82, 1
    s_mul_i32 s89, s84, 9
    s_add_u32 s89, s89, s88
    s_cmp_lt_u32 s82, 9
    s_cselect_b32 s88, s88, s89
    s_add_u32 s88, s88, 162
    s_add_u32 s89, s87, 36
    s_add_u32 s87, s87, 18
    s_cmp_lt_u32 s82, 9
    s_cselect_b32 s87, s87, s89
    s_add_u32 s87, s87, 160
    s_cmp_lt_u32 s83, 2
    s_cselect_b32 s84, s88, s87
    s_add_u32 s84, s84, s83
    s_add_u32 s84, s84, s85
    s_lshl_b32 s84, s84, 10
    s_add_u32 s84, s84, s86
    buffer_store_dwordx4 v[32:35], v2, s[40:43], s84 offen sc0 sc1
    s_cmp_lt_u32 s81, 8
    s_cselect_b32 s84, s81, 1
    s_cselect_b32 s83, 1, 4
    s_mul_i32 s85, s84, 234
    s_add_u32 s85, s85, 72
    s_cmp_lt_u32 s84, 4
    s_mul_i32 s84, s84, 252
    s_cselect_b32 s85, s84, s85
    s_cselect_b32 s84, 3, 2
    s_mul_i32 s87, s84, s82
    s_lshl_b32 s88, s82, 1
    s_mul_i32 s89, s84, 9
    s_add_u32 s89, s89, s88
    s_cmp_lt_u32 s82, 9
    s_cselect_b32 s88, s88, s89
    s_add_u32 s88, s88, 162
    s_add_u32 s89, s87, 36
    s_add_u32 s87, s87, 18
    s_cmp_lt_u32 s82, 9
    s_cselect_b32 s87, s87, s89
    s_add_u32 s87, s87, 160
    s_cmp_lt_u32 s83, 2
    s_cselect_b32 s84, s88, s87
    s_add_u32 s84, s84, s83
    s_add_u32 s84, s84, s85
    s_lshl_b32 s84, s84, 10
    s_add_u32 s84, s84, s86
    buffer_store_dwordx4 v[36:39], v2, s[40:43], s84 offen sc0 sc1
    s_cmp_lt_u32 s81, 8
    s_cselect_b32 s84, s81, 2
    s_cselect_b32 s83, 2, 4
    s_mul_i32 s85, s84, 234
    s_add_u32 s85, s85, 72
    s_cmp_lt_u32 s84, 4
    s_mul_i32 s84, s84, 252
    s_cselect_b32 s85, s84, s85
    s_cselect_b32 s84, 3, 2
    s_mul_i32 s87, s84, s82
    s_lshl_b32 s88, s82, 1
    s_mul_i32 s89, s84, 9
    s_add_u32 s89, s89, s88
    s_cmp_lt_u32 s82, 9
    s_cselect_b32 s88, s88, s89
    s_add_u32 s88, s88, 162
    s_add_u32 s89, s87, 36
    s_add_u32 s87, s87, 18
    s_cmp_lt_u32 s82, 9
    s_cselect_b32 s87, s87, s89
    s_add_u32 s87, s87, 160
    s_cmp_lt_u32 s83, 2
    s_cselect_b32 s84, s88, s87
    s_add_u32 s84, s84, s83
    s_add_u32 s84, s84, s85
    s_lshl_b32 s84, s84, 10
    s_add_u32 s84, s84, s86
    buffer_store_dwordx4 v[40:43], v2, s[40:43], s84 offen sc0 sc1
    s_cmp_lt_u32 s81, 8
    s_cselect_b32 s84, s81, 3
    s_cselect_b32 s83, 3, 4
    s_mul_i32 s85, s84, 234
    s_add_u32 s85, s85, 72
    s_cmp_lt_u32 s84, 4
    s_mul_i32 s84, s84, 252
    s_cselect_b32 s85, s84, s85
    s_cselect_b32 s84, 3, 2
    s_mul_i32 s87, s84, s82
    s_lshl_b32 s88, s82, 1
    s_mul_i32 s89, s84, 9
    s_add_u32 s89, s89, s88
    s_cmp_lt_u32 s82, 9
    s_cselect_b32 s88, s88, s89
    s_add_u32 s88, s88, 162
    s_add_u32 s89, s87, 36
    s_add_u32 s87, s87, 18
    s_cmp_lt_u32 s82, 9
    s_cselect_b32 s87, s87, s89
    s_add_u32 s87, s87, 160
    s_cmp_lt_u32 s83, 2
    s_cselect_b32 s84, s88, s87
    s_add_u32 s84, s84, s83
    s_add_u32 s84, s84, s85
    s_lshl_b32 s84, s84, 10
    s_add_u32 s84, s84, s86
    buffer_store_dwordx4 v[44:47], v2, s[40:43], s84 offen sc0 sc1
pk1_end:
p0_drain:
    s_branch b0_join
p0_w0:
    s_cmp_lt_u32 s2, 24
    s_cselect_b32 s59, 5, 4
p0_cw:
    ds_read_b32 v15, v4
    s_waitcnt lgkmcnt(0)
    v_readfirstlane_b32 s58, v15
    s_cmp_ge_u32 s58, s59
    s_cbranch_scc1 p0_cw_ok
    s_cmp_eq_u32 s28, 0
    s_cbranch_scc1 p0_cw_ok
    s_sub_u32 s28, s28, 1
    s_sleep 1
    s_branch p0_cw
p0_cw_ok:
    s_waitcnt lgkmcnt(0)
    s_mul_i32 s27, s27, 1664525
    s_add_u32 s27, s27, 1013904223
    s_add_u32 s32, s24, 0x3400000
    s_addc_u32 s33, s25, 0
    s_mov_b32 s34, 0x8000
    s_mov_b32 s35, 0x20000
    s_lshl_b32 s29, s2, 7
    v_mov_b32 v4, s27
    v_mov_b32 v5, 0
    s_mov_b64 exec, 1
    buffer_store_dword v4, v5, s[32:35], s29 offen sc0 sc1
    s_mov_b64 exec, -1
    s_add_u32 s32, s24, 0x3400000
    s_addc_u32 s33, s25, 0
    s_mov_b32 s34, 0x8000
    s_mov_b32 s35, 0x20000
    v_lshlrev_b32 v4, 7, v1
    v_add_u32 v5, 8192, v4
    v_add_u32 v6, 16384, v4
    v_add_u32 v7, 24576, v4
b0_p:
    buffer_load_dword v8, v4, s[32:35], 0 offen sc0 sc1
    buffer_load_dword v9, v5, s[32:35], 0 offen sc0 sc1
    buffer_load_dword v10, v6, s[32:35], 0 offen sc0 sc1
    buffer_load_dword v11, v7, s[32:35], 0 offen sc0 sc1
    s_waitcnt vmcnt(0)
    v_xor_b32 v8, s27, v8
    v_xor_b32 v9, s27, v9
    v_xor_b32 v10, s27, v10
    v_xor_b32 v11, s27, v11
    v_or_b32 v8, v8, v9
    v_or3_b32 v8, v8, v10, v11
    v_cmp_ne_u32 vcc, 0, v8
    s_cbranch_vccz b0_p_x
    s_cmp_eq_u32 s28, 0
    s_cbranch_scc1 b0_p_x
    s_sub_u32 s28, s28, 1
    s_branch b0_p
b0_p_x:
b0_join:
    s_barrier
    s_and_b32 s53, s2, 7
    s_lshr_b32 s54, s2, 3
    s_and_b32 s51, s53, 3
    s_lshl_b32 s51, s51, 1
    s_and_b32 s55, s54, 1
    s_add_u32 s51, s51, s55
    s_lshr_b32 s52, s53, 2
    s_lshl_b32 s52, s52, 4
    s_lshr_b32 s55, s54, 1
    s_add_u32 s52, s52, s55
    s_mul_i32 s53, s52, 73728
    s_add_u32 s53, s53, 42991616
    s_add_u32 s36, s24, s53
    s_addc_u32 s37, s25, 0
    s_mov_b32 s38, 0x12000
    s_mov_b32 s39, 0x20000
    s_add_u32 s40, s24, 0x2600000
    s_addc_u32 s41, s25, 0
    s_mov_b32 s42, 0x240000
    s_mov_b32 s43, 0x20000
    s_mul_i32 s54, s26, 9216
    s_add_u32 s55, s54, 0
    s_mov_b32 m0, s55
    s_nop 0
    buffer_load_dwordx4 v2, s[36:39], s55 offen offset:0 lds
    buffer_load_dwordx4 v2, s[36:39], s55 offen offset:1024 lds
    buffer_load_dwordx4 v2, s[36:39], s55 offen offset:2048 lds
    buffer_load_dwordx4 v2, s[36:39], s55 offen offset:3072 lds
    s_add_u32 s55, s54, 4096
    s_mov_b32 m0, s55
    s_nop 0
    buffer_load_dwordx4 v2, s[36:39], s55 offen offset:0 lds
    buffer_load_dwordx4 v2, s[36:39], s55 offen offset:1024 lds
    buffer_load_dwordx4 v2, s[36:39], s55 offen offset:2048 lds
    buffer_load_dwordx4 v2, s[36:39], s55 offen offset:3072 lds
    s_add_u32 s55, s54, 8192
    s_mov_b32 m0, s55
    s_nop 0
    buffer_load_dwordx4 v2, s[36:39], s55 offen offset:0 lds
    s_barrier
    s_lshl_b32 s56, s51, 3
    s_add_u32 s56, s56, s26
    s_mul_i32 s57, s56, 36864
    buffer_load_dwordx4 v[16:19], v2, s[40:43], s57 offen offset:0
    buffer_load_dwordx4 v[20:23], v2, s[40:43], s57 offen offset:1024
    buffer_load_dwordx4 v[24:27], v2, s[40:43], s57 offen offset:2048
    buffer_load_dwordx4 v[28:31], v2, s[40:43], s57 offen offset:3072
    s_add_u32 s57, s57, 4096
    buffer_load_dwordx4 v[32:35], v2, s[40:43], s57 offen offset:0
    buffer_load_dwordx4 v[36:39], v2, s[40:43], s57 offen offset:1024
    buffer_load_dwordx4 v[40:43], v2, s[40:43], s57 offen offset:2048
    buffer_load_dwordx4 v[44:47], v2, s[40:43], s57 offen offset:3072
    s_add_u32 s57, s57, 4096
    buffer_load_dwordx4 v[48:51], v2, s[40:43], s57 offen offset:0
    buffer_load_dwordx4 v[52:55], v2, s[40:43], s57 offen offset:1024
    buffer_load_dwordx4 v[56:59], v2, s[40:43], s57 offen offset:2048
    buffer_load_dwordx4 v[60:63], v2, s[40:43], s57 offen offset:3072
    s_mov_b32 s58, 0x3fb8aa3b
    v_add_u32 v14, 0x10000, v2
    s_waitcnt vmcnt(12)
    s_barrier
    ds_read_b128 v[192:195], v2 offset:0
    ds_read_b128 v[196:199], v2 offset:1024
    ds_read_b128 v[200:203], v2 offset:2048
    ds_read_b128 v[204:207], v2 offset:3072
    s_waitcnt vmcnt(11) lgkmcnt(2)
    v_mfma_f32_32x32x16_bf16 v[160:175], v[192:195], v[16:19], 0
    v_mfma_f32_32x32x16_bf16 v[176:191], v[196:199], v[16:19], 0
    s_add_u32 s57, s57, 4096
    buffer_load_dwordx4 v[16:19], v2, s[40:43], s57 offen offset:0
    ds_read_b128 v[192:195], v2 offset:4096
    ds_read_b128 v[196:199], v2 offset:5120
    s_waitcnt vmcnt(11) lgkmcnt(2)
    v_mfma_f32_32x32x16_bf16 v[160:175], v[200:203], v[20:23], v[160:175]
    v_mfma_f32_32x32x16_bf16 v[176:191], v[204:207], v[20:23], v[176:191]
    buffer_load_dwordx4 v[20:23], v2, s[40:43], s57 offen offset:1024
    ds_read_b128 v[200:203], v2 offset:6144
    ds_read_b128 v[204:207], v2 offset:7168
    s_waitcnt vmcnt(11) lgkmcnt(2)
    v_mfma_f32_32x32x16_bf16 v[160:175], v[192:195], v[24:27], v[160:175]
    v_mfma_f32_32x32x16_bf16 v[176:191], v[196:199], v[24:27], v[176:191]
    buffer_load_dwordx4 v[24:27], v2, s[40:43], s57 offen offset:2048
    ds_read_b128 v[192:195], v2 offset:8192
    ds_read_b128 v[196:199], v2 offset:9216
    s_waitcnt vmcnt(11) lgkmcnt(2)
    v_mfma_f32_32x32x16_bf16 v[160:175], v[200:203], v[28:31], v[160:175]
    v_mfma_f32_32x32x16_bf16 v[176:191], v[204:207], v[28:31], v[176:191]
    buffer_load_dwordx4 v[28:31], v2, s[40:43], s57 offen offset:3072
    ds_read_b128 v[200:203], v2 offset:10240
    ds_read_b128 v[204:207], v2 offset:11264
    s_waitcnt vmcnt(11) lgkmcnt(2)
    v_mfma_f32_32x32x16_bf16 v[160:175], v[192:195], v[32:35], v[160:175]
    v_mfma_f32_32x32x16_bf16 v[176:191], v[196:199], v[32:35], v[176:191]
    s_add_u32 s57, s57, 4096
    buffer_load_dwordx4 v[32:35], v2, s[40:43], s57 offen offset:0
    ds_read_b128 v[192:195], v2 offset:12288
    ds_read_b128 v[196:199], v2 offset:13312
    s_waitcnt vmcnt(11) lgkmcnt(2)
    v_mfma_f32_32x32x16_bf16 v[160:175], v[200:203], v[36:39], v[160:175]
    v_mfma_f32_32x32x16_bf16 v[176:191], v[204:207], v[36:39], v[176:191]
    buffer_load_dwordx4 v[36:39], v2, s[40:43], s57 offen offset:1024
    ds_read_b128 v[200:203], v2 offset:14336
    ds_read_b128 v[204:207], v2 offset:15360
    s_waitcnt vmcnt(11) lgkmcnt(2)
    v_mfma_f32_32x32x16_bf16 v[160:175], v[192:195], v[40:43], v[160:175]
    v_mfma_f32_32x32x16_bf16 v[176:191], v[196:199], v[40:43], v[176:191]
    buffer_load_dwordx4 v[40:43], v2, s[40:43], s57 offen offset:2048
    ds_read_b128 v[192:195], v2 offset:16384
    ds_read_b128 v[196:199], v2 offset:17408
    s_waitcnt vmcnt(11) lgkmcnt(2)
    v_mfma_f32_32x32x16_bf16 v[160:175], v[200:203], v[44:47], v[160:175]
    v_mfma_f32_32x32x16_bf16 v[176:191], v[204:207], v[44:47], v[176:191]
    buffer_load_dwordx4 v[44:47], v2, s[40:43], s57 offen offset:3072
    ds_read_b128 v[200:203], v2 offset:18432
    ds_read_b128 v[204:207], v2 offset:19456
    s_waitcnt vmcnt(11) lgkmcnt(2)
    v_mfma_f32_32x32x16_bf16 v[160:175], v[192:195], v[48:51], v[160:175]
    v_mfma_f32_32x32x16_bf16 v[176:191], v[196:199], v[48:51], v[176:191]
    s_add_u32 s57, s57, 4096
    buffer_load_dwordx4 v[48:51], v2, s[40:43], s57 offen offset:0
    ds_read_b128 v[192:195], v2 offset:20480
    ds_read_b128 v[196:199], v2 offset:21504
    s_waitcnt vmcnt(11) lgkmcnt(2)
    v_mfma_f32_32x32x16_bf16 v[160:175], v[200:203], v[52:55], v[160:175]
    v_mfma_f32_32x32x16_bf16 v[176:191], v[204:207], v[52:55], v[176:191]
    buffer_load_dwordx4 v[52:55], v2, s[40:43], s57 offen offset:1024
    ds_read_b128 v[200:203], v2 offset:22528
    ds_read_b128 v[204:207], v2 offset:23552
    s_waitcnt vmcnt(11) lgkmcnt(2)
    v_mfma_f32_32x32x16_bf16 v[160:175], v[192:195], v[56:59], v[160:175]
    v_mfma_f32_32x32x16_bf16 v[176:191], v[196:199], v[56:59], v[176:191]
    buffer_load_dwordx4 v[56:59], v2, s[40:43], s57 offen offset:2048
    ds_read_b128 v[192:195], v2 offset:24576
    ds_read_b128 v[196:199], v2 offset:25600
    s_waitcnt vmcnt(11) lgkmcnt(2)
    v_mfma_f32_32x32x16_bf16 v[160:175], v[200:203], v[60:63], v[160:175]
    v_mfma_f32_32x32x16_bf16 v[176:191], v[204:207], v[60:63], v[176:191]
    buffer_load_dwordx4 v[60:63], v2, s[40:43], s57 offen offset:3072
    ds_read_b128 v[200:203], v2 offset:26624
    ds_read_b128 v[204:207], v2 offset:27648
    s_waitcnt vmcnt(11) lgkmcnt(2)
    v_mfma_f32_32x32x16_bf16 v[160:175], v[192:195], v[16:19], v[160:175]
    v_mfma_f32_32x32x16_bf16 v[176:191], v[196:199], v[16:19], v[176:191]
    s_add_u32 s57, s57, 4096
    buffer_load_dwordx4 v[16:19], v2, s[40:43], s57 offen offset:0
    ds_read_b128 v[192:195], v2 offset:28672
    ds_read_b128 v[196:199], v2 offset:29696
    s_waitcnt vmcnt(11) lgkmcnt(2)
    v_mfma_f32_32x32x16_bf16 v[160:175], v[200:203], v[20:23], v[160:175]
    v_mfma_f32_32x32x16_bf16 v[176:191], v[204:207], v[20:23], v[176:191]
    buffer_load_dwordx4 v[20:23], v2, s[40:43], s57 offen offset:1024
    ds_read_b128 v[200:203], v2 offset:30720
    ds_read_b128 v[204:207], v2 offset:31744
    s_waitcnt vmcnt(11) lgkmcnt(2)
    v_mfma_f32_32x32x16_bf16 v[160:175], v[192:195], v[24:27], v[160:175]
    v_mfma_f32_32x32x16_bf16 v[176:191], v[196:199], v[24:27], v[176:191]
    buffer_load_dwordx4 v[24:27], v2, s[40:43], s57 offen offset:2048
    ds_read_b128 v[192:195], v2 offset:32768
    ds_read_b128 v[196:199], v2 offset:33792
    s_waitcnt vmcnt(11) lgkmcnt(2)
    v_mfma_f32_32x32x16_bf16 v[160:175], v[200:203], v[28:31], v[160:175]
    v_mfma_f32_32x32x16_bf16 v[176:191], v[204:207], v[28:31], v[176:191]
    buffer_load_dwordx4 v[28:31], v2, s[40:43], s57 offen offset:3072
    ds_read_b128 v[200:203], v2 offset:34816
    ds_read_b128 v[204:207], v2 offset:35840
    s_waitcnt vmcnt(11) lgkmcnt(2)
    v_mfma_f32_32x32x16_bf16 v[160:175], v[192:195], v[32:35], v[160:175]
    v_mfma_f32_32x32x16_bf16 v[176:191], v[196:199], v[32:35], v[176:191]
    s_add_u32 s57, s57, 4096
    buffer_load_dwordx4 v[32:35], v2, s[40:43], s57 offen offset:0
    ds_read_b128 v[192:195], v2 offset:36864
    ds_read_b128 v[196:199], v2 offset:37888
    s_waitcnt vmcnt(11) lgkmcnt(2)
    v_mfma_f32_32x32x16_bf16 v[160:175], v[200:203], v[36:39], v[160:175]
    v_mfma_f32_32x32x16_bf16 v[176:191], v[204:207], v[36:39], v[176:191]
    buffer_load_dwordx4 v[36:39], v2, s[40:43], s57 offen offset:1024
    ds_read_b128 v[200:203], v2 offset:38912
    ds_read_b128 v[204:207], v2 offset:39936
    s_waitcnt vmcnt(11) lgkmcnt(2)
    v_mfma_f32_32x32x16_bf16 v[160:175], v[192:195], v[40:43], v[160:175]
    v_mfma_f32_32x32x16_bf16 v[176:191], v[196:199], v[40:43], v[176:191]
    buffer_load_dwordx4 v[40:43], v2, s[40:43], s57 offen offset:2048
    ds_read_b128 v[192:195], v2 offset:40960
    ds_read_b128 v[196:199], v2 offset:41984
    s_waitcnt vmcnt(11) lgkmcnt(2)
    v_mfma_f32_32x32x16_bf16 v[160:175], v[200:203], v[44:47], v[160:175]
    v_mfma_f32_32x32x16_bf16 v[176:191], v[204:207], v[44:47], v[176:191]
    buffer_load_dwordx4 v[44:47], v2, s[40:43], s57 offen offset:3072
    ds_read_b128 v[200:203], v2 offset:43008
    ds_read_b128 v[204:207], v2 offset:44032
    s_waitcnt vmcnt(11) lgkmcnt(2)
    v_mfma_f32_32x32x16_bf16 v[160:175], v[192:195], v[48:51], v[160:175]
    v_mfma_f32_32x32x16_bf16 v[176:191], v[196:199], v[48:51], v[176:191]
    s_add_u32 s57, s57, 4096
    buffer_load_dwordx4 v[48:51], v2, s[40:43], s57 offen offset:0
    ds_read_b128 v[192:195], v2 offset:45056
    ds_read_b128 v[196:199], v2 offset:46080
    s_waitcnt vmcnt(11) lgkmcnt(2)
    v_mfma_f32_32x32x16_bf16 v[160:175], v[200:203], v[52:55], v[160:175]
    v_mfma_f32_32x32x16_bf16 v[176:191], v[204:207], v[52:55], v[176:191]
    buffer_load_dwordx4 v[52:55], v2, s[40:43], s57 offen offset:1024
    ds_read_b128 v[200:203], v2 offset:47104
    ds_read_b128 v[204:207], v2 offset:48128
    s_waitcnt vmcnt(11) lgkmcnt(2)
    v_mfma_f32_32x32x16_bf16 v[160:175], v[192:195], v[56:59], v[160:175]
    v_mfma_f32_32x32x16_bf16 v[176:191], v[196:199], v[56:59], v[176:191]
    buffer_load_dwordx4 v[56:59], v2, s[40:43], s57 offen offset:2048
    ds_read_b128 v[192:195], v2 offset:49152
    ds_read_b128 v[196:199], v2 offset:50176
    s_waitcnt vmcnt(11) lgkmcnt(2)
    v_mfma_f32_32x32x16_bf16 v[160:175], v[200:203], v[60:63], v[160:175]
    v_mfma_f32_32x32x16_bf16 v[176:191], v[204:207], v[60:63], v[176:191]
    buffer_load_dwordx4 v[60:63], v2, s[40:43], s57 offen offset:3072
    ds_read_b128 v[200:203], v2 offset:51200
    ds_read_b128 v[204:207], v2 offset:52224
    s_waitcnt vmcnt(11) lgkmcnt(2)
    v_mfma_f32_32x32x16_bf16 v[160:175], v[192:195], v[16:19], v[160:175]
    v_mfma_f32_32x32x16_bf16 v[176:191], v[196:199], v[16:19], v[176:191]
    ds_read_b128 v[192:195], v2 offset:53248
    ds_read_b128 v[196:199], v2 offset:54272
    s_waitcnt vmcnt(10) lgkmcnt(2)
    v_mfma_f32_32x32x16_bf16 v[160:175], v[200:203], v[20:23], v[160:175]
    v_mfma_f32_32x32x16_bf16 v[176:191], v[204:207], v[20:23], v[176:191]
    ds_read_b128 v[200:203], v2 offset:55296
    ds_read_b128 v[204:207], v2 offset:56320
    s_waitcnt vmcnt(9) lgkmcnt(2)
    v_mfma_f32_32x32x16_bf16 v[160:175], v[192:195], v[24:27], v[160:175]
    v_mfma_f32_32x32x16_bf16 v[176:191], v[196:199], v[24:27], v[176:191]
    ds_read_b128 v[192:195], v2 offset:57344
    ds_read_b128 v[196:199], v2 offset:58368
    s_waitcnt vmcnt(8) lgkmcnt(2)
    v_mfma_f32_32x32x16_bf16 v[160:175], v[200:203], v[28:31], v[160:175]
    v_mfma_f32_32x32x16_bf16 v[176:191], v[204:207], v[28:31], v[176:191]
    ds_read_b128 v[200:203], v2 offset:59392
    ds_read_b128 v[204:207], v2 offset:60416
    s_waitcnt vmcnt(7) lgkmcnt(2)
    v_mfma_f32_32x32x16_bf16 v[160:175], v[192:195], v[32:35], v[160:175]
    v_mfma_f32_32x32x16_bf16 v[176:191], v[196:199], v[32:35], v[176:191]
    ds_read_b128 v[192:195], v2 offset:61440
    ds_read_b128 v[196:199], v2 offset:62464
    s_waitcnt vmcnt(6) lgkmcnt(2)
    v_mfma_f32_32x32x16_bf16 v[160:175], v[200:203], v[36:39], v[160:175]
    v_mfma_f32_32x32x16_bf16 v[176:191], v[204:207], v[36:39], v[176:191]
    ds_read_b128 v[200:203], v2 offset:63488
    ds_read_b128 v[204:207], v2 offset:64512
    s_waitcnt vmcnt(5) lgkmcnt(2)
    v_mfma_f32_32x32x16_bf16 v[160:175], v[192:195], v[40:43], v[160:175]
    v_mfma_f32_32x32x16_bf16 v[176:191], v[196:199], v[40:43], v[176:191]
    ds_read_b128 v[192:195], v14 offset:0
    ds_read_b128 v[196:199], v14 offset:1024
    s_waitcnt vmcnt(4) lgkmcnt(2)
    v_mfma_f32_32x32x16_bf16 v[160:175], v[200:203], v[44:47], v[160:175]
    v_mfma_f32_32x32x16_bf16 v[176:191], v[204:207], v[44:47], v[176:191]
    ds_read_b128 v[200:203], v14 offset:2048
    ds_read_b128 v[204:207], v14 offset:3072
    s_waitcnt vmcnt(3) lgkmcnt(2)
    v_mfma_f32_32x32x16_bf16 v[160:175], v[192:195], v[48:51], v[160:175]
    v_mfma_f32_32x32x16_bf16 v[176:191], v[196:199], v[48:51], v[176:191]
    ds_read_b128 v[192:195], v14 offset:4096
    ds_read_b128 v[196:199], v14 offset:5120
    s_waitcnt vmcnt(2) lgkmcnt(2)
    v_mfma_f32_32x32x16_bf16 v[160:175], v[200:203], v[52:55], v[160:175]
    v_mfma_f32_32x32x16_bf16 v[176:191], v[204:207], v[52:55], v[176:191]
    ds_read_b128 v[200:203], v14 offset:6144
    ds_read_b128 v[204:207], v14 offset:7168
    s_waitcnt vmcnt(1) lgkmcnt(2)
    v_mfma_f32_32x32x16_bf16 v[160:175], v[192:195], v[56:59], v[160:175]
    v_mfma_f32_32x32x16_bf16 v[176:191], v[196:199], v[56:59], v[176:191]
    s_waitcnt vmcnt(0) lgkmcnt(0)
    v_mfma_f32_32x32x16_bf16 v[160:175], v[200:203], v[60:63], v[160:175]
    v_mfma_f32_32x32x16_bf16 v[176:191], v[204:207], v[60:63], v[176:191]
    s_add_u32 s44, s24, 0x2e00000
    s_addc_u32 s45, s25, 0
    s_mov_b32 s46, 0x480000
    s_mov_b32 s47, 0x20000
    s_mul_i32 s53, s52, 2880
    s_add_u32 s53, s53, 47185920
    s_add_u32 s48, s24, s53
    s_addc_u32 s49, s25, 0
    s_mov_b32 s50, 0xb40
    s_mov_b32 s51, 0x20000
    s_nop 15
    v_max3_f32 v208, v160, v161, v162
    v_min3_f32 v209, v160, v161, v162
    v_max3_f32 v208, v208, v163, v164
    v_min3_f32 v209, v209, v163, v164
    v_max3_f32 v208, v208, v165, v166
    v_min3_f32 v209, v209, v165, v166
    v_max3_f32 v208, v208, v167, v168
    v_min3_f32 v209, v209, v167, v168
    v_mov_b32 v210, v208
    v_mov_b32 v211, v209
    s_nop 0
    v_permlane32_swap_b32 v208, v210
    v_permlane32_swap_b32 v209, v211
    s_nop 0
    v_max_f32 v208, v208, v210
    v_min_f32 v209, v209, v211
    v_mul_f32 v208, s58, v208
    v_mul_f32 v209, s58, v209
    v_fma_f32 v212, v160, s58, -v208
    v_fma_f32 v221, -v160, s58, v209
    v_fma_f32 v213, v161, s58, -v208
    v_fma_f32 v222, -v161, s58, v209
    v_fma_f32 v214, v162, s58, -v208
    v_fma_f32 v223, -v162, s58, v209
    v_fma_f32 v215, v163, s58, -v208
    v_fma_f32 v224, -v163, s58, v209
    v_fma_f32 v216, v164, s58, -v208
    v_fma_f32 v225, -v164, s58, v209
    v_fma_f32 v217, v165, s58, -v208
    v_fma_f32 v226, -v165, s58, v209
    v_fma_f32 v218, v166, s58, -v208
    v_fma_f32 v227, -v166, s58, v209
    v_fma_f32 v219, v167, s58, -v208
    v_fma_f32 v228, -v167, s58, v209
    v_fma_f32 v220, v168, s58, -v208
    v_fma_f32 v229, -v168, s58, v209
    v_exp_f32 v212, v212
    v_exp_f32 v221, v221
    v_exp_f32 v213, v213
    v_exp_f32 v222, v222
    v_exp_f32 v214, v214
    v_exp_f32 v223, v223
    v_exp_f32 v215, v215
    v_exp_f32 v224, v224
    v_exp_f32 v216, v216
    v_exp_f32 v225, v225
    v_exp_f32 v217, v217
    v_exp_f32 v226, v226
    v_exp_f32 v218, v218
    v_exp_f32 v227, v227
    v_exp_f32 v219, v219
    v_exp_f32 v228, v228
    v_exp_f32 v220, v220
    v_exp_f32 v229, v229
    s_nop 0
    v_add_f32 v208, v212, v213
    v_add_f32 v209, v221, v222
    v_add_f32 v208, v208, v214
    v_add_f32 v209, v209, v223
    v_add_f32 v208, v208, v215
    v_add_f32 v209, v209, v224
    v_add_f32 v208, v208, v216
    v_add_f32 v209, v209, v225
    v_add_f32 v208, v208, v217
    v_add_f32 v209, v209, v226
    v_add_f32 v208, v208, v218
    v_add_f32 v209, v209, v227
    v_add_f32 v208, v208, v219
    v_add_f32 v209, v209, v228
    v_add_f32 v208, v208, v220
    v_add_f32 v209, v209, v229
    v_mov_b32 v210, v208
    v_mov_b32 v211, v209
    s_nop 0
    v_permlane32_swap_b32 v208, v210
    v_permlane32_swap_b32 v209, v211
    s_nop 0
    v_add_f32 v208, v208, v210
    v_add_f32 v209, v209, v211
    v_rcp_f32 v208, v208
    v_rcp_f32 v209, v209
    s_nop 0
    v_mul_f32 v212, v212, v208
    v_mul_f32 v221, v221, v209
    v_mul_f32 v213, v213, v208
    v_mul_f32 v222, v222, v209
    v_mul_f32 v214, v214, v208
    v_mul_f32 v223, v223, v209
    v_mul_f32 v215, v215, v208
    v_mul_f32 v224, v224, v209
    v_mul_f32 v216, v216, v208
    v_mul_f32 v225, v225, v209
    v_mul_f32 v217, v217, v208
    v_mul_f32 v226, v226, v209
    v_mul_f32 v218, v218, v208
    v_mul_f32 v227, v227, v209
    v_mul_f32 v219, v219, v208
    v_mul_f32 v228, v228, v209
    v_mul_f32 v220, v220, v208
    v_mul_f32 v229, v229, v209
    v_cvt_pk_bf16_f32 v16, v212, v213
    v_cvt_pk_bf16_f32 v17, v214, v215
    v_cvt_pk_bf16_f32 v18, v216, v217
    v_cvt_pk_bf16_f32 v19, v218, v219
    v_cvt_pk_bf16_f32 v20, v220, v221
    v_cvt_pk_bf16_f32 v21, v222, v223
    v_cvt_pk_bf16_f32 v22, v224, v225
    v_cvt_pk_bf16_f32 v23, v226, v227
    v_cvt_pk_bf16_f32 v24, v228, v229
    s_lshl_b32 s54, s56, 5
    s_add_u32 s54, s54, s52
    s_mul_i32 s54, s54, 2304
    buffer_store_dwordx4 v[16:19], v2, s[44:47], s54 offen sc0 sc1
    buffer_store_dwordx4 v[20:23], v2, s[44:47], s54 offen offset:1024 sc0 sc1
    buffer_store_dword v24, v3, s[44:47], s54 offen offset:2048 sc0 sc1
    v_max3_f32 v208, v176, v177, v178
    v_min3_f32 v209, v176, v177, v178
    v_max3_f32 v208, v208, v179, v180
    v_min3_f32 v209, v209, v179, v180
    v_max3_f32 v208, v208, v181, v182
    v_min3_f32 v209, v209, v181, v182
    v_max3_f32 v208, v208, v183, v184
    v_min3_f32 v209, v209, v183, v184
    v_mov_b32 v210, v208
    v_mov_b32 v211, v209
    s_nop 0
    v_permlane32_swap_b32 v208, v210
    v_permlane32_swap_b32 v209, v211
    s_nop 0
    v_max_f32 v208, v208, v210
    v_min_f32 v209, v209, v211
    v_mul_f32 v208, s58, v208
    v_mul_f32 v209, s58, v209
    v_fma_f32 v212, v176, s58, -v208
    v_fma_f32 v221, -v176, s58, v209
    v_fma_f32 v213, v177, s58, -v208
    v_fma_f32 v222, -v177, s58, v209
    v_fma_f32 v214, v178, s58, -v208
    v_fma_f32 v223, -v178, s58, v209
    v_fma_f32 v215, v179, s58, -v208
    v_fma_f32 v224, -v179, s58, v209
    v_fma_f32 v216, v180, s58, -v208
    v_fma_f32 v225, -v180, s58, v209
    v_fma_f32 v217, v181, s58, -v208
    v_fma_f32 v226, -v181, s58, v209
    v_fma_f32 v218, v182, s58, -v208
    v_fma_f32 v227, -v182, s58, v209
    v_fma_f32 v219, v183, s58, -v208
    v_fma_f32 v228, -v183, s58, v209
    v_fma_f32 v220, v184, s58, -v208
    v_fma_f32 v229, -v184, s58, v209
    v_exp_f32 v212, v212
    v_exp_f32 v221, v221
    v_exp_f32 v213, v213
    v_exp_f32 v222, v222
    v_exp_f32 v214, v214
    v_exp_f32 v223, v223
    v_exp_f32 v215, v215
    v_exp_f32 v224, v224
    v_exp_f32 v216, v216
    v_exp_f32 v225, v225
    v_exp_f32 v217, v217
    v_exp_f32 v226, v226
    v_exp_f32 v218, v218
    v_exp_f32 v227, v227
    v_exp_f32 v219, v219
    v_exp_f32 v228, v228
    v_exp_f32 v220, v220
    v_exp_f32 v229, v229
    s_nop 0
    v_add_f32 v208, v212, v213
    v_add_f32 v209, v221, v222
    v_add_f32 v208, v208, v214
    v_add_f32 v209, v209, v223
    v_add_f32 v208, v208, v215
    v_add_f32 v209, v209, v224
    v_add_f32 v208, v208, v216
    v_add_f32 v209, v209, v225
    v_add_f32 v208, v208, v217
    v_add_f32 v209, v209, v226
    v_add_f32 v208, v208, v218
    v_add_f32 v209, v209, v227
    v_add_f32 v208, v208, v219
    v_add_f32 v209, v209, v228
    v_add_f32 v208, v208, v220
    v_add_f32 v209, v209, v229
    v_mov_b32 v210, v208
    v_mov_b32 v211, v209
    s_nop 0
    v_permlane32_swap_b32 v208, v210
    v_permlane32_swap_b32 v209, v211
    s_nop 0
    v_add_f32 v208, v208, v210
    v_add_f32 v209, v209, v211
    v_rcp_f32 v208, v208
    v_rcp_f32 v209, v209
    s_nop 0
    v_mul_f32 v212, v212, v208
    v_mul_f32 v221, v221, v209
    v_mul_f32 v213, v213, v208
    v_mul_f32 v222, v222, v209
    v_mul_f32 v214, v214, v208
    v_mul_f32 v223, v223, v209
    v_mul_f32 v215, v215, v208
    v_mul_f32 v224, v224, v209
    v_mul_f32 v216, v216, v208
    v_mul_f32 v225, v225, v209
    v_mul_f32 v217, v217, v208
    v_mul_f32 v226, v226, v209
    v_mul_f32 v218, v218, v208
    v_mul_f32 v227, v227, v209
    v_mul_f32 v219, v219, v208
    v_mul_f32 v228, v228, v209
    v_mul_f32 v220, v220, v208
    v_mul_f32 v229, v229, v209
    v_cvt_pk_bf16_f32 v28, v212, v213
    v_cvt_pk_bf16_f32 v29, v214, v215
    v_cvt_pk_bf16_f32 v30, v216, v217
    v_cvt_pk_bf16_f32 v31, v218, v219
    v_cvt_pk_bf16_f32 v32, v220, v221
    v_cvt_pk_bf16_f32 v33, v222, v223
    v_cvt_pk_bf16_f32 v34, v224, v225
    v_cvt_pk_bf16_f32 v35, v226, v227
    v_cvt_pk_bf16_f32 v36, v228, v229
    v_and_b32 v5, 31, v1
    v_lshrrev_b32 v6, 5, v1
    s_lshl_b32 s54, s26, 5
    v_add_u32 v7, s54, v5
    v_mul_u32_u24 v8, 72, v7
    v_mad_u32_u24 v8, v6, 36, v8
    v_add_u32 v8, 73728, v8
    ds_write2_b32 v8, v28, v29 offset0:0 offset1:1
    ds_write2_b32 v8, v30, v31 offset0:2 offset1:3
    ds_write2_b32 v8, v32, v33 offset0:4 offset1:5
    ds_write2_b32 v8, v34, v35 offset0:6 offset1:7
    ds_write_b32 v8, v36 offset:32
    v_cmp_eq_u32 vcc, 0, v6
    v_mov_b32 v9, 1.0
    s_nop 0
    v_cndmask_b32 v9, 0, v9, vcc
    v_cvt_pk_bf16_f32 v40, v169, v170
    v_cvt_pk_bf16_f32 v41, v171, v172
    v_cvt_pk_bf16_f32 v42, v173, v174
    v_cvt_pk_bf16_f32 v43, v175, v185
    v_cvt_pk_bf16_f32 v44, v186, v9
    v_mul_u32_u24 v8, 40, v7
    v_mad_u32_u24 v8, v6, 20, v8
    v_add_u32 v8, 92160, v8
    ds_write2_b32 v8, v40, v41 offset0:0 offset1:1
    ds_write2_b32 v8, v42, v43 offset0:2 offset1:3
    ds_write_b32 v8, v44 offset:16
    v_bfe_u32 v10, v1, 2, 2
    v_lshrrev_b32 v11, 5, v1
    v_lshl_add_u32 v10, v11, 3, v10
    s_lshl_b32 s54, s26, 5
    v_add_u32 v10, s54, v10
    v_bfe_u32 v11, v1, 4, 1
    v_and_b32 v12, 3, v1
    v_lshl_add_u32 v11, v11, 2, v12
    v_lshlrev_b32 v11, 3, v11
    v_mad_u32_u24 v12, v10, 40, v11
    v_add_u32 v12, 92160, v12
    v_mul_u32_u24 v13, 72, v10
    v_add_u32 v13, v13, v11
    v_add_u32 v13, 73728, v13
    s_waitcnt lgkmcnt(0)
    ds_read_b64_tr_b16 v[160:161], v12 offset:0
    ds_read_b64_tr_b16 v[168:169], v13 offset:0
    ds_read_b64_tr_b16 v[172:173], v13 offset:64
    ds_read_b64_tr_b16 v[162:163], v12 offset:160
    ds_read_b64_tr_b16 v[170:171], v13 offset:288
    ds_read_b64_tr_b16 v[174:175], v13 offset:352
    ds_read_b64_tr_b16 v[164:165], v12 offset:640
    ds_read_b64_tr_b16 v[176:177], v13 offset:1152
    ds_read_b64_tr_b16 v[180:181], v13 offset:1216
    ds_read_b64_tr_b16 v[166:167], v12 offset:800
    ds_read_b64_tr_b16 v[178:179], v13 offset:1440
    ds_read_b64_tr_b16 v[182:183], v13 offset:1504
    v_and_b32 v5, 31, v1
    v_lshrrev_b32 v6, 5, v1
    v_mul_u32_u24 v6, 640, v6
    v_lshl_add_u32 v6, v5, 2, v6
    s_mul_i32 s54, s26, 3840
    s_add_u32 s54, s54, 102912
    v_add_u32 v6, s54, v6
    s_waitcnt lgkmcnt(0)
    v_mfma_f32_32x32x16_bf16 v[192:207], v[160:163], v[168:171], 0
    v_mfma_f32_32x32x16_bf16 v[208:223], v[160:163], v[172:175], 0
    v_mfma_f32_32x32x16_bf16 v[192:207], v[164:167], v[176:179], v[192:207]
    v_mfma_f32_32x32x16_bf16 v[208:223], v[164:167], v[180:183], v[208:223]
    v_add_u32 v7, 0, v0
    v_mul_u32_u24 v8, 1821, v7
    v_lshrrev_b32 v8, 16, v8
    v_mul_u32_u24 v9, 36, v8
    v_sub_u32 v9, v7, v9
    v_mul_u32_u24 v8, 160, v8
    v_lshl_add_u32 v14, v9, 2, v8
    v_add_u32 v14, 102912, v14
    v_add_u32 v7, 512, v0
    v_mul_u32_u24 v8, 1821, v7
    v_lshrrev_b32 v8, 16, v8
    v_mul_u32_u24 v9, 36, v8
    v_sub_u32 v9, v7, v9
    v_mul_u32_u24 v8, 160, v8
    v_lshl_add_u32 v15, v9, 2, v8
    v_add_u32 v15, 102912, v15
    s_nop 4
    ds_write_b32 v6, v192 offset:0
    ds_write_b32 v6, v193 offset:160
    ds_write_b32 v6, v194 offset:320
    ds_write_b32 v6, v195 offset:480
    ds_write_b32 v6, v196 offset:1280
    ds_write_b32 v6, v197 offset:1440
    ds_write_b32 v6, v198 offset:1600
    ds_write_b32 v6, v199 offset:1760
    ds_write_b32 v6, v200 offset:2560
    ds_write_b32 v6, v201 offset:2720
    ds_write_b32 v6, v202 offset:2880
    ds_write_b32 v6, v203 offset:3040
    s_mov_b32 exec_lo, 0xff
    s_mov_b32 exec_hi, 0xff
    ds_write_b32 v6, v208 offset:128
    ds_write_b32 v6, v209 offset:288
    ds_write_b32 v6, v210 offset:448
    ds_write_b32 v6, v211 offset:608
    ds_write_b32 v6, v212 offset:1408
    ds_write_b32 v6, v213 offset:1568
    ds_write_b32 v6, v214 offset:1728
    ds_write_b32 v6, v215 offset:1888
    ds_write_b32 v6, v216 offset:2688
    ds_write_b32 v6, v217 offset:2848
    ds_write_b32 v6, v218 offset:3008
    ds_write_b32 v6, v219 offset:3168
    s_mov_b64 exec, -1
    s_waitcnt lgkmcnt(0)
    s_barrier
    ds_read_b32 v16, v14 offset:0
    ds_read_b32 v17, v14 offset:3840
    ds_read_b32 v18, v14 offset:7680
    ds_read_b32 v19, v14 offset:11520
    ds_read_b32 v20, v14 offset:15360
    ds_read_b32 v21, v14 offset:19200
    ds_read_b32 v22, v14 offset:23040
    ds_read_b32 v23, v14 offset:26880
    s_waitcnt lgkmcnt(0)
    v_add_f32 v16, v16, v17
    v_add_f32 v18, v18, v19
    v_add_f32 v20, v20, v21
    v_add_f32 v22, v22, v23
    v_add_f32 v16, v16, v18
    v_add_f32 v20, v20, v22
    v_add_f32 v16, v16, v20
    v_lshlrev_b32 v7, 2, v0
    buffer_atomic_add_f32 v16, v7, s[48:51], 0 offen offset:0
    s_cmp_ge_u32 s26, 4
    s_cbranch_scc1 p1_other
    ds_read_b32 v24, v15 offset:0
    ds_read_b32 v25, v15 offset:3840
    ds_read_b32 v26, v15 offset:7680
    ds_read_b32 v27, v15 offset:11520
    ds_read_b32 v28, v15 offset:15360
    ds_read_b32 v29, v15 offset:19200
    ds_read_b32 v30, v15 offset:23040
    ds_read_b32 v31, v15 offset:26880
    s_waitcnt lgkmcnt(0)
    v_add_f32 v24, v24, v25
    v_add_f32 v26, v26, v27
    v_add_f32 v28, v28, v29
    v_add_f32 v30, v30, v31
    v_add_f32 v24, v24, v26
    v_add_f32 v28, v28, v30
    v_add_f32 v24, v24, v28
    v_lshlrev_b32 v7, 2, v0
    buffer_atomic_add_f32 v24, v7, s[48:51], 0 offen offset:2048
p1_other:
    s_waitcnt vmcnt(0)
    v_mov_b32 v4, 147476
    v_mov_b32 v5, 1
    s_mov_b64 exec, 1
    ds_add_u32 v4, v5
    s_mov_b64 exec, -1
    s_cmp_lg_u32 s26, 0
    s_cbranch_scc1 b1_ns
    v_mov_b32 v4, 147476
b1_cw:
    ds_read_b32 v15, v4
    s_waitcnt lgkmcnt(0)
    v_readfirstlane_b32 s58, v15
    s_cmp_ge_u32 s58, 8
    s_cbranch_scc1 b1_cw_ok
    s_cmp_eq_u32 s28, 0
    s_cbranch_scc1 b1_cw_ok
    s_sub_u32 s28, s28, 1
    s_sleep 1
    s_branch b1_cw
b1_cw_ok:
    s_add_u32 s32, s24, 0x3408000
    s_addc_u32 s33, s25, 0
    s_mov_b32 s34, 0x8000
    s_mov_b32 s35, 0x20000
    s_lshl_b32 s29, s2, 7
    v_mov_b32 v4, s27
    v_mov_b32 v5, 0
    s_mov_b64 exec, 1
    buffer_store_dword v4, v5, s[32:35], s29 offen sc0 sc1
    s_mov_b64 exec, -1
b1_ns:
    s_and_b32 s53, s2, 7
    s_lshr_b32 s51, s2, 3
    s_lshr_b32 s52, s51, 2
    s_lshl_b32 s53, s53, 3
    s_add_u32 s52, s52, s53
    s_and_b32 s51, s51, 3
    s_add_u32 s44, s24, 0x2c00000
    s_addc_u32 s45, s25, 0
    s_mov_b32 s46, 0xa2000
    s_mov_b32 s47, 0x20000
    s_mul_i32 s59, s51, 9
    s_add_u32 s54, s59, s26
    s_mul_i32 s54, s54, 18432
    buffer_load_dwordx4 v[64:67], v2, s[44:47], s54 offen offset:0
    buffer_load_dwordx4 v[68:71], v2, s[44:47], s54 offen offset:1024
    buffer_load_dwordx4 v[72:75], v2, s[44:47], s54 offen offset:2048
    buffer_load_dwordx4 v[76:79], v2, s[44:47], s54 offen offset:3072
    s_add_u32 s54, s54, 4096
    buffer_load_dwordx4 v[80:83], v2, s[44:47], s54 offen offset:0
    buffer_load_dwordx4 v[84:87], v2, s[44:47], s54 offen offset:1024
    buffer_load_dwordx4 v[88:91], v2, s[44:47], s54 offen offset:2048
    buffer_load_dwordx4 v[92:95], v2, s[44:47], s54 offen offset:3072
    s_add_u32 s54, s54, 4096
    buffer_load_dwordx4 v[96:99], v2, s[44:47], s54 offen offset:0
    buffer_load_dwordx4 v[100:103], v2, s[44:47], s54 offen offset:1024
    buffer_load_dwordx4 v[104:107], v2, s[44:47], s54 offen offset:2048
    buffer_load_dwordx4 v[108:111], v2, s[44:47], s54 offen offset:3072
    s_add_u32 s54, s54, 4096
    buffer_load_dwordx4 v[112:115], v2, s[44:47], s54 offen offset:0
    buffer_load_dwordx4 v[116:119], v2, s[44:47], s54 offen offset:1024
    buffer_load_dwordx4 v[120:123], v2, s[44:47], s54 offen offset:2048
    buffer_load_dwordx4 v[124:127], v2, s[44:47], s54 offen offset:3072
    s_add_u32 s54, s54, 4096
    buffer_load_dwordx4 v[128:131], v2, s[44:47], s54 offen offset:0
    buffer_load_dwordx4 v[132:135], v2, s[44:47], s54 offen offset:1024
    s_cmp_ge_u32 s26, 1
    s_cbranch_scc1 p2_nowo2
    s_add_u32 s54, s59, 8
    s_mul_i32 s54, s54, 18432
    buffer_load_dwordx4 v[136:139], v2, s[44:47], s54 offen offset:0
    buffer_load_dwordx4 v[140:143], v2, s[44:47], s54 offen offset:1024
    buffer_load_dwordx4 v[144:147], v2, s[44:47], s54 offen offset:2048
    buffer_load_dwordx4 v[148:151], v2, s[44:47], s54 offen offset:3072
    s_add_u32 s54, s54, 4096
    buffer_load_dwordx4 v[152:155], v2, s[44:47], s54 offen offset:0
    buffer_load_dwordx4 v[156:159], v2, s[44:47], s54 offen offset:1024
    buffer_load_dwordx4 v[160:163], v2, s[44:47], s54 offen offset:2048
    buffer_load_dwordx4 v[164:167], v2, s[44:47], s54 offen offset:3072
    s_add_u32 s54, s54, 4096
    buffer_load_dwordx4 v[168:171], v2, s[44:47], s54 offen offset:0
    buffer_load_dwordx4 v[172:175], v2, s[44:47], s54 offen offset:1024
    buffer_load_dwordx4 v[176:179], v2, s[44:47], s54 offen offset:2048
    buffer_load_dwordx4 v[180:183], v2, s[44:47], s54 offen offset:3072
    s_add_u32 s54, s54, 4096
    buffer_load_dwordx4 v[184:187], v2, s[44:47], s54 offen offset:0
    buffer_load_dwordx4 v[188:191], v2, s[44:47], s54 offen offset:1024
    buffer_load_dwordx4 v[192:195], v2, s[44:47], s54 offen offset:2048
    buffer_load_dwordx4 v[196:199], v2, s[44:47], s54 offen offset:3072
    s_add_u32 s54, s54, 4096
    buffer_load_dwordx4 v[200:203], v2, s[44:47], s54 offen offset:0
    buffer_load_dwordx4 v[204:207], v2, s[44:47], s54 offen offset:1024
p2_nowo2:
    s_cmp_lg_u32 s26, 0
    s_cbranch_scc1 b1_join
    s_add_u32 s32, s24, 0x3408000
    s_addc_u32 s33, s25, 0
    s_mov_b32 s34, 0x8000
    s_mov_b32 s35, 0x20000
    v_lshlrev_b32 v4, 7, v1
    v_add_u32 v5, 8192, v4
    v_add_u32 v6, 16384, v4
    v_add_u32 v7, 24576, v4
b1_p:
    buffer_load_dword v8, v4, s[32:35], 0 offen sc0 sc1
    buffer_load_dword v9, v5, s[32:35], 0 offen sc0 sc1
    buffer_load_dword v10, v6, s[32:35], 0 offen sc0 sc1
    buffer_load_dword v11, v7, s[32:35], 0 offen sc0 sc1
    s_waitcnt vmcnt(0)
    v_xor_b32 v8, s27, v8
    v_xor_b32 v9, s27, v9
    v_xor_b32 v10, s27, v10
    v_xor_b32 v11, s27, v11
    v_or_b32 v8, v8, v9
    v_or3_b32 v8, v8, v10, v11
    v_cmp_ne_u32 vcc, 0, v8
    s_cbranch_vccz b1_p_x
    s_cmp_eq_u32 s28, 0
    s_cbranch_scc1 b1_p_x
    s_sub_u32 s28, s28, 1
    s_branch b1_p
b1_p_x:
    s_cmp_lg_u32 s2, 0
    s_cbranch_scc1 b1_join
    s_add_u32 s32, s24, 0x3500000
    s_addc_u32 s33, s25, 0
    s_mov_b32 s34, 0x4
    s_mov_b32 s35, 0x20000
    v_mov_b32 v4, s27
    v_mov_b32 v5, 0
    s_mov_b64 exec, 1
    buffer_store_dword v4, v5, s[32:35], 0 offen sc0 sc1
    s_mov_b64 exec, -1
b1_join:
    s_barrier
    s_add_u32 s36, s24, 0x2d00000
    s_addc_u32 s37, s25, 0
    s_mov_b32 s38, 0x16800
    s_mov_b32 s39, 0x20000
    s_add_u32 s40, s24, 0x2e00000
    s_addc_u32 s41, s25, 0
    s_mov_b32 s42, 0x480000
    s_mov_b32 s43, 0x20000
    s_mul_i32 s54, s26, 11520
    s_mul_i32 s56, s26, 12288
    s_sub_u32 s57, s56, s54
    s_add_u32 s55, s54, 0
    s_add_u32 s58, s55, s57
    s_mov_b32 m0, s58
    s_nop 0
    buffer_load_dwordx4 v2, s[36:39], s55 offen offset:0 lds
    buffer_load_dwordx4 v2, s[36:39], s55 offen offset:1024 lds
    buffer_load_dwordx4 v2, s[36:39], s55 offen offset:2048 lds
    buffer_load_dwordx4 v2, s[36:39], s55 offen offset:3072 lds
    s_add_u32 s55, s54, 4096
    s_add_u32 s58, s55, s57
    s_mov_b32 m0, s58
    s_nop 0
    buffer_load_dwordx4 v2, s[36:39], s55 offen offset:0 lds
    buffer_load_dwordx4 v2, s[36:39], s55 offen offset:1024 lds
    buffer_load_dwordx4 v2, s[36:39], s55 offen offset:2048 lds
    buffer_load_dwordx4 v2, s[36:39], s55 offen offset:3072 lds
    s_add_u32 s55, s54, 8192
    s_add_u32 s58, s55, s57
    s_mov_b32 m0, s58
    s_nop 0
    buffer_load_dwordx4 v2, s[36:39], s55 offen offset:0 lds
    buffer_load_dwordx4 v2, s[36:39], s55 offen offset:1024 lds
    buffer_load_dwordx4 v2, s[36:39], s55 offen offset:2048 lds
    buffer_load_dwordx4 v2, s[36:39], s55 offen offset:3072 lds
    s_lshl_b32 s54, s52, 5
    s_lshl_b32 s55, s26, 2
    s_add_u32 s54, s54, s55
    s_mul_i32 s54, s54, 2304
    buffer_load_dwordx4 v[16:19], v2, s[40:43], s54 offen
    buffer_load_dwordx4 v[20:23], v2, s[40:43], s54 offen offset:1024
    buffer_load_dword v24, v3, s[40:43], s54 offen offset:2048
    v_mov_b32 v25, 0
    v_mov_b32 v26, 0
    v_mov_b32 v27, 0
    s_add_u32 s54, s54, 2304
    buffer_load_dwordx4 v[28:31], v2, s[40:43], s54 offen
    buffer_load_dwordx4 v[32:35], v2, s[40:43], s54 offen offset:1024
    buffer_load_dword v36, v3, s[40:43], s54 offen offset:2048
    v_mov_b32 v37, 0
    v_mov_b32 v38, 0
    v_mov_b32 v39, 0
    s_add_u32 s54, s54, 2304
    buffer_load_dwordx4 v[40:43], v2, s[40:43], s54 offen
    buffer_load_dwordx4 v[44:47], v2, s[40:43], s54 offen offset:1024
    buffer_load_dword v48, v3, s[40:43], s54 offen offset:2048
    v_mov_b32 v49, 0
    v_mov_b32 v50, 0
    v_mov_b32 v51, 0
    s_add_u32 s54, s54, 2304
    buffer_load_dwordx4 v[52:55], v2, s[40:43], s54 offen
    buffer_load_dwordx4 v[56:59], v2, s[40:43], s54 offen offset:1024
    buffer_load_dword v60, v3, s[40:43], s54 offen offset:2048
    v_mov_b32 v61, 0
    v_mov_b32 v62, 0
    v_mov_b32 v63, 0
    v_and_b32 v5, 31, v1
    v_lshrrev_b32 v6, 5, v1
    v_bfe_u32 v7, v5, 2, 1
    v_lshrrev_b32 v8, 3, v5
    v_and_b32 v9, 3, v5
    v_lshl_add_u32 v8, v8, 2, v9
    v_mad_u32_u24 v9, v7, 10, v8
    v_mov_b32 v10, 9
    v_cmp_eq_u32 vcc, 9, v8
    s_nop 1
    v_cndmask_b32 v9, v9, v10, vcc
    v_mov_b32 v10, 19
    v_cmp_lt_u32 vcc, 9, v8
    s_nop 1
    v_cndmask_b32 v9, v9, v10, vcc
    v_mul_u32_u24 v9, 144, v9
    v_mad_u32_u24 v9, v6, 64, v9
    v_lshl_add_u32 v9, v6, 3, v9
    v_add_u32 v9, s56, v9
    v_mov_b32 v235, 0
    v_mov_b32 v236, 0
    v_mov_b32 v237, 0
    s_waitcnt vmcnt(12)
    ds_read_b64 v[208:209], v9 offset:0
    ds_read_b64 v[210:211], v9 offset:8
    ds_read_b64 v[212:213], v9 offset:16
    ds_read_b64 v[214:215], v9 offset:24
    ds_read_b64 v[216:217], v9 offset:32
    ds_read_b64 v[218:219], v9 offset:40
    ds_read_b64 v[220:221], v9 offset:48
    ds_read_b64 v[222:223], v9 offset:56
    ds_read_b64 v[224:225], v9 offset:64
    s_waitcnt lgkmcnt(0)
    v_cvt_pk_bf16_f32 v226, v208, v209
    v_cvt_pk_bf16_f32 v227, v210, v211
    v_cvt_pk_bf16_f32 v228, v212, v213
    v_cvt_pk_bf16_f32 v229, v214, v215
    v_cvt_pk_bf16_f32 v230, v216, v217
    v_cvt_pk_bf16_f32 v231, v218, v219
    v_cvt_pk_bf16_f32 v232, v220, v221
    v_cvt_pk_bf16_f32 v233, v222, v223
    v_cvt_pk_bf16_f32 v234, v224, v225
    s_waitcnt vmcnt(9)
    s_nop 1
    v_mfma_f32_32x32x16_bf16 v[238:253], v[226:229], v[16:19], 0
    v_mfma_f32_32x32x16_bf16 v[238:253], v[230:233], v[20:23], v[238:253]
    v_mfma_f32_32x32x16_bf16 v[238:253], v[234:237], v[24:27], v[238:253]
    s_nop 15
    v_add_f32 v208, 0x358637bd, v247
    v_rcp_f32 v208, v208
    s_nop 0
    v_mul_f32 v16, v238, v208
    v_mul_f32 v17, v239, v208
    v_mul_f32 v18, v240, v208
    v_mul_f32 v19, v241, v208
    v_mul_f32 v20, v242, v208
    v_mul_f32 v21, v243, v208
    v_mul_f32 v22, v244, v208
    v_mul_f32 v23, v245, v208
    v_mul_f32 v24, v246, v208
    ds_read_b64 v[208:209], v9 offset:2880
    ds_read_b64 v[210:211], v9 offset:2888
    ds_read_b64 v[212:213], v9 offset:2896
    ds_read_b64 v[214:215], v9 offset:2904
    ds_read_b64 v[216:217], v9 offset:2912
    ds_read_b64 v[218:219], v9 offset:2920
    ds_read_b64 v[220:221], v9 offset:2928
    ds_read_b64 v[222:223], v9 offset:2936
    ds_read_b64 v[224:225], v9 offset:2944
    s_waitcnt lgkmcnt(0)
    v_cvt_pk_bf16_f32 v226, v208, v209
    v_cvt_pk_bf16_f32 v227, v210, v211
    v_cvt_pk_bf16_f32 v228, v212, v213
    v_cvt_pk_bf16_f32 v229, v214, v215
    v_cvt_pk_bf16_f32 v230, v216, v217
    v_cvt_pk_bf16_f32 v231, v218, v219
    v_cvt_pk_bf16_f32 v232, v220, v221
    v_cvt_pk_bf16_f32 v233, v222, v223
    v_cvt_pk_bf16_f32 v234, v224, v225
    s_waitcnt vmcnt(6)
    s_nop 1
    v_mfma_f32_32x32x16_bf16 v[238:253], v[226:229], v[28:31], 0
    v_mfma_f32_32x32x16_bf16 v[238:253], v[230:233], v[32:35], v[238:253]
    v_mfma_f32_32x32x16_bf16 v[238:253], v[234:237], v[36:39], v[238:253]
    s_nop 15
    v_add_f32 v208, 0x358637bd, v247
    v_rcp_f32 v208, v208
    s_nop 0
    v_mul_f32 v28, v238, v208
    v_mul_f32 v29, v239, v208
    v_mul_f32 v30, v240, v208
    v_mul_f32 v31, v241, v208
    v_mul_f32 v32, v242, v208
    v_mul_f32 v33, v243, v208
    v_mul_f32 v34, v244, v208
    v_mul_f32 v35, v245, v208
    v_mul_f32 v36, v246, v208
    ds_read_b64 v[208:209], v9 offset:5760
    ds_read_b64 v[210:211], v9 offset:5768
    ds_read_b64 v[212:213], v9 offset:5776
    ds_read_b64 v[214:215], v9 offset:5784
    ds_read_b64 v[216:217], v9 offset:5792
    ds_read_b64 v[218:219], v9 offset:5800
    ds_read_b64 v[220:221], v9 offset:5808
    ds_read_b64 v[222:223], v9 offset:5816
    ds_read_b64 v[224:225], v9 offset:5824
    s_waitcnt lgkmcnt(0)
    v_cvt_pk_bf16_f32 v226, v208, v209
    v_cvt_pk_bf16_f32 v227, v210, v211
    v_cvt_pk_bf16_f32 v228, v212, v213
    v_cvt_pk_bf16_f32 v229, v214, v215
    v_cvt_pk_bf16_f32 v230, v216, v217
    v_cvt_pk_bf16_f32 v231, v218, v219
    v_cvt_pk_bf16_f32 v232, v220, v221
    v_cvt_pk_bf16_f32 v233, v222, v223
    v_cvt_pk_bf16_f32 v234, v224, v225
    s_waitcnt vmcnt(3)
    s_nop 1
    v_mfma_f32_32x32x16_bf16 v[238:253], v[226:229], v[40:43], 0
    v_mfma_f32_32x32x16_bf16 v[238:253], v[230:233], v[44:47], v[238:253]
    v_mfma_f32_32x32x16_bf16 v[238:253], v[234:237], v[48:51], v[238:253]
    s_nop 15
    v_add_f32 v208, 0x358637bd, v247
    v_rcp_f32 v208, v208
    s_nop 0
    v_mul_f32 v40, v238, v208
    v_mul_f32 v41, v239, v208
    v_mul_f32 v42, v240, v208
    v_mul_f32 v43, v241, v208
    v_mul_f32 v44, v242, v208
    v_mul_f32 v45, v243, v208
    v_mul_f32 v46, v244, v208
    v_mul_f32 v47, v245, v208
    v_mul_f32 v48, v246, v208
    ds_read_b64 v[208:209], v9 offset:8640
    ds_read_b64 v[210:211], v9 offset:8648
    ds_read_b64 v[212:213], v9 offset:8656
    ds_read_b64 v[214:215], v9 offset:8664
    ds_read_b64 v[216:217], v9 offset:8672
    ds_read_b64 v[218:219], v9 offset:8680
    ds_read_b64 v[220:221], v9 offset:8688
    ds_read_b64 v[222:223], v9 offset:8696
    ds_read_b64 v[224:225], v9 offset:8704
    s_waitcnt lgkmcnt(0)
    v_cvt_pk_bf16_f32 v226, v208, v209
    v_cvt_pk_bf16_f32 v227, v210, v211
    v_cvt_pk_bf16_f32 v228, v212, v213
    v_cvt_pk_bf16_f32 v229, v214, v215
    v_cvt_pk_bf16_f32 v230, v216, v217
    v_cvt_pk_bf16_f32 v231, v218, v219
    v_cvt_pk_bf16_f32 v232, v220, v221
    v_cvt_pk_bf16_f32 v233, v222, v223
    v_cvt_pk_bf16_f32 v234, v224, v225
    s_waitcnt vmcnt(0)
    s_nop 1
    v_mfma_f32_32x32x16_bf16 v[238:253], v[226:229], v[52:55], 0
    v_mfma_f32_32x32x16_bf16 v[238:253], v[230:233], v[56:59], v[238:253]
    v_mfma_f32_32x32x16_bf16 v[238:253], v[234:237], v[60:63], v[238:253]
    s_nop 15
    v_add_f32 v208, 0x358637bd, v247
    v_rcp_f32 v208, v208
    s_nop 0
    v_mul_f32 v52, v238, v208
    v_mul_f32 v53, v239, v208
    v_mul_f32 v54, v240, v208
    v_mul_f32 v55, v241, v208
    v_mul_f32 v56, v242, v208
    v_mul_f32 v57, v243, v208
    v_mul_f32 v58, v244, v208
    v_mul_f32 v59, v245, v208
    v_mul_f32 v60, v246, v208
    v_cvt_pk_bf16_f32 v208, v16, v28
    v_cvt_pk_bf16_f32 v209, v17, v29
    v_cvt_pk_bf16_f32 v210, v18, v30
    v_cvt_pk_bf16_f32 v211, v19, v31
    v_cvt_pk_bf16_f32 v212, v20, v32
    v_cvt_pk_bf16_f32 v213, v21, v33
    v_cvt_pk_bf16_f32 v214, v22, v34
    v_cvt_pk_bf16_f32 v215, v23, v35
    v_cvt_pk_bf16_f32 v216, v24, v36
    v_cvt_pk_bf16_f32 v217, v40, v52
    v_cvt_pk_bf16_f32 v218, v41, v53
    v_cvt_pk_bf16_f32 v219, v42, v54
    v_cvt_pk_bf16_f32 v220, v43, v55
    v_cvt_pk_bf16_f32 v221, v44, v56
    v_cvt_pk_bf16_f32 v222, v45, v57
    v_cvt_pk_bf16_f32 v223, v46, v58
    v_cvt_pk_bf16_f32 v224, v47, v59
    v_cvt_pk_bf16_f32 v225, v48, v60
    v_bfe_u32 v7, v5, 1, 3
    v_mul_u32_u24 v8, 1152, v5
    v_add_u32 v8, 98304, v8
    s_mul_i32 s54, s26, 9
    v_lshlrev_b32 v9, 2, v6
    v_add_u32 v9, s54, v9
    v_add_u32 v10, 0, v9
    v_xor_b32 v10, v10, v7
    v_lshl_add_u32 v10, v10, 4, v8
    ds_write_b128 v10, v[208:211]
    v_add_u32 v10, 1, v9
    v_xor_b32 v10, v10, v7
    v_lshl_add_u32 v10, v10, 4, v8
    ds_write_b128 v10, v[212:215]
    v_add_u32 v10, 2, v9
    v_xor_b32 v10, v10, v7
    v_lshl_add_u32 v10, v10, 4, v8
    ds_write_b128 v10, v[216:219]
    v_add_u32 v10, 3, v9
    v_xor_b32 v10, v10, v7
    v_lshl_add_u32 v10, v10, 4, v8
    ds_write_b128 v10, v[220:223]
    s_add_u32 s54, s54, 8
    v_xor_b32 v10, s54, v7
    v_lshl_add_u32 v10, v10, 4, v8
    v_lshl_add_u32 v10, v6, 3, v10
    ds_write_b64 v10, v[224:225]
    s_mov_b32 s36, s4
    s_mov_b32 s37, s5
    s_mov_b32 s38, 0x240000
    s_mov_b32 s39, 0x20000
    s_mul_i32 s56, s52, 36864
    s_mul_i32 s55, s51, 288
    s_add_u32 s56, s56, s55
    v_mov_b32 v10, v0
    v_mul_u32_u24 v11, 3641, v10
    v_lshrrev_b32 v11, 16, v11
    v_mul_u32_u24 v4, 18, v11
    v_sub_u32 v4, v10, v4
    v_mul_u32_u24 v12, 1152, v11
    v_lshl_add_u32 v12, v4, 4, v12
    v_mul_u32_u24 v14, 592, v11
    v_lshl_add_u32 v14, v4, 5, v14
    v_add_u32 v10, 512, v0
    v_mul_u32_u24 v11, 3641, v10
    v_lshrrev_b32 v11, 16, v11
    v_mul_u32_u24 v4, 18, v11
    v_sub_u32 v4, v10, v4
    v_mul_u32_u24 v13, 1152, v11
    v_lshl_add_u32 v13, v4, 4, v13
    v_mul_u32_u24 v15, 592, v11
    v_lshl_add_u32 v15, v4, 5, v15
    buffer_load_dwordx4 v[16:19], v12, s[36:39], s56 offen
    s_cmp_ge_u32 s26, 1
    s_cbranch_scc1 p2_nox2
    buffer_load_dwordx4 v[20:23], v13, s[36:39], s56 offen
p2_nox2:
    s_waitcnt lgkmcnt(0)
    s_barrier
    v_and_b32 v5, 15, v1
    v_lshrrev_b32 v6, 4, v1
    v_lshrrev_b32 v7, 1, v5
    v_mul_u32_u24 v8, 1152, v5
    v_add_u32 v8, 98304, v8
    v_xor_b32 v9, v6, v7
    v_lshl_add_u32 v10, v9, 4, v8
    v_xor_b32 v9, 4, v9
    v_lshl_add_u32 v11, v9, 4, v8
    s_cmp_ge_u32 s26, 1
    s_cbranch_scc1 p2_g1
    ds_read_b128 v[208:211], v10 offset:0
    ds_read_b128 v[212:215], v10 offset:18432
    ds_read_b128 v[216:219], v11 offset:0
    ds_read_b128 v[220:223], v11 offset:18432
    s_waitcnt lgkmcnt(2)
    v_mfma_f32_16x16x32_bf16 v[224:227], v[64:67], v[208:211], 0
    v_mfma_f32_16x16x32_bf16 v[228:231], v[64:67], v[212:215], 0
    v_mfma_f32_16x16x32_bf16 v[232:235], v[136:139], v[208:211], 0
    v_mfma_f32_16x16x32_bf16 v[236:239], v[136:139], v[212:215], 0
    ds_read_b128 v[208:211], v10 offset:128
    ds_read_b128 v[212:215], v10 offset:18560
    s_waitcnt lgkmcnt(2)
    v_mfma_f32_16x16x32_bf16 v[224:227], v[68:71], v[216:219], v[224:227]
    v_mfma_f32_16x16x32_bf16 v[228:231], v[68:71], v[220:223], v[228:231]
    v_mfma_f32_16x16x32_bf16 v[232:235], v[140:143], v[216:219], v[232:235]
    v_mfma_f32_16x16x32_bf16 v[236:239], v[140:143], v[220:223], v[236:239]
    ds_read_b128 v[216:219], v11 offset:128
    ds_read_b128 v[220:223], v11 offset:18560
    s_waitcnt lgkmcnt(2)
    v_mfma_f32_16x16x32_bf16 v[224:227], v[72:75], v[208:211], v[224:227]
    v_mfma_f32_16x16x32_bf16 v[228:231], v[72:75], v[212:215], v[228:231]
    v_mfma_f32_16x16x32_bf16 v[232:235], v[144:147], v[208:211], v[232:235]
    v_mfma_f32_16x16x32_bf16 v[236:239], v[144:147], v[212:215], v[236:239]
    ds_read_b128 v[208:211], v10 offset:256
    ds_read_b128 v[212:215], v10 offset:18688
    s_waitcnt lgkmcnt(2)
    v_mfma_f32_16x16x32_bf16 v[224:227], v[76:79], v[216:219], v[224:227]
    v_mfma_f32_16x16x32_bf16 v[228:231], v[76:79], v[220:223], v[228:231]
    v_mfma_f32_16x16x32_bf16 v[232:235], v[148:151], v[216:219], v[232:235]
    v_mfma_f32_16x16x32_bf16 v[236:239], v[148:151], v[220:223], v[236:239]
    ds_read_b128 v[216:219], v11 offset:256
    ds_read_b128 v[220:223], v11 offset:18688
    s_waitcnt lgkmcnt(2)
    v_mfma_f32_16x16x32_bf16 v[224:227], v[80:83], v[208:211], v[224:227]
    v_mfma_f32_16x16x32_bf16 v[228:231], v[80:83], v[212:215], v[228:231]
    v_mfma_f32_16x16x32_bf16 v[232:235], v[152:155], v[208:211], v[232:235]
    v_mfma_f32_16x16x32_bf16 v[236:239], v[152:155], v[212:215], v[236:239]
    ds_read_b128 v[208:211], v10 offset:384
    ds_read_b128 v[212:215], v10 offset:18816
    s_waitcnt lgkmcnt(2)
    v_mfma_f32_16x16x32_bf16 v[224:227], v[84:87], v[216:219], v[224:227]
    v_mfma_f32_16x16x32_bf16 v[228:231], v[84:87], v[220:223], v[228:231]
    v_mfma_f32_16x16x32_bf16 v[232:235], v[156:159], v[216:219], v[232:235]
    v_mfma_f32_16x16x32_bf16 v[236:239], v[156:159], v[220:223], v[236:239]
    ds_read_b128 v[216:219], v11 offset:384
    ds_read_b128 v[220:223], v11 offset:18816
    s_waitcnt lgkmcnt(2)
    v_mfma_f32_16x16x32_bf16 v[224:227], v[88:91], v[208:211], v[224:227]
    v_mfma_f32_16x16x32_bf16 v[228:231], v[88:91], v[212:215], v[228:231]
    v_mfma_f32_16x16x32_bf16 v[232:235], v[160:163], v[208:211], v[232:235]
    v_mfma_f32_16x16x32_bf16 v[236:239], v[160:163], v[212:215], v[236:239]
    ds_read_b128 v[208:211], v10 offset:512
    ds_read_b128 v[212:215], v10 offset:18944
    s_waitcnt lgkmcnt(2)
    v_mfma_f32_16x16x32_bf16 v[224:227], v[92:95], v[216:219], v[224:227]
    v_mfma_f32_16x16x32_bf16 v[228:231], v[92:95], v[220:223], v[228:231]
    v_mfma_f32_16x16x32_bf16 v[232:235], v[164:167], v[216:219], v[232:235]
    v_mfma_f32_16x16x32_bf16 v[236:239], v[164:167], v[220:223], v[236:239]
    ds_read_b128 v[216:219], v11 offset:512
    ds_read_b128 v[220:223], v11 offset:18944
    s_waitcnt lgkmcnt(2)
    v_mfma_f32_16x16x32_bf16 v[224:227], v[96:99], v[208:211], v[224:227]
    v_mfma_f32_16x16x32_bf16 v[228:231], v[96:99], v[212:215], v[228:231]
    v_mfma_f32_16x16x32_bf16 v[232:235], v[168:171], v[208:211], v[232:235]
    v_mfma_f32_16x16x32_bf16 v[236:239], v[168:171], v[212:215], v[236:239]
    ds_read_b128 v[208:211], v10 offset:640
    ds_read_b128 v[212:215], v10 offset:19072
    s_waitcnt lgkmcnt(2)
    v_mfma_f32_16x16x32_bf16 v[224:227], v[100:103], v[216:219], v[224:227]
    v_mfma_f32_16x16x32_bf16 v[228:231], v[100:103], v[220:223], v[228:231]
    v_mfma_f32_16x16x32_bf16 v[232:235], v[172:175], v[216:219], v[232:235]
    v_mfma_f32_16x16x32_bf16 v[236:239], v[172:175], v[220:223], v[236:239]
    ds_read_b128 v[216:219], v11 offset:640
    ds_read_b128 v[220:223], v11 offset:19072
    s_waitcnt lgkmcnt(2)
    v_mfma_f32_16x16x32_bf16 v[224:227], v[104:107], v[208:211], v[224:227]
    v_mfma_f32_16x16x32_bf16 v[228:231], v[104:107], v[212:215], v[228:231]
    v_mfma_f32_16x16x32_bf16 v[232:235], v[176:179], v[208:211], v[232:235]
    v_mfma_f32_16x16x32_bf16 v[236:239], v[176:179], v[212:215], v[236:239]
    ds_read_b128 v[208:211], v10 offset:768
    ds_read_b128 v[212:215], v10 offset:19200
    s_waitcnt lgkmcnt(2)
    v_mfma_f32_16x16x32_bf16 v[224:227], v[108:111], v[216:219], v[224:227]
    v_mfma_f32_16x16x32_bf16 v[228:231], v[108:111], v[220:223], v[228:231]
    v_mfma_f32_16x16x32_bf16 v[232:235], v[180:183], v[216:219], v[232:235]
    v_mfma_f32_16x16x32_bf16 v[236:239], v[180:183], v[220:223], v[236:239]
    ds_read_b128 v[216:219], v11 offset:768
    ds_read_b128 v[220:223], v11 offset:19200
    s_waitcnt lgkmcnt(2)
    v_mfma_f32_16x16x32_bf16 v[224:227], v[112:115], v[208:211], v[224:227]
    v_mfma_f32_16x16x32_bf16 v[228:231], v[112:115], v[212:215], v[228:231]
    v_mfma_f32_16x16x32_bf16 v[232:235], v[184:187], v[208:211], v[232:235]
    v_mfma_f32_16x16x32_bf16 v[236:239], v[184:187], v[212:215], v[236:239]
    ds_read_b128 v[208:211], v10 offset:896
    ds_read_b128 v[212:215], v10 offset:19328
    s_waitcnt lgkmcnt(2)
    v_mfma_f32_16x16x32_bf16 v[224:227], v[116:119], v[216:219], v[224:227]
    v_mfma_f32_16x16x32_bf16 v[228:231], v[116:119], v[220:223], v[228:231]
    v_mfma_f32_16x16x32_bf16 v[232:235], v[188:191], v[216:219], v[232:235]
    v_mfma_f32_16x16x32_bf16 v[236:239], v[188:191], v[220:223], v[236:239]
    ds_read_b128 v[216:219], v11 offset:896
    ds_read_b128 v[220:223], v11 offset:19328
    s_waitcnt lgkmcnt(2)
    v_mfma_f32_16x16x32_bf16 v[224:227], v[120:123], v[208:211], v[224:227]
    v_mfma_f32_16x16x32_bf16 v[228:231], v[120:123], v[212:215], v[228:231]
    v_mfma_f32_16x16x32_bf16 v[232:235], v[192:195], v[208:211], v[232:235]
    v_mfma_f32_16x16x32_bf16 v[236:239], v[192:195], v[212:215], v[236:239]
    ds_read_b128 v[208:211], v10 offset:1024
    ds_read_b128 v[212:215], v10 offset:19456
    s_waitcnt lgkmcnt(2)
    v_mfma_f32_16x16x32_bf16 v[224:227], v[124:127], v[216:219], v[224:227]
    v_mfma_f32_16x16x32_bf16 v[228:231], v[124:127], v[220:223], v[228:231]
    v_mfma_f32_16x16x32_bf16 v[232:235], v[196:199], v[216:219], v[232:235]
    v_mfma_f32_16x16x32_bf16 v[236:239], v[196:199], v[220:223], v[236:239]
    ds_read_b128 v[216:219], v11 offset:1024
    ds_read_b128 v[220:223], v11 offset:19456
    s_waitcnt lgkmcnt(2)
    v_mfma_f32_16x16x32_bf16 v[224:227], v[128:131], v[208:211], v[224:227]
    v_mfma_f32_16x16x32_bf16 v[228:231], v[128:131], v[212:215], v[228:231]
    v_mfma_f32_16x16x32_bf16 v[232:235], v[200:203], v[208:211], v[232:235]
    v_mfma_f32_16x16x32_bf16 v[236:239], v[200:203], v[212:215], v[236:239]
    s_waitcnt lgkmcnt(0)
    v_mfma_f32_16x16x32_bf16 v[224:227], v[132:135], v[216:219], v[224:227]
    v_mfma_f32_16x16x32_bf16 v[228:231], v[132:135], v[220:223], v[228:231]
    v_mfma_f32_16x16x32_bf16 v[232:235], v[204:207], v[216:219], v[232:235]
    v_mfma_f32_16x16x32_bf16 v[236:239], v[204:207], v[220:223], v[236:239]
    s_branch p2_g2
p2_g1:
    ds_read_b128 v[208:211], v10 offset:0
    ds_read_b128 v[212:215], v10 offset:18432
    ds_read_b128 v[216:219], v11 offset:0
    ds_read_b128 v[220:223], v11 offset:18432
    s_waitcnt lgkmcnt(2)
    v_mfma_f32_16x16x32_bf16 v[224:227], v[64:67], v[208:211], 0
    v_mfma_f32_16x16x32_bf16 v[228:231], v[64:67], v[212:215], 0
    ds_read_b128 v[208:211], v10 offset:128
    ds_read_b128 v[212:215], v10 offset:18560
    s_waitcnt lgkmcnt(2)
    v_mfma_f32_16x16x32_bf16 v[224:227], v[68:71], v[216:219], v[224:227]
    v_mfma_f32_16x16x32_bf16 v[228:231], v[68:71], v[220:223], v[228:231]
    ds_read_b128 v[216:219], v11 offset:128
    ds_read_b128 v[220:223], v11 offset:18560
    s_waitcnt lgkmcnt(2)
    v_mfma_f32_16x16x32_bf16 v[224:227], v[72:75], v[208:211], v[224:227]
    v_mfma_f32_16x16x32_bf16 v[228:231], v[72:75], v[212:215], v[228:231]
    ds_read_b128 v[208:211], v10 offset:256
    ds_read_b128 v[212:215], v10 offset:18688
    s_waitcnt lgkmcnt(2)
    v_mfma_f32_16x16x32_bf16 v[224:227], v[76:79], v[216:219], v[224:227]
    v_mfma_f32_16x16x32_bf16 v[228:231], v[76:79], v[220:223], v[228:231]
    ds_read_b128 v[216:219], v11 offset:256
    ds_read_b128 v[220:223], v11 offset:18688
    s_waitcnt lgkmcnt(2)
    v_mfma_f32_16x16x32_bf16 v[224:227], v[80:83], v[208:211], v[224:227]
    v_mfma_f32_16x16x32_bf16 v[228:231], v[80:83], v[212:215], v[228:231]
    ds_read_b128 v[208:211], v10 offset:384
    ds_read_b128 v[212:215], v10 offset:18816
    s_waitcnt lgkmcnt(2)
    v_mfma_f32_16x16x32_bf16 v[224:227], v[84:87], v[216:219], v[224:227]
    v_mfma_f32_16x16x32_bf16 v[228:231], v[84:87], v[220:223], v[228:231]
    ds_read_b128 v[216:219], v11 offset:384
    ds_read_b128 v[220:223], v11 offset:18816
    s_waitcnt lgkmcnt(2)
    v_mfma_f32_16x16x32_bf16 v[224:227], v[88:91], v[208:211], v[224:227]
    v_mfma_f32_16x16x32_bf16 v[228:231], v[88:91], v[212:215], v[228:231]
    ds_read_b128 v[208:211], v10 offset:512
    ds_read_b128 v[212:215], v10 offset:18944
    s_waitcnt lgkmcnt(2)
    v_mfma_f32_16x16x32_bf16 v[224:227], v[92:95], v[216:219], v[224:227]
    v_mfma_f32_16x16x32_bf16 v[228:231], v[92:95], v[220:223], v[228:231]
    ds_read_b128 v[216:219], v11 offset:512
    ds_read_b128 v[220:223], v11 offset:18944
    s_waitcnt lgkmcnt(2)
    v_mfma_f32_16x16x32_bf16 v[224:227], v[96:99], v[208:211], v[224:227]
    v_mfma_f32_16x16x32_bf16 v[228:231], v[96:99], v[212:215], v[228:231]
    ds_read_b128 v[208:211], v10 offset:640
    ds_read_b128 v[212:215], v10 offset:19072
    s_waitcnt lgkmcnt(2)
    v_mfma_f32_16x16x32_bf16 v[224:227], v[100:103], v[216:219], v[224:227]
    v_mfma_f32_16x16x32_bf16 v[228:231], v[100:103], v[220:223], v[228:231]
    ds_read_b128 v[216:219], v11 offset:640
    ds_read_b128 v[220:223], v11 offset:19072
    s_waitcnt lgkmcnt(2)
    v_mfma_f32_16x16x32_bf16 v[224:227], v[104:107], v[208:211], v[224:227]
    v_mfma_f32_16x16x32_bf16 v[228:231], v[104:107], v[212:215], v[228:231]
    ds_read_b128 v[208:211], v10 offset:768
    ds_read_b128 v[212:215], v10 offset:19200
    s_waitcnt lgkmcnt(2)
    v_mfma_f32_16x16x32_bf16 v[224:227], v[108:111], v[216:219], v[224:227]
    v_mfma_f32_16x16x32_bf16 v[228:231], v[108:111], v[220:223], v[228:231]
    ds_read_b128 v[216:219], v11 offset:768
    ds_read_b128 v[220:223], v11 offset:19200
    s_waitcnt lgkmcnt(2)
    v_mfma_f32_16x16x32_bf16 v[224:227], v[112:115], v[208:211], v[224:227]
    v_mfma_f32_16x16x32_bf16 v[228:231], v[112:115], v[212:215], v[228:231]
    ds_read_b128 v[208:211], v10 offset:896
    ds_read_b128 v[212:215], v10 offset:19328
    s_waitcnt lgkmcnt(2)
    v_mfma_f32_16x16x32_bf16 v[224:227], v[116:119], v[216:219], v[224:227]
    v_mfma_f32_16x16x32_bf16 v[228:231], v[116:119], v[220:223], v[228:231]
    ds_read_b128 v[216:219], v11 offset:896
    ds_read_b128 v[220:223], v11 offset:19328
    s_waitcnt lgkmcnt(2)
    v_mfma_f32_16x16x32_bf16 v[224:227], v[120:123], v[208:211], v[224:227]
    v_mfma_f32_16x16x32_bf16 v[228:231], v[120:123], v[212:215], v[228:231]
    ds_read_b128 v[208:211], v10 offset:1024
    ds_read_b128 v[212:215], v10 offset:19456
    s_waitcnt lgkmcnt(2)
    v_mfma_f32_16x16x32_bf16 v[224:227], v[124:127], v[216:219], v[224:227]
    v_mfma_f32_16x16x32_bf16 v[228:231], v[124:127], v[220:223], v[228:231]
    ds_read_b128 v[216:219], v11 offset:1024
    ds_read_b128 v[220:223], v11 offset:19456
    s_waitcnt lgkmcnt(2)
    v_mfma_f32_16x16x32_bf16 v[224:227], v[128:131], v[208:211], v[224:227]
    v_mfma_f32_16x16x32_bf16 v[228:231], v[128:131], v[212:215], v[228:231]
    s_waitcnt lgkmcnt(0)
    v_mfma_f32_16x16x32_bf16 v[224:227], v[132:135], v[216:219], v[224:227]
    v_mfma_f32_16x16x32_bf16 v[228:231], v[132:135], v[220:223], v[228:231]
p2_g2:
    v_mul_u32_u24 v8, 592, v5
    v_lshl_add_u32 v8, v6, 4, v8
    s_lshl_b32 s54, s26, 6
    v_add_u32 v9, s54, v8
    s_nop 7
    ds_write_b128 v9, v[224:227]
    ds_write_b128 v9, v[228:231] offset:9472
    s_cmp_ge_u32 s26, 1
    s_cbranch_scc1 p2_e1
    ds_write_b128 v8, v[232:235] offset:512
    ds_write_b128 v8, v[236:239] offset:9984
p2_e1:
    s_waitcnt vmcnt(0) lgkmcnt(0)
    s_barrier
    s_add_u32 s40, s24, 0x1000000
    s_addc_u32 s41, s25, 0
    s_mov_b32 s42, 0x240000
    s_mov_b32 s43, 0x20000
    ds_read_b128 v[24:27], v14
    ds_read_b128 v[28:31], v14 offset:16
    v_lshlrev_b32 v32, 16, v16
    v_and_b32 v33, 0xffff0000, v16
    v_lshlrev_b32 v34, 16, v17
    v_and_b32 v35, 0xffff0000, v17
    v_lshlrev_b32 v36, 16, v18
    v_and_b32 v37, 0xffff0000, v18
    v_lshlrev_b32 v38, 16, v19
    v_and_b32 v39, 0xffff0000, v19
    s_waitcnt lgkmcnt(0)
    v_add_f32 v24, v24, v32
    v_add_f32 v25, v25, v33
    v_add_f32 v26, v26, v34
    v_add_f32 v27, v27, v35
    v_add_f32 v28, v28, v36
    v_add_f32 v29, v29, v37
    v_add_f32 v30, v30, v38
    v_add_f32 v31, v31, v39
    v_cvt_pk_bf16_f32 v40, v24, v25
    v_cvt_pk_bf16_f32 v41, v26, v27
    v_cvt_pk_bf16_f32 v42, v28, v29
    v_cvt_pk_bf16_f32 v43, v30, v31
    buffer_store_dwordx4 v[40:43], v12, s[40:43], s56 offen sc0 sc1
    s_cmp_ge_u32 s26, 1
    s_cbranch_scc1 p2_fin
    ds_read_b128 v[24:27], v15
    ds_read_b128 v[28:31], v15 offset:16
    v_lshlrev_b32 v32, 16, v20
    v_and_b32 v33, 0xffff0000, v20
    v_lshlrev_b32 v34, 16, v21
    v_and_b32 v35, 0xffff0000, v21
    v_lshlrev_b32 v36, 16, v22
    v_and_b32 v37, 0xffff0000, v22
    v_lshlrev_b32 v38, 16, v23
    v_and_b32 v39, 0xffff0000, v23
    s_waitcnt lgkmcnt(0)
    v_add_f32 v24, v24, v32
    v_add_f32 v25, v25, v33
    v_add_f32 v26, v26, v34
    v_add_f32 v27, v27, v35
    v_add_f32 v28, v28, v36
    v_add_f32 v29, v29, v37
    v_add_f32 v30, v30, v38
    v_add_f32 v31, v31, v39
    v_cvt_pk_bf16_f32 v44, v24, v25
    v_cvt_pk_bf16_f32 v45, v26, v27
    v_cvt_pk_bf16_f32 v46, v28, v29
    v_cvt_pk_bf16_f32 v47, v30, v31
    buffer_store_dwordx4 v[44:47], v13, s[40:43], s56 offen sc0 sc1
p2_fin:
    s_waitcnt vmcnt(0) lgkmcnt(0)
    s_barrier
    s_cmp_lg_u32 s26, 0
    s_cbranch_scc1 b2_s
    s_add_u32 s32, s24, 0x3410000
    s_addc_u32 s33, s25, 0
    s_mov_b32 s34, 0x8000
    s_mov_b32 s35, 0x20000
    s_lshl_b32 s29, s2, 7
    v_mov_b32 v4, s27
    v_mov_b32 v5, 0
    s_mov_b64 exec, 1
    buffer_store_dword v4, v5, s[32:35], s29 offen sc0 sc1
    s_mov_b64 exec, -1
b2_s:
    s_and_b32 s53, s2, 7
    s_lshr_b32 s54, s2, 3
    s_and_b32 s50, s53, 3
    s_lshl_b32 s50, s50, 1
    s_and_b32 s55, s54, 1
    s_add_u32 s50, s50, s55
    s_lshr_b32 s51, s53, 2
    s_lshl_b32 s51, s51, 4
    s_lshr_b32 s55, s54, 1
    s_add_u32 s51, s51, s55
    s_mul_i32 s53, s50, 1990656
    s_add_u32 s53, s53, 0
    s_add_u32 s36, s24, s53
    s_addc_u32 s37, s25, 0
    s_mov_b32 s38, 0x1e6000
    s_mov_b32 s39, 0x20000
    s_mul_i32 s53, s26, 252
    s_mul_i32 s54, s26, 234
    s_add_u32 s54, s54, 72
    s_cmp_lt_u32 s26, 4
    s_cselect_b32 s53, s53, s54
    s_lshl_b32 s52, s53, 10
    buffer_load_dwordx4 v[48:51], v2, s[36:39], s52 offen offset:0
    buffer_load_dwordx4 v[52:55], v2, s[36:39], s52 offen offset:1024
    buffer_load_dwordx4 v[56:59], v2, s[36:39], s52 offen offset:2048
    buffer_load_dwordx4 v[60:63], v2, s[36:39], s52 offen offset:3072
    s_add_u32 s52, s52, 4096
    buffer_load_dwordx4 v[64:67], v2, s[36:39], s52 offen offset:0
    buffer_load_dwordx4 v[68:71], v2, s[36:39], s52 offen offset:1024
    buffer_load_dwordx4 v[72:75], v2, s[36:39], s52 offen offset:2048
    buffer_load_dwordx4 v[76:79], v2, s[36:39], s52 offen offset:3072
    s_add_u32 s52, s52, 4096
    buffer_load_dwordx4 v[80:83], v2, s[36:39], s52 offen offset:0
    buffer_load_dwordx4 v[84:87], v2, s[36:39], s52 offen offset:1024
    buffer_load_dwordx4 v[88:91], v2, s[36:39], s52 offen offset:2048
    buffer_load_dwordx4 v[92:95], v2, s[36:39], s52 offen offset:3072
    s_add_u32 s52, s52, 4096
    buffer_load_dwordx4 v[96:99], v2, s[36:39], s52 offen offset:0
    buffer_load_dwordx4 v[100:103], v2, s[36:39], s52 offen offset:1024
    buffer_load_dwordx4 v[104:107], v2, s[36:39], s52 offen offset:2048
    buffer_load_dwordx4 v[108:111], v2, s[36:39], s52 offen offset:3072
    s_add_u32 s52, s52, 4096
    buffer_load_dwordx4 v[112:115], v2, s[36:39], s52 offen offset:0
    buffer_load_dwordx4 v[116:119], v2, s[36:39], s52 offen offset:1024
    buffer_load_dwordx4 v[120:123], v2, s[36:39], s52 offen offset:2048
    buffer_load_dwordx4 v[124:127], v2, s[36:39], s52 offen offset:3072
    s_add_u32 s52, s52, 4096
    buffer_load_dwordx4 v[128:131], v2, s[36:39], s52 offen offset:0
    s_cmp_lg_u32 s26, 0
    s_cbranch_scc1 b2_join
    s_lshr_b32 s53, s51, 2
    s_and_b32 s54, s51, 3
    s_lshl_b32 s54, s54, 6
    s_add_u32 s53, s53, s54
    s_add_u32 s32, s24, 0x3410000
    s_addc_u32 s33, s25, 0
    s_mov_b32 s34, 0x8000
    s_mov_b32 s35, 0x20000
    v_mul_u32_u24 v4, 1024, v1
    s_lshl_b32 s29, s53, 7
    s_mov_b64 exec, 0xff
    buffer_load_dword v8, v4, s[32:35], s29 offen sc0 sc1
b2_p:
    buffer_load_dword v9, v4, s[32:35], s29 offen sc0 sc1
    s_waitcnt vmcnt(1)
    v_cmp_ne_u32 vcc, s27, v8
    s_cbranch_vccz b2_p_x
    buffer_load_dword v8, v4, s[32:35], s29 offen sc0 sc1
    s_waitcnt vmcnt(1)
    v_cmp_ne_u32 vcc, s27, v9
    s_cbranch_vccz b2_p_x
    s_cmp_eq_u32 s28, 0
    s_cbranch_scc1 b2_p_x
    s_sub_u32 s28, s28, 1
    s_branch b2_p
b2_p_x:
    s_waitcnt vmcnt(0)
    s_mov_b64 exec, -1
b2_join:
    s_barrier
    s_mul_i32 s53, s51, 73728
    s_add_u32 s53, s53, 16777216
    s_add_u32 s40, s24, s53
    s_addc_u32 s41, s25, 0
    s_mov_b32 s42, 0x12000
    s_mov_b32 s43, 0x20000
    s_lshl_b32 s54, s50, 5
    s_add_u32 s54, s54, s51
    s_mul_i32 s53, s54, 73728
    s_add_u32 s53, s53, 20971520
    s_add_u32 s44, s24, s53
    s_addc_u32 s45, s25, 0
    s_mov_b32 s46, 0x12000
    s_mov_b32 s47, 0x20000
    v_lshrrev_b32 v12, 3, v0
    v_and_b32 v13, 7, v0
    v_mul_u32_u24 v14, 1152, v12
    v_lshl_add_u32 v15, v13, 4, v14
    buffer_load_dwordx4 v[132:135], v15, s[40:43], 0 offen offset:0
    buffer_load_dwordx4 v[136:139], v15, s[40:43], 0 offen offset:128
    buffer_load_dwordx4 v[140:143], v15, s[40:43], 0 offen offset:256
    buffer_load_dwordx4 v[144:147], v15, s[40:43], 0 offen offset:384
    buffer_load_dwordx4 v[148:151], v15, s[40:43], 0 offen offset:512
    buffer_load_dwordx4 v[152:155], v15, s[40:43], 0 offen offset:640
    buffer_load_dwordx4 v[156:159], v15, s[40:43], 0 offen offset:768
    buffer_load_dwordx4 v[160:163], v15, s[40:43], 0 offen offset:896
    buffer_load_dwordx4 v[164:167], v15, s[40:43], 0 offen offset:1024
    v_bfe_u32 v4, v12, 1, 3
    v_xor_b32 v4, v4, v13
    v_lshl_add_u32 v248, v4, 4, v14
    v_mov_b32 v12, 147456
    v_mov_b32 v13, 147460
    v_mov_b32 v14, 0
    ds_write_b32 v12, v14
    ds_write_b32 v13, v14
    v_and_b32 v14, 15, v1
    v_lshrrev_b32 v15, 4, v1
    v_lshrrev_b32 v232, 1, v14
    v_mul_u32_u24 v233, 1152, v14
    v_xor_b32 v14, v15, v232
    v_lshl_add_u32 v4, v14, 4, v233
    v_xor_b32 v14, 4, v14
    v_lshl_add_u32 v5, v14, 4, v233
    v_add_u32 v6, 73728, v4
    v_add_u32 v7, 73728, v5
    s_mul_i32 s53, s26, 9
    v_add_u32 v233, 73728, v233
    v_add_u32 v14, s53, v15
    v_xor_b32 v14, v14, v232
    v_lshl_add_u32 v8, v14, 4, v233
    s_add_u32 s53, s53, 4
    v_add_u32 v14, s53, v15
    v_xor_b32 v14, v14, v232
    v_lshl_add_u32 v9, v14, 4, v233
    s_add_u32 s53, s53, 4
    v_xor_b32 v14, s53, v232
    v_lshl_add_u32 v14, v14, 4, v233
    v_lshl_add_u32 v10, v15, 2, v14
    v_mov_b32 v11, 0xc0135761
    s_mov_b32 s57, 0xbdd2d3e8
    s_waitcnt vmcnt(0)
    v_mov_b32 v232, 0
    v_mov_b32 v233, 0
    v_mov_b32 v234, 0
    v_mov_b32 v235, 0
    v_mov_b32 v236, 0x3f803f80
    v_dot2c_f32_bf16 v232, v132, v236
    v_dot2c_f32_bf16 v234, v132, v132
    v_dot2c_f32_bf16 v233, v133, v236
    v_dot2c_f32_bf16 v235, v133, v133
    v_dot2c_f32_bf16 v232, v134, v236
    v_dot2c_f32_bf16 v234, v134, v134
    v_dot2c_f32_bf16 v233, v135, v236
    v_dot2c_f32_bf16 v235, v135, v135
    v_dot2c_f32_bf16 v232, v136, v236
    v_dot2c_f32_bf16 v234, v136, v136
    v_dot2c_f32_bf16 v233, v137, v236
    v_dot2c_f32_bf16 v235, v137, v137
    v_dot2c_f32_bf16 v232, v138, v236
    v_dot2c_f32_bf16 v234, v138, v138
    v_dot2c_f32_bf16 v233, v139, v236
    v_dot2c_f32_bf16 v235, v139, v139
    v_dot2c_f32_bf16 v232, v140, v236
    v_dot2c_f32_bf16 v234, v140, v140
    v_dot2c_f32_bf16 v233, v141, v236
    v_dot2c_f32_bf16 v235, v141, v141
    v_dot2c_f32_bf16 v232, v142, v236
    v_dot2c_f32_bf16 v234, v142, v142
    v_dot2c_f32_bf16 v233, v143, v236
    v_dot2c_f32_bf16 v235, v143, v143
    v_dot2c_f32_bf16 v232, v144, v236
    v_dot2c_f32_bf16 v234, v144, v144
    v_dot2c_f32_bf16 v233, v145, v236
    v_dot2c_f32_bf16 v235, v145, v145
    v_dot2c_f32_bf16 v232, v146, v236
    v_dot2c_f32_bf16 v234, v146, v146
    v_dot2c_f32_bf16 v233, v147, v236
    v_dot2c_f32_bf16 v235, v147, v147
    v_dot2c_f32_bf16 v232, v148, v236
    v_dot2c_f32_bf16 v234, v148, v148
    v_dot2c_f32_bf16 v233, v149, v236
    v_dot2c_f32_bf16 v235, v149, v149
    v_dot2c_f32_bf16 v232, v150, v236
    v_dot2c_f32_bf16 v234, v150, v150
    v_dot2c_f32_bf16 v233, v151, v236
    v_dot2c_f32_bf16 v235, v151, v151
    v_dot2c_f32_bf16 v232, v152, v236
    v_dot2c_f32_bf16 v234, v152, v152
    v_dot2c_f32_bf16 v233, v153, v236
    v_dot2c_f32_bf16 v235, v153, v153
    v_dot2c_f32_bf16 v232, v154, v236
    v_dot2c_f32_bf16 v234, v154, v154
    v_dot2c_f32_bf16 v233, v155, v236
    v_dot2c_f32_bf16 v235, v155, v155
    v_dot2c_f32_bf16 v232, v156, v236
    v_dot2c_f32_bf16 v234, v156, v156
    v_dot2c_f32_bf16 v233, v157, v236
    v_dot2c_f32_bf16 v235, v157, v157
    v_dot2c_f32_bf16 v232, v158, v236
    v_dot2c_f32_bf16 v234, v158, v158
    v_dot2c_f32_bf16 v233, v159, v236
    v_dot2c_f32_bf16 v235, v159, v159
    v_dot2c_f32_bf16 v232, v160, v236
    v_dot2c_f32_bf16 v234, v160, v160
    v_dot2c_f32_bf16 v233, v161, v236
    v_dot2c_f32_bf16 v235, v161, v161
    v_dot2c_f32_bf16 v232, v162, v236
    v_dot2c_f32_bf16 v234, v162, v162
    v_dot2c_f32_bf16 v233, v163, v236
    v_dot2c_f32_bf16 v235, v163, v163
    v_dot2c_f32_bf16 v232, v164, v236
    v_dot2c_f32_bf16 v234, v164, v164
    v_dot2c_f32_bf16 v233, v165, v236
    v_dot2c_f32_bf16 v235, v165, v165
    v_dot2c_f32_bf16 v232, v166, v236
    v_dot2c_f32_bf16 v234, v166, v166
    v_dot2c_f32_bf16 v233, v167, v236
    v_dot2c_f32_bf16 v235, v167, v167
    s_nop 3
    v_add_f32 v232, v232, v233
    v_add_f32 v234, v234, v235
    s_nop 1
    v_add_f32_dpp v232, v232, v232 quad_perm:[1,0,3,2] row_mask:0xf bank_mask:0xf
    v_add_f32_dpp v234, v234, v234 quad_perm:[1,0,3,2] row_mask:0xf bank_mask:0xf
    s_nop 1
    v_add_f32_dpp v232, v232, v232 quad_perm:[2,3,0,1] row_mask:0xf bank_mask:0xf
    v_add_f32_dpp v234, v234, v234 quad_perm:[2,3,0,1] row_mask:0xf bank_mask:0xf
    s_nop 1
    v_add_f32_dpp v232, v232, v232 row_half_mirror row_mask:0xf bank_mask:0xf
    v_add_f32_dpp v234, v234, v234 row_half_mirror row_mask:0xf bank_mask:0xf
    v_mul_f32 v232, 0x3ae38e39, v232
    v_mul_f32 v234, 0x3ae38e39, v234
    v_fma_f32 v234, -v232, v232, v234
    v_max_f32 v234, 0, v234
    v_add_f32 v234, 0x3727c5ac, v234
    v_rsq_f32 v234, v234
    s_nop 0
    v_mul_f32 v232, v232, v234
    v_sub_f32 v232, 0, v232
    v_lshlrev_b32 v240, 16, v132
    v_and_b32 v241, 0xffff0000, v132
    v_lshlrev_b32 v242, 16, v133
    v_and_b32 v243, 0xffff0000, v133
    v_lshlrev_b32 v244, 16, v134
    v_and_b32 v245, 0xffff0000, v134
    v_lshlrev_b32 v246, 16, v135
    v_and_b32 v247, 0xffff0000, v135
    v_fma_f32 v240, v240, v234, v232
    v_fma_f32 v241, v241, v234, v232
    v_fma_f32 v242, v242, v234, v232
    v_fma_f32 v243, v243, v234, v232
    v_fma_f32 v244, v244, v234, v232
    v_fma_f32 v245, v245, v234, v232
    v_fma_f32 v246, v246, v234, v232
    v_fma_f32 v247, v247, v234, v232
    v_cvt_pk_bf16_f32 v132, v240, v241
    v_cvt_pk_bf16_f32 v133, v242, v243
    v_cvt_pk_bf16_f32 v134, v244, v245
    v_cvt_pk_bf16_f32 v135, v246, v247
    v_lshlrev_b32 v240, 16, v136
    v_and_b32 v241, 0xffff0000, v136
    v_lshlrev_b32 v242, 16, v137
    v_and_b32 v243, 0xffff0000, v137
    v_lshlrev_b32 v244, 16, v138
    v_and_b32 v245, 0xffff0000, v138
    v_lshlrev_b32 v246, 16, v139
    v_and_b32 v247, 0xffff0000, v139
    v_fma_f32 v240, v240, v234, v232
    v_fma_f32 v241, v241, v234, v232
    v_fma_f32 v242, v242, v234, v232
    v_fma_f32 v243, v243, v234, v232
    v_fma_f32 v244, v244, v234, v232
    v_fma_f32 v245, v245, v234, v232
    v_fma_f32 v246, v246, v234, v232
    v_fma_f32 v247, v247, v234, v232
    v_cvt_pk_bf16_f32 v136, v240, v241
    v_cvt_pk_bf16_f32 v137, v242, v243
    v_cvt_pk_bf16_f32 v138, v244, v245
    v_cvt_pk_bf16_f32 v139, v246, v247
    v_lshlrev_b32 v240, 16, v140
    v_and_b32 v241, 0xffff0000, v140
    v_lshlrev_b32 v242, 16, v141
    v_and_b32 v243, 0xffff0000, v141
    v_lshlrev_b32 v244, 16, v142
    v_and_b32 v245, 0xffff0000, v142
    v_lshlrev_b32 v246, 16, v143
    v_and_b32 v247, 0xffff0000, v143
    v_fma_f32 v240, v240, v234, v232
    v_fma_f32 v241, v241, v234, v232
    v_fma_f32 v242, v242, v234, v232
    v_fma_f32 v243, v243, v234, v232
    v_fma_f32 v244, v244, v234, v232
    v_fma_f32 v245, v245, v234, v232
    v_fma_f32 v246, v246, v234, v232
    v_fma_f32 v247, v247, v234, v232
    v_cvt_pk_bf16_f32 v140, v240, v241
    v_cvt_pk_bf16_f32 v141, v242, v243
    v_cvt_pk_bf16_f32 v142, v244, v245
    v_cvt_pk_bf16_f32 v143, v246, v247
    v_lshlrev_b32 v240, 16, v144
    v_and_b32 v241, 0xffff0000, v144
    v_lshlrev_b32 v242, 16, v145
    v_and_b32 v243, 0xffff0000, v145
    v_lshlrev_b32 v244, 16, v146
    v_and_b32 v245, 0xffff0000, v146
    v_lshlrev_b32 v246, 16, v147
    v_and_b32 v247, 0xffff0000, v147
    v_fma_f32 v240, v240, v234, v232
    v_fma_f32 v241, v241, v234, v232
    v_fma_f32 v242, v242, v234, v232
    v_fma_f32 v243, v243, v234, v232
    v_fma_f32 v244, v244, v234, v232
    v_fma_f32 v245, v245, v234, v232
    v_fma_f32 v246, v246, v234, v232
    v_fma_f32 v247, v247, v234, v232
    v_cvt_pk_bf16_f32 v144, v240, v241
    v_cvt_pk_bf16_f32 v145, v242, v243
    v_cvt_pk_bf16_f32 v146, v244, v245
    v_cvt_pk_bf16_f32 v147, v246, v247
    v_lshlrev_b32 v240, 16, v148
    v_and_b32 v241, 0xffff0000, v148
    v_lshlrev_b32 v242, 16, v149
    v_and_b32 v243, 0xffff0000, v149
    v_lshlrev_b32 v244, 16, v150
    v_and_b32 v245, 0xffff0000, v150
    v_lshlrev_b32 v246, 16, v151
    v_and_b32 v247, 0xffff0000, v151
    v_fma_f32 v240, v240, v234, v232
    v_fma_f32 v241, v241, v234, v232
    v_fma_f32 v242, v242, v234, v232
    v_fma_f32 v243, v243, v234, v232
    v_fma_f32 v244, v244, v234, v232
    v_fma_f32 v245, v245, v234, v232
    v_fma_f32 v246, v246, v234, v232
    v_fma_f32 v247, v247, v234, v232
    v_cvt_pk_bf16_f32 v148, v240, v241
    v_cvt_pk_bf16_f32 v149, v242, v243
    v_cvt_pk_bf16_f32 v150, v244, v245
    v_cvt_pk_bf16_f32 v151, v246, v247
    v_lshlrev_b32 v240, 16, v152
    v_and_b32 v241, 0xffff0000, v152
    v_lshlrev_b32 v242, 16, v153
    v_and_b32 v243, 0xffff0000, v153
    v_lshlrev_b32 v244, 16, v154
    v_and_b32 v245, 0xffff0000, v154
    v_lshlrev_b32 v246, 16, v155
    v_and_b32 v247, 0xffff0000, v155
    v_fma_f32 v240, v240, v234, v232
    v_fma_f32 v241, v241, v234, v232
    v_fma_f32 v242, v242, v234, v232
    v_fma_f32 v243, v243, v234, v232
    v_fma_f32 v244, v244, v234, v232
    v_fma_f32 v245, v245, v234, v232
    v_fma_f32 v246, v246, v234, v232
    v_fma_f32 v247, v247, v234, v232
    v_cvt_pk_bf16_f32 v152, v240, v241
    v_cvt_pk_bf16_f32 v153, v242, v243
    v_cvt_pk_bf16_f32 v154, v244, v245
    v_cvt_pk_bf16_f32 v155, v246, v247
    v_lshlrev_b32 v240, 16, v156
    v_and_b32 v241, 0xffff0000, v156
    v_lshlrev_b32 v242, 16, v157
    v_and_b32 v243, 0xffff0000, v157
    v_lshlrev_b32 v244, 16, v158
    v_and_b32 v245, 0xffff0000, v158
    v_lshlrev_b32 v246, 16, v159
    v_and_b32 v247, 0xffff0000, v159
    v_fma_f32 v240, v240, v234, v232
    v_fma_f32 v241, v241, v234, v232
    v_fma_f32 v242, v242, v234, v232
    v_fma_f32 v243, v243, v234, v232
    v_fma_f32 v244, v244, v234, v232
    v_fma_f32 v245, v245, v234, v232
    v_fma_f32 v246, v246, v234, v232
    v_fma_f32 v247, v247, v234, v232
    v_cvt_pk_bf16_f32 v156, v240, v241
    v_cvt_pk_bf16_f32 v157, v242, v243
    v_cvt_pk_bf16_f32 v158, v244, v245
    v_cvt_pk_bf16_f32 v159, v246, v247
    v_lshlrev_b32 v240, 16, v160
    v_and_b32 v241, 0xffff0000, v160
    v_lshlrev_b32 v242, 16, v161
    v_and_b32 v243, 0xffff0000, v161
    v_lshlrev_b32 v244, 16, v162
    v_and_b32 v245, 0xffff0000, v162
    v_lshlrev_b32 v246, 16, v163
    v_and_b32 v247, 0xffff0000, v163
    v_fma_f32 v240, v240, v234, v232
    v_fma_f32 v241, v241, v234, v232
    v_fma_f32 v242, v242, v234, v232
    v_fma_f32 v243, v243, v234, v232
    v_fma_f32 v244, v244, v234, v232
    v_fma_f32 v245, v245, v234, v232
    v_fma_f32 v246, v246, v234, v232
    v_fma_f32 v247, v247, v234, v232
    v_cvt_pk_bf16_f32 v160, v240, v241
    v_cvt_pk_bf16_f32 v161, v242, v243
    v_cvt_pk_bf16_f32 v162, v244, v245
    v_cvt_pk_bf16_f32 v163, v246, v247
    v_lshlrev_b32 v240, 16, v164
    v_and_b32 v241, 0xffff0000, v164
    v_lshlrev_b32 v242, 16, v165
    v_and_b32 v243, 0xffff0000, v165
    v_lshlrev_b32 v244, 16, v166
    v_and_b32 v245, 0xffff0000, v166
    v_lshlrev_b32 v246, 16, v167
    v_and_b32 v247, 0xffff0000, v167
    v_fma_f32 v240, v240, v234, v232
    v_fma_f32 v241, v241, v234, v232
    v_fma_f32 v242, v242, v234, v232
    v_fma_f32 v243, v243, v234, v232
    v_fma_f32 v244, v244, v234, v232
    v_fma_f32 v245, v245, v234, v232
    v_fma_f32 v246, v246, v234, v232
    v_fma_f32 v247, v247, v234, v232
    v_cvt_pk_bf16_f32 v164, v240, v241
    v_cvt_pk_bf16_f32 v165, v242, v243
    v_cvt_pk_bf16_f32 v166, v244, v245
    v_cvt_pk_bf16_f32 v167, v246, v247
    ds_write_b128 v248, v[132:135] offset:0
    ds_write_b128 v248, v[136:139] offset:128
    ds_write_b128 v248, v[140:143] offset:256
    ds_write_b128 v248, v[144:147] offset:384
    ds_write_b128 v248, v[148:151] offset:512
    ds_write_b128 v248, v[152:155] offset:640
    ds_write_b128 v248, v[156:159] offset:768
    ds_write_b128 v248, v[160:163] offset:896
    ds_write_b128 v248, v[164:167] offset:1024
    s_waitcnt lgkmcnt(0)
    s_barrier
    ds_read_b128 v[16:19], v4 offset:0
    ds_read_b128 v[20:23], v4 offset:18432
    ds_read_b128 v[24:27], v4 offset:36864
    ds_read_b128 v[28:31], v4 offset:55296
    s_cmp_lt_u32 s26, 4
    s_cbranch_scc1 ap13a
    s_setprio 1
    s_branch ap13b
ap13a:
    s_setprio 0
ap13b:
    s_waitcnt vmcnt(20) lgkmcnt(0)
    v_mfma_f32_16x16x32_bf16 v[132:135], v[48:51], v[16:19], 0
    ds_read_b128 v[32:35], v5 offset:0
    v_mfma_f32_16x16x32_bf16 v[136:139], v[48:51], v[20:23], 0
    ds_read_b128 v[36:39], v5 offset:18432
    v_mfma_f32_16x16x32_bf16 v[140:143], v[48:51], v[24:27], 0
    ds_read_b128 v[40:43], v5 offset:36864
    v_mfma_f32_16x16x32_bf16 v[144:147], v[48:51], v[28:31], 0
    ds_read_b128 v[44:47], v5 offset:55296
    buffer_load_dwordx4 v[48:51], v2, s[36:39], s52 offen offset:1024
    s_waitcnt vmcnt(20)
    v_mfma_f32_16x16x32_bf16 v[148:151], v[52:55], v[16:19], 0
    v_mfma_f32_16x16x32_bf16 v[152:155], v[52:55], v[20:23], 0
    v_mfma_f32_16x16x32_bf16 v[156:159], v[52:55], v[24:27], 0
    v_mfma_f32_16x16x32_bf16 v[160:163], v[52:55], v[28:31], 0
    buffer_load_dwordx4 v[52:55], v2, s[36:39], s52 offen offset:2048
    s_waitcnt vmcnt(20)
    v_mfma_f32_16x16x32_bf16 v[164:167], v[56:59], v[16:19], 0
    v_mfma_f32_16x16x32_bf16 v[168:171], v[56:59], v[20:23], 0
    v_mfma_f32_16x16x32_bf16 v[172:175], v[56:59], v[24:27], 0
    v_mfma_f32_16x16x32_bf16 v[176:179], v[56:59], v[28:31], 0
    buffer_load_dwordx4 v[56:59], v2, s[36:39], s52 offen offset:3072
    s_waitcnt vmcnt(20)
    v_mfma_f32_16x16x32_bf16 v[180:183], v[60:63], v[16:19], 0
    v_mfma_f32_16x16x32_bf16 v[184:187], v[60:63], v[20:23], 0
    v_mfma_f32_16x16x32_bf16 v[188:191], v[60:63], v[24:27], 0
    v_mfma_f32_16x16x32_bf16 v[192:195], v[60:63], v[28:31], 0
    s_add_u32 s52, s52, 4096
    buffer_load_dwordx4 v[60:63], v2, s[36:39], s52 offen offset:0
    s_waitcnt vmcnt(20) lgkmcnt(0)
    v_mfma_f32_16x16x32_bf16 v[132:135], v[64:67], v[32:35], v[132:135]
    ds_read_b128 v[16:19], v4 offset:128
    v_mfma_f32_16x16x32_bf16 v[136:139], v[64:67], v[36:39], v[136:139]
    ds_read_b128 v[20:23], v4 offset:18560
    v_mfma_f32_16x16x32_bf16 v[140:143], v[64:67], v[40:43], v[140:143]
    ds_read_b128 v[24:27], v4 offset:36992
    v_mfma_f32_16x16x32_bf16 v[144:147], v[64:67], v[44:47], v[144:147]
    ds_read_b128 v[28:31], v4 offset:55424
    buffer_load_dwordx4 v[64:67], v2, s[36:39], s52 offen offset:1024
    s_waitcnt vmcnt(20)
    v_mfma_f32_16x16x32_bf16 v[148:151], v[68:71], v[32:35], v[148:151]
    v_mfma_f32_16x16x32_bf16 v[152:155], v[68:71], v[36:39], v[152:155]
    v_mfma_f32_16x16x32_bf16 v[156:159], v[68:71], v[40:43], v[156:159]
    v_mfma_f32_16x16x32_bf16 v[160:163], v[68:71], v[44:47], v[160:163]
    buffer_load_dwordx4 v[68:71], v2, s[36:39], s52 offen offset:2048
    s_waitcnt vmcnt(20)
    v_mfma_f32_16x16x32_bf16 v[164:167], v[72:75], v[32:35], v[164:167]
    v_mfma_f32_16x16x32_bf16 v[168:171], v[72:75], v[36:39], v[168:171]
    v_mfma_f32_16x16x32_bf16 v[172:175], v[72:75], v[40:43], v[172:175]
    v_mfma_f32_16x16x32_bf16 v[176:179], v[72:75], v[44:47], v[176:179]
    buffer_load_dwordx4 v[72:75], v2, s[36:39], s52 offen offset:3072
    s_waitcnt vmcnt(20)
    v_mfma_f32_16x16x32_bf16 v[180:183], v[76:79], v[32:35], v[180:183]
    v_mfma_f32_16x16x32_bf16 v[184:187], v[76:79], v[36:39], v[184:187]
    v_mfma_f32_16x16x32_bf16 v[188:191], v[76:79], v[40:43], v[188:191]
    v_mfma_f32_16x16x32_bf16 v[192:195], v[76:79], v[44:47], v[192:195]
    s_add_u32 s52, s52, 4096
    buffer_load_dwordx4 v[76:79], v2, s[36:39], s52 offen offset:0
    s_waitcnt vmcnt(20) lgkmcnt(0)
    v_mfma_f32_16x16x32_bf16 v[132:135], v[80:83], v[16:19], v[132:135]
    ds_read_b128 v[32:35], v5 offset:128
    v_mfma_f32_16x16x32_bf16 v[136:139], v[80:83], v[20:23], v[136:139]
    ds_read_b128 v[36:39], v5 offset:18560
    v_mfma_f32_16x16x32_bf16 v[140:143], v[80:83], v[24:27], v[140:143]
    ds_read_b128 v[40:43], v5 offset:36992
    v_mfma_f32_16x16x32_bf16 v[144:147], v[80:83], v[28:31], v[144:147]
    ds_read_b128 v[44:47], v5 offset:55424
    buffer_load_dwordx4 v[80:83], v2, s[36:39], s52 offen offset:1024
    s_waitcnt vmcnt(20)
    v_mfma_f32_16x16x32_bf16 v[148:151], v[84:87], v[16:19], v[148:151]
    v_mfma_f32_16x16x32_bf16 v[152:155], v[84:87], v[20:23], v[152:155]
    v_mfma_f32_16x16x32_bf16 v[156:159], v[84:87], v[24:27], v[156:159]
    v_mfma_f32_16x16x32_bf16 v[160:163], v[84:87], v[28:31], v[160:163]
    buffer_load_dwordx4 v[84:87], v2, s[36:39], s52 offen offset:2048
    s_waitcnt vmcnt(20)
    v_mfma_f32_16x16x32_bf16 v[164:167], v[88:91], v[16:19], v[164:167]
    v_mfma_f32_16x16x32_bf16 v[168:171], v[88:91], v[20:23], v[168:171]
    v_mfma_f32_16x16x32_bf16 v[172:175], v[88:91], v[24:27], v[172:175]
    v_mfma_f32_16x16x32_bf16 v[176:179], v[88:91], v[28:31], v[176:179]
    buffer_load_dwordx4 v[88:91], v2, s[36:39], s52 offen offset:3072
    s_waitcnt vmcnt(20)
    v_mfma_f32_16x16x32_bf16 v[180:183], v[92:95], v[16:19], v[180:183]
    v_mfma_f32_16x16x32_bf16 v[184:187], v[92:95], v[20:23], v[184:187]
    v_mfma_f32_16x16x32_bf16 v[188:191], v[92:95], v[24:27], v[188:191]
    v_mfma_f32_16x16x32_bf16 v[192:195], v[92:95], v[28:31], v[192:195]
    s_add_u32 s52, s52, 4096
    buffer_load_dwordx4 v[92:95], v2, s[36:39], s52 offen offset:0
    s_cmp_lt_u32 s26, 4
    s_cbranch_scc1 ap14a
    s_setprio 0
    s_branch ap14b
ap14a:
    s_setprio 1
ap14b:
    s_waitcnt vmcnt(20) lgkmcnt(0)
    v_mfma_f32_16x16x32_bf16 v[132:135], v[96:99], v[32:35], v[132:135]
    ds_read_b128 v[16:19], v4 offset:256
    v_mfma_f32_16x16x32_bf16 v[136:139], v[96:99], v[36:39], v[136:139]
    ds_read_b128 v[20:23], v4 offset:18688
    v_mfma_f32_16x16x32_bf16 v[140:143], v[96:99], v[40:43], v[140:143]
    ds_read_b128 v[24:27], v4 offset:37120
    v_mfma_f32_16x16x32_bf16 v[144:147], v[96:99], v[44:47], v[144:147]
    ds_read_b128 v[28:31], v4 offset:55552
    buffer_load_dwordx4 v[96:99], v2, s[36:39], s52 offen offset:1024
    s_waitcnt vmcnt(20)
    v_mfma_f32_16x16x32_bf16 v[148:151], v[100:103], v[32:35], v[148:151]
    v_mfma_f32_16x16x32_bf16 v[152:155], v[100:103], v[36:39], v[152:155]
    v_mfma_f32_16x16x32_bf16 v[156:159], v[100:103], v[40:43], v[156:159]
    v_mfma_f32_16x16x32_bf16 v[160:163], v[100:103], v[44:47], v[160:163]
    buffer_load_dwordx4 v[100:103], v2, s[36:39], s52 offen offset:2048
    s_waitcnt vmcnt(20)
    v_mfma_f32_16x16x32_bf16 v[164:167], v[104:107], v[32:35], v[164:167]
    v_mfma_f32_16x16x32_bf16 v[168:171], v[104:107], v[36:39], v[168:171]
    v_mfma_f32_16x16x32_bf16 v[172:175], v[104:107], v[40:43], v[172:175]
    v_mfma_f32_16x16x32_bf16 v[176:179], v[104:107], v[44:47], v[176:179]
    buffer_load_dwordx4 v[104:107], v2, s[36:39], s52 offen offset:3072
    s_waitcnt vmcnt(20)
    v_mfma_f32_16x16x32_bf16 v[180:183], v[108:111], v[32:35], v[180:183]
    v_mfma_f32_16x16x32_bf16 v[184:187], v[108:111], v[36:39], v[184:187]
    v_mfma_f32_16x16x32_bf16 v[188:191], v[108:111], v[40:43], v[188:191]
    v_mfma_f32_16x16x32_bf16 v[192:195], v[108:111], v[44:47], v[192:195]
    s_add_u32 s52, s52, 4096
    buffer_load_dwordx4 v[108:111], v2, s[36:39], s52 offen offset:0
    s_waitcnt vmcnt(20) lgkmcnt(0)
    v_mfma_f32_16x16x32_bf16 v[132:135], v[112:115], v[16:19], v[132:135]
    ds_read_b128 v[32:35], v5 offset:256
    v_mfma_f32_16x16x32_bf16 v[136:139], v[112:115], v[20:23], v[136:139]
    ds_read_b128 v[36:39], v5 offset:18688
    v_mfma_f32_16x16x32_bf16 v[140:143], v[112:115], v[24:27], v[140:143]
    ds_read_b128 v[40:43], v5 offset:37120
    v_mfma_f32_16x16x32_bf16 v[144:147], v[112:115], v[28:31], v[144:147]
    ds_read_b128 v[44:47], v5 offset:55552
    buffer_load_dwordx4 v[112:115], v2, s[36:39], s52 offen offset:1024
    s_waitcnt vmcnt(20)
    v_mfma_f32_16x16x32_bf16 v[148:151], v[116:119], v[16:19], v[148:151]
    v_mfma_f32_16x16x32_bf16 v[152:155], v[116:119], v[20:23], v[152:155]
    v_mfma_f32_16x16x32_bf16 v[156:159], v[116:119], v[24:27], v[156:159]
    v_mfma_f32_16x16x32_bf16 v[160:163], v[116:119], v[28:31], v[160:163]
    buffer_load_dwordx4 v[116:119], v2, s[36:39], s52 offen offset:2048
    s_waitcnt vmcnt(20)
    v_mfma_f32_16x16x32_bf16 v[164:167], v[120:123], v[16:19], v[164:167]
    v_mfma_f32_16x16x32_bf16 v[168:171], v[120:123], v[20:23], v[168:171]
    v_mfma_f32_16x16x32_bf16 v[172:175], v[120:123], v[24:27], v[172:175]
    v_mfma_f32_16x16x32_bf16 v[176:179], v[120:123], v[28:31], v[176:179]
    buffer_load_dwordx4 v[120:123], v2, s[36:39], s52 offen offset:3072
    s_waitcnt vmcnt(20)
    v_mfma_f32_16x16x32_bf16 v[180:183], v[124:127], v[16:19], v[180:183]
    v_mfma_f32_16x16x32_bf16 v[184:187], v[124:127], v[20:23], v[184:187]
    v_mfma_f32_16x16x32_bf16 v[188:191], v[124:127], v[24:27], v[188:191]
    v_mfma_f32_16x16x32_bf16 v[192:195], v[124:127], v[28:31], v[192:195]
    s_add_u32 s52, s52, 4096
    buffer_load_dwordx4 v[124:127], v2, s[36:39], s52 offen offset:0
    s_waitcnt vmcnt(20) lgkmcnt(0)
    v_mfma_f32_16x16x32_bf16 v[132:135], v[128:131], v[32:35], v[132:135]
    ds_read_b128 v[16:19], v4 offset:384
    v_mfma_f32_16x16x32_bf16 v[136:139], v[128:131], v[36:39], v[136:139]
    ds_read_b128 v[20:23], v4 offset:18816
    v_mfma_f32_16x16x32_bf16 v[140:143], v[128:131], v[40:43], v[140:143]
    ds_read_b128 v[24:27], v4 offset:37248
    v_mfma_f32_16x16x32_bf16 v[144:147], v[128:131], v[44:47], v[144:147]
    ds_read_b128 v[28:31], v4 offset:55680
    buffer_load_dwordx4 v[128:131], v2, s[36:39], s52 offen offset:1024
    s_waitcnt vmcnt(20)
    v_mfma_f32_16x16x32_bf16 v[148:151], v[48:51], v[32:35], v[148:151]
    v_mfma_f32_16x16x32_bf16 v[152:155], v[48:51], v[36:39], v[152:155]
    v_mfma_f32_16x16x32_bf16 v[156:159], v[48:51], v[40:43], v[156:159]
    v_mfma_f32_16x16x32_bf16 v[160:163], v[48:51], v[44:47], v[160:163]
    buffer_load_dwordx4 v[48:51], v2, s[36:39], s52 offen offset:2048
    s_waitcnt vmcnt(20)
    v_mfma_f32_16x16x32_bf16 v[164:167], v[52:55], v[32:35], v[164:167]
    v_mfma_f32_16x16x32_bf16 v[168:171], v[52:55], v[36:39], v[168:171]
    v_mfma_f32_16x16x32_bf16 v[172:175], v[52:55], v[40:43], v[172:175]
    v_mfma_f32_16x16x32_bf16 v[176:179], v[52:55], v[44:47], v[176:179]
    buffer_load_dwordx4 v[52:55], v2, s[36:39], s52 offen offset:3072
    s_waitcnt vmcnt(20)
    v_mfma_f32_16x16x32_bf16 v[180:183], v[56:59], v[32:35], v[180:183]
    v_mfma_f32_16x16x32_bf16 v[184:187], v[56:59], v[36:39], v[184:187]
    v_mfma_f32_16x16x32_bf16 v[188:191], v[56:59], v[40:43], v[188:191]
    v_mfma_f32_16x16x32_bf16 v[192:195], v[56:59], v[44:47], v[192:195]
    s_add_u32 s52, s52, 4096
    buffer_load_dwordx4 v[56:59], v2, s[36:39], s52 offen offset:0
    s_cmp_lt_u32 s26, 4
    s_cbranch_scc1 ap15a
    s_setprio 1
    s_branch ap15b
ap15a:
    s_setprio 0
ap15b:
    s_waitcnt vmcnt(20) lgkmcnt(0)
    v_mfma_f32_16x16x32_bf16 v[132:135], v[60:63], v[16:19], v[132:135]
    ds_read_b128 v[32:35], v5 offset:384
    v_mfma_f32_16x16x32_bf16 v[136:139], v[60:63], v[20:23], v[136:139]
    ds_read_b128 v[36:39], v5 offset:18816
    v_mfma_f32_16x16x32_bf16 v[140:143], v[60:63], v[24:27], v[140:143]
    ds_read_b128 v[40:43], v5 offset:37248
    v_mfma_f32_16x16x32_bf16 v[144:147], v[60:63], v[28:31], v[144:147]
    ds_read_b128 v[44:47], v5 offset:55680
    buffer_load_dwordx4 v[60:63], v2, s[36:39], s52 offen offset:1024
    s_waitcnt vmcnt(20)
    v_mfma_f32_16x16x32_bf16 v[148:151], v[64:67], v[16:19], v[148:151]
    v_mfma_f32_16x16x32_bf16 v[152:155], v[64:67], v[20:23], v[152:155]
    v_mfma_f32_16x16x32_bf16 v[156:159], v[64:67], v[24:27], v[156:159]
    v_mfma_f32_16x16x32_bf16 v[160:163], v[64:67], v[28:31], v[160:163]
    buffer_load_dwordx4 v[64:67], v2, s[36:39], s52 offen offset:2048
    s_waitcnt vmcnt(20)
    v_mfma_f32_16x16x32_bf16 v[164:167], v[68:71], v[16:19], v[164:167]
    v_mfma_f32_16x16x32_bf16 v[168:171], v[68:71], v[20:23], v[168:171]
    v_mfma_f32_16x16x32_bf16 v[172:175], v[68:71], v[24:27], v[172:175]
    v_mfma_f32_16x16x32_bf16 v[176:179], v[68:71], v[28:31], v[176:179]
    buffer_load_dwordx4 v[68:71], v2, s[36:39], s52 offen offset:3072
    s_waitcnt vmcnt(20)
    v_mfma_f32_16x16x32_bf16 v[180:183], v[72:75], v[16:19], v[180:183]
    v_mfma_f32_16x16x32_bf16 v[184:187], v[72:75], v[20:23], v[184:187]
    v_mfma_f32_16x16x32_bf16 v[188:191], v[72:75], v[24:27], v[188:191]
    v_mfma_f32_16x16x32_bf16 v[192:195], v[72:75], v[28:31], v[192:195]
    s_add_u32 s52, s52, 4096
    buffer_load_dwordx4 v[72:75], v2, s[36:39], s52 offen offset:0
    s_waitcnt vmcnt(20) lgkmcnt(0)
    v_mfma_f32_16x16x32_bf16 v[132:135], v[76:79], v[32:35], v[132:135]
    ds_read_b128 v[16:19], v4 offset:512
    v_mfma_f32_16x16x32_bf16 v[136:139], v[76:79], v[36:39], v[136:139]
    ds_read_b128 v[20:23], v4 offset:18944
    v_mfma_f32_16x16x32_bf16 v[140:143], v[76:79], v[40:43], v[140:143]
    ds_read_b128 v[24:27], v4 offset:37376
    v_mfma_f32_16x16x32_bf16 v[144:147], v[76:79], v[44:47], v[144:147]
    ds_read_b128 v[28:31], v4 offset:55808
    buffer_load_dwordx4 v[76:79], v2, s[36:39], s52 offen offset:1024
    s_waitcnt vmcnt(20)
    v_mfma_f32_16x16x32_bf16 v[148:151], v[80:83], v[32:35], v[148:151]
    v_mfma_f32_16x16x32_bf16 v[152:155], v[80:83], v[36:39], v[152:155]
    v_mfma_f32_16x16x32_bf16 v[156:159], v[80:83], v[40:43], v[156:159]
    v_mfma_f32_16x16x32_bf16 v[160:163], v[80:83], v[44:47], v[160:163]
    buffer_load_dwordx4 v[80:83], v2, s[36:39], s52 offen offset:2048
    s_waitcnt vmcnt(20)
    v_mfma_f32_16x16x32_bf16 v[164:167], v[84:87], v[32:35], v[164:167]
    v_mfma_f32_16x16x32_bf16 v[168:171], v[84:87], v[36:39], v[168:171]
    v_mfma_f32_16x16x32_bf16 v[172:175], v[84:87], v[40:43], v[172:175]
    v_mfma_f32_16x16x32_bf16 v[176:179], v[84:87], v[44:47], v[176:179]
    buffer_load_dwordx4 v[84:87], v2, s[36:39], s52 offen offset:3072
    s_waitcnt vmcnt(20)
    v_mfma_f32_16x16x32_bf16 v[180:183], v[88:91], v[32:35], v[180:183]
    v_mfma_f32_16x16x32_bf16 v[184:187], v[88:91], v[36:39], v[184:187]
    v_mfma_f32_16x16x32_bf16 v[188:191], v[88:91], v[40:43], v[188:191]
    v_mfma_f32_16x16x32_bf16 v[192:195], v[88:91], v[44:47], v[192:195]
    s_add_u32 s52, s52, 4096
    buffer_load_dwordx4 v[88:91], v2, s[36:39], s52 offen offset:0
    s_waitcnt vmcnt(20) lgkmcnt(0)
    v_mfma_f32_16x16x32_bf16 v[132:135], v[92:95], v[16:19], v[132:135]
    ds_read_b128 v[32:35], v5 offset:512
    v_mfma_f32_16x16x32_bf16 v[136:139], v[92:95], v[20:23], v[136:139]
    ds_read_b128 v[36:39], v5 offset:18944
    v_mfma_f32_16x16x32_bf16 v[140:143], v[92:95], v[24:27], v[140:143]
    ds_read_b128 v[40:43], v5 offset:37376
    v_mfma_f32_16x16x32_bf16 v[144:147], v[92:95], v[28:31], v[144:147]
    ds_read_b128 v[44:47], v5 offset:55808
    buffer_load_dwordx4 v[92:95], v2, s[36:39], s52 offen offset:1024
    s_waitcnt vmcnt(20)
    v_mfma_f32_16x16x32_bf16 v[148:151], v[96:99], v[16:19], v[148:151]
    v_mfma_f32_16x16x32_bf16 v[152:155], v[96:99], v[20:23], v[152:155]
    v_mfma_f32_16x16x32_bf16 v[156:159], v[96:99], v[24:27], v[156:159]
    v_mfma_f32_16x16x32_bf16 v[160:163], v[96:99], v[28:31], v[160:163]
    buffer_load_dwordx4 v[96:99], v2, s[36:39], s52 offen offset:2048
    s_waitcnt vmcnt(20)
    v_mfma_f32_16x16x32_bf16 v[164:167], v[100:103], v[16:19], v[164:167]
    v_mfma_f32_16x16x32_bf16 v[168:171], v[100:103], v[20:23], v[168:171]
    v_mfma_f32_16x16x32_bf16 v[172:175], v[100:103], v[24:27], v[172:175]
    v_mfma_f32_16x16x32_bf16 v[176:179], v[100:103], v[28:31], v[176:179]
    buffer_load_dwordx4 v[100:103], v2, s[36:39], s52 offen offset:3072
    s_waitcnt vmcnt(20)
    v_mfma_f32_16x16x32_bf16 v[180:183], v[104:107], v[16:19], v[180:183]
    v_mfma_f32_16x16x32_bf16 v[184:187], v[104:107], v[20:23], v[184:187]
    v_mfma_f32_16x16x32_bf16 v[188:191], v[104:107], v[24:27], v[188:191]
    v_mfma_f32_16x16x32_bf16 v[192:195], v[104:107], v[28:31], v[192:195]
    s_add_u32 s52, s52, 4096
    buffer_load_dwordx4 v[104:107], v2, s[36:39], s52 offen offset:0
    s_cmp_lt_u32 s26, 4
    s_cbranch_scc1 ap16a
    s_setprio 0
    s_branch ap16b
ap16a:
    s_setprio 1
ap16b:
    s_waitcnt vmcnt(20) lgkmcnt(0)
    v_mfma_f32_16x16x32_bf16 v[132:135], v[108:111], v[32:35], v[132:135]
    ds_read_b128 v[16:19], v4 offset:640
    v_mfma_f32_16x16x32_bf16 v[136:139], v[108:111], v[36:39], v[136:139]
    ds_read_b128 v[20:23], v4 offset:19072
    v_mfma_f32_16x16x32_bf16 v[140:143], v[108:111], v[40:43], v[140:143]
    ds_read_b128 v[24:27], v4 offset:37504
    v_mfma_f32_16x16x32_bf16 v[144:147], v[108:111], v[44:47], v[144:147]
    ds_read_b128 v[28:31], v4 offset:55936
    buffer_load_dwordx4 v[108:111], v2, s[36:39], s52 offen offset:1024
    s_waitcnt vmcnt(20)
    v_mfma_f32_16x16x32_bf16 v[148:151], v[112:115], v[32:35], v[148:151]
    v_mfma_f32_16x16x32_bf16 v[152:155], v[112:115], v[36:39], v[152:155]
    v_mfma_f32_16x16x32_bf16 v[156:159], v[112:115], v[40:43], v[156:159]
    v_mfma_f32_16x16x32_bf16 v[160:163], v[112:115], v[44:47], v[160:163]
    buffer_load_dwordx4 v[112:115], v2, s[36:39], s52 offen offset:2048
    s_waitcnt vmcnt(20)
    v_mfma_f32_16x16x32_bf16 v[164:167], v[116:119], v[32:35], v[164:167]
    v_mfma_f32_16x16x32_bf16 v[168:171], v[116:119], v[36:39], v[168:171]
    v_mfma_f32_16x16x32_bf16 v[172:175], v[116:119], v[40:43], v[172:175]
    v_mfma_f32_16x16x32_bf16 v[176:179], v[116:119], v[44:47], v[176:179]
    buffer_load_dwordx4 v[116:119], v2, s[36:39], s52 offen offset:3072
    s_waitcnt vmcnt(20)
    v_mfma_f32_16x16x32_bf16 v[180:183], v[120:123], v[32:35], v[180:183]
    v_mfma_f32_16x16x32_bf16 v[184:187], v[120:123], v[36:39], v[184:187]
    v_mfma_f32_16x16x32_bf16 v[188:191], v[120:123], v[40:43], v[188:191]
    v_mfma_f32_16x16x32_bf16 v[192:195], v[120:123], v[44:47], v[192:195]
    s_add_u32 s52, s52, 4096
    buffer_load_dwordx4 v[120:123], v2, s[36:39], s52 offen offset:0
    s_waitcnt vmcnt(20) lgkmcnt(0)
    v_mfma_f32_16x16x32_bf16 v[132:135], v[124:127], v[16:19], v[132:135]
    ds_read_b128 v[32:35], v5 offset:640
    v_mfma_f32_16x16x32_bf16 v[136:139], v[124:127], v[20:23], v[136:139]
    ds_read_b128 v[36:39], v5 offset:19072
    v_mfma_f32_16x16x32_bf16 v[140:143], v[124:127], v[24:27], v[140:143]
    ds_read_b128 v[40:43], v5 offset:37504
    v_mfma_f32_16x16x32_bf16 v[144:147], v[124:127], v[28:31], v[144:147]
    ds_read_b128 v[44:47], v5 offset:55936
    buffer_load_dwordx4 v[124:127], v2, s[36:39], s52 offen offset:1024
    s_waitcnt vmcnt(20)
    v_mfma_f32_16x16x32_bf16 v[148:151], v[128:131], v[16:19], v[148:151]
    v_mfma_f32_16x16x32_bf16 v[152:155], v[128:131], v[20:23], v[152:155]
    v_mfma_f32_16x16x32_bf16 v[156:159], v[128:131], v[24:27], v[156:159]
    v_mfma_f32_16x16x32_bf16 v[160:163], v[128:131], v[28:31], v[160:163]
    buffer_load_dwordx4 v[128:131], v2, s[36:39], s52 offen offset:2048
    s_waitcnt vmcnt(20)
    v_mfma_f32_16x16x32_bf16 v[164:167], v[48:51], v[16:19], v[164:167]
    v_mfma_f32_16x16x32_bf16 v[168:171], v[48:51], v[20:23], v[168:171]
    v_mfma_f32_16x16x32_bf16 v[172:175], v[48:51], v[24:27], v[172:175]
    v_mfma_f32_16x16x32_bf16 v[176:179], v[48:51], v[28:31], v[176:179]
    buffer_load_dwordx4 v[48:51], v2, s[36:39], s52 offen offset:3072
    s_waitcnt vmcnt(20)
    v_mfma_f32_16x16x32_bf16 v[180:183], v[52:55], v[16:19], v[180:183]
    v_mfma_f32_16x16x32_bf16 v[184:187], v[52:55], v[20:23], v[184:187]
    v_mfma_f32_16x16x32_bf16 v[188:191], v[52:55], v[24:27], v[188:191]
    v_mfma_f32_16x16x32_bf16 v[192:195], v[52:55], v[28:31], v[192:195]
    s_add_u32 s52, s52, 4096
    buffer_load_dwordx4 v[52:55], v2, s[36:39], s52 offen offset:0
    s_waitcnt vmcnt(20) lgkmcnt(0)
    v_mfma_f32_16x16x32_bf16 v[132:135], v[56:59], v[32:35], v[132:135]
    ds_read_b128 v[16:19], v4 offset:768
    v_mfma_f32_16x16x32_bf16 v[136:139], v[56:59], v[36:39], v[136:139]
    ds_read_b128 v[20:23], v4 offset:19200
    v_mfma_f32_16x16x32_bf16 v[140:143], v[56:59], v[40:43], v[140:143]
    ds_read_b128 v[24:27], v4 offset:37632
    v_mfma_f32_16x16x32_bf16 v[144:147], v[56:59], v[44:47], v[144:147]
    ds_read_b128 v[28:31], v4 offset:56064
    buffer_load_dwordx4 v[56:59], v2, s[36:39], s52 offen offset:1024
    s_waitcnt vmcnt(20)
    v_mfma_f32_16x16x32_bf16 v[148:151], v[60:63], v[32:35], v[148:151]
    v_mfma_f32_16x16x32_bf16 v[152:155], v[60:63], v[36:39], v[152:155]
    v_mfma_f32_16x16x32_bf16 v[156:159], v[60:63], v[40:43], v[156:159]
    v_mfma_f32_16x16x32_bf16 v[160:163], v[60:63], v[44:47], v[160:163]
    buffer_load_dwordx4 v[60:63], v2, s[36:39], s52 offen offset:2048
    s_waitcnt vmcnt(20)
    v_mfma_f32_16x16x32_bf16 v[164:167], v[64:67], v[32:35], v[164:167]
    v_mfma_f32_16x16x32_bf16 v[168:171], v[64:67], v[36:39], v[168:171]
    v_mfma_f32_16x16x32_bf16 v[172:175], v[64:67], v[40:43], v[172:175]
    v_mfma_f32_16x16x32_bf16 v[176:179], v[64:67], v[44:47], v[176:179]
    buffer_load_dwordx4 v[64:67], v2, s[36:39], s52 offen offset:3072
    s_waitcnt vmcnt(20)
    v_mfma_f32_16x16x32_bf16 v[180:183], v[68:71], v[32:35], v[180:183]
    v_mfma_f32_16x16x32_bf16 v[184:187], v[68:71], v[36:39], v[184:187]
    v_mfma_f32_16x16x32_bf16 v[188:191], v[68:71], v[40:43], v[188:191]
    v_mfma_f32_16x16x32_bf16 v[192:195], v[68:71], v[44:47], v[192:195]
    s_add_u32 s52, s52, 4096
    buffer_load_dwordx4 v[68:71], v2, s[36:39], s52 offen offset:0
    s_cmp_lt_u32 s26, 4
    s_cbranch_scc1 ap17a
    s_setprio 1
    s_branch ap17b
ap17a:
    s_setprio 0
ap17b:
    s_waitcnt vmcnt(20) lgkmcnt(0)
    v_mfma_f32_16x16x32_bf16 v[132:135], v[72:75], v[16:19], v[132:135]
    ds_read_b128 v[32:35], v5 offset:768
    v_mfma_f32_16x16x32_bf16 v[136:139], v[72:75], v[20:23], v[136:139]
    ds_read_b128 v[36:39], v5 offset:19200
    v_mfma_f32_16x16x32_bf16 v[140:143], v[72:75], v[24:27], v[140:143]
    ds_read_b128 v[40:43], v5 offset:37632
    v_mfma_f32_16x16x32_bf16 v[144:147], v[72:75], v[28:31], v[144:147]
    ds_read_b128 v[44:47], v5 offset:56064
    buffer_load_dwordx4 v[72:75], v2, s[36:39], s52 offen offset:1024
    s_waitcnt vmcnt(20)
    v_mfma_f32_16x16x32_bf16 v[148:151], v[76:79], v[16:19], v[148:151]
    v_mfma_f32_16x16x32_bf16 v[152:155], v[76:79], v[20:23], v[152:155]
    v_mfma_f32_16x16x32_bf16 v[156:159], v[76:79], v[24:27], v[156:159]
    v_mfma_f32_16x16x32_bf16 v[160:163], v[76:79], v[28:31], v[160:163]
    buffer_load_dwordx4 v[76:79], v2, s[36:39], s52 offen offset:2048
    s_waitcnt vmcnt(20)
    v_mfma_f32_16x16x32_bf16 v[164:167], v[80:83], v[16:19], v[164:167]
    v_mfma_f32_16x16x32_bf16 v[168:171], v[80:83], v[20:23], v[168:171]
    v_mfma_f32_16x16x32_bf16 v[172:175], v[80:83], v[24:27], v[172:175]
    v_mfma_f32_16x16x32_bf16 v[176:179], v[80:83], v[28:31], v[176:179]
    buffer_load_dwordx4 v[80:83], v2, s[36:39], s52 offen offset:3072
    s_waitcnt vmcnt(20)
    v_mfma_f32_16x16x32_bf16 v[180:183], v[84:87], v[16:19], v[180:183]
    v_mfma_f32_16x16x32_bf16 v[184:187], v[84:87], v[20:23], v[184:187]
    v_mfma_f32_16x16x32_bf16 v[188:191], v[84:87], v[24:27], v[188:191]
    v_mfma_f32_16x16x32_bf16 v[192:195], v[84:87], v[28:31], v[192:195]
    s_add_u32 s52, s52, 4096
    buffer_load_dwordx4 v[84:87], v2, s[36:39], s52 offen offset:0
    s_waitcnt vmcnt(20) lgkmcnt(0)
    v_mfma_f32_16x16x32_bf16 v[132:135], v[88:91], v[32:35], v[132:135]
    ds_read_b128 v[16:19], v4 offset:896
    v_mfma_f32_16x16x32_bf16 v[136:139], v[88:91], v[36:39], v[136:139]
    ds_read_b128 v[20:23], v4 offset:19328
    v_mfma_f32_16x16x32_bf16 v[140:143], v[88:91], v[40:43], v[140:143]
    ds_read_b128 v[24:27], v4 offset:37760
    v_mfma_f32_16x16x32_bf16 v[144:147], v[88:91], v[44:47], v[144:147]
    ds_read_b128 v[28:31], v4 offset:56192
    buffer_load_dwordx4 v[88:91], v2, s[36:39], s52 offen offset:1024
    s_waitcnt vmcnt(20)
    v_mfma_f32_16x16x32_bf16 v[148:151], v[92:95], v[32:35], v[148:151]
    v_mfma_f32_16x16x32_bf16 v[152:155], v[92:95], v[36:39], v[152:155]
    v_mfma_f32_16x16x32_bf16 v[156:159], v[92:95], v[40:43], v[156:159]
    v_mfma_f32_16x16x32_bf16 v[160:163], v[92:95], v[44:47], v[160:163]
    buffer_load_dwordx4 v[92:95], v2, s[36:39], s52 offen offset:2048
    s_waitcnt vmcnt(20)
    v_mfma_f32_16x16x32_bf16 v[164:167], v[96:99], v[32:35], v[164:167]
    v_mfma_f32_16x16x32_bf16 v[168:171], v[96:99], v[36:39], v[168:171]
    v_mfma_f32_16x16x32_bf16 v[172:175], v[96:99], v[40:43], v[172:175]
    v_mfma_f32_16x16x32_bf16 v[176:179], v[96:99], v[44:47], v[176:179]
    buffer_load_dwordx4 v[96:99], v2, s[36:39], s52 offen offset:3072
    s_waitcnt vmcnt(20)
    v_mfma_f32_16x16x32_bf16 v[180:183], v[100:103], v[32:35], v[180:183]
    v_mfma_f32_16x16x32_bf16 v[184:187], v[100:103], v[36:39], v[184:187]
    v_mfma_f32_16x16x32_bf16 v[188:191], v[100:103], v[40:43], v[188:191]
    v_mfma_f32_16x16x32_bf16 v[192:195], v[100:103], v[44:47], v[192:195]
    s_add_u32 s52, s52, 4096
    buffer_load_dwordx4 v[100:103], v2, s[36:39], s52 offen offset:0
    s_waitcnt vmcnt(20) lgkmcnt(0)
    v_mfma_f32_16x16x32_bf16 v[132:135], v[104:107], v[16:19], v[132:135]
    ds_read_b128 v[32:35], v5 offset:896
    v_mfma_f32_16x16x32_bf16 v[136:139], v[104:107], v[20:23], v[136:139]
    ds_read_b128 v[36:39], v5 offset:19328
    v_mfma_f32_16x16x32_bf16 v[140:143], v[104:107], v[24:27], v[140:143]
    ds_read_b128 v[40:43], v5 offset:37760
    v_mfma_f32_16x16x32_bf16 v[144:147], v[104:107], v[28:31], v[144:147]
    ds_read_b128 v[44:47], v5 offset:56192
    buffer_load_dwordx4 v[104:107], v2, s[36:39], s52 offen offset:1024
    s_waitcnt vmcnt(20)
    v_mfma_f32_16x16x32_bf16 v[148:151], v[108:111], v[16:19], v[148:151]
    v_mfma_f32_16x16x32_bf16 v[152:155], v[108:111], v[20:23], v[152:155]
    v_mfma_f32_16x16x32_bf16 v[156:159], v[108:111], v[24:27], v[156:159]
    v_mfma_f32_16x16x32_bf16 v[160:163], v[108:111], v[28:31], v[160:163]
    buffer_load_dwordx4 v[108:111], v2, s[36:39], s52 offen offset:2048
    s_waitcnt vmcnt(20)
    v_mfma_f32_16x16x32_bf16 v[164:167], v[112:115], v[16:19], v[164:167]
    v_mfma_f32_16x16x32_bf16 v[168:171], v[112:115], v[20:23], v[168:171]
    v_mfma_f32_16x16x32_bf16 v[172:175], v[112:115], v[24:27], v[172:175]
    v_mfma_f32_16x16x32_bf16 v[176:179], v[112:115], v[28:31], v[176:179]
    buffer_load_dwordx4 v[112:115], v2, s[36:39], s52 offen offset:3072
    s_waitcnt vmcnt(20)
    v_mfma_f32_16x16x32_bf16 v[180:183], v[116:119], v[16:19], v[180:183]
    v_mfma_f32_16x16x32_bf16 v[184:187], v[116:119], v[20:23], v[184:187]
    v_mfma_f32_16x16x32_bf16 v[188:191], v[116:119], v[24:27], v[188:191]
    v_mfma_f32_16x16x32_bf16 v[192:195], v[116:119], v[28:31], v[192:195]
    s_add_u32 s52, s52, 4096
    buffer_load_dwordx4 v[116:119], v2, s[36:39], s52 offen offset:0
    s_cmp_lt_u32 s26, 4
    s_cbranch_scc1 ap18a
    s_setprio 0
    s_branch ap18b
ap18a:
    s_setprio 1
ap18b:
    s_waitcnt vmcnt(20) lgkmcnt(0)
    v_mfma_f32_16x16x32_bf16 v[132:135], v[120:123], v[32:35], v[132:135]
    ds_read_b128 v[16:19], v4 offset:1024
    v_mfma_f32_16x16x32_bf16 v[136:139], v[120:123], v[36:39], v[136:139]
    ds_read_b128 v[20:23], v4 offset:19456
    v_mfma_f32_16x16x32_bf16 v[140:143], v[120:123], v[40:43], v[140:143]
    ds_read_b128 v[24:27], v4 offset:37888
    v_mfma_f32_16x16x32_bf16 v[144:147], v[120:123], v[44:47], v[144:147]
    ds_read_b128 v[28:31], v4 offset:56320
    buffer_load_dwordx4 v[120:123], v2, s[36:39], s52 offen offset:1024
    s_waitcnt vmcnt(20)
    v_mfma_f32_16x16x32_bf16 v[148:151], v[124:127], v[32:35], v[148:151]
    v_mfma_f32_16x16x32_bf16 v[152:155], v[124:127], v[36:39], v[152:155]
    v_mfma_f32_16x16x32_bf16 v[156:159], v[124:127], v[40:43], v[156:159]
    v_mfma_f32_16x16x32_bf16 v[160:163], v[124:127], v[44:47], v[160:163]
    buffer_load_dwordx4 v[124:127], v2, s[36:39], s52 offen offset:2048
    s_waitcnt vmcnt(20)
    v_mfma_f32_16x16x32_bf16 v[164:167], v[128:131], v[32:35], v[164:167]
    v_mfma_f32_16x16x32_bf16 v[168:171], v[128:131], v[36:39], v[168:171]
    v_mfma_f32_16x16x32_bf16 v[172:175], v[128:131], v[40:43], v[172:175]
    v_mfma_f32_16x16x32_bf16 v[176:179], v[128:131], v[44:47], v[176:179]
    buffer_load_dwordx4 v[128:131], v2, s[36:39], s52 offen offset:3072
    s_waitcnt vmcnt(20)
    v_mfma_f32_16x16x32_bf16 v[180:183], v[48:51], v[32:35], v[180:183]
    v_mfma_f32_16x16x32_bf16 v[184:187], v[48:51], v[36:39], v[184:187]
    v_mfma_f32_16x16x32_bf16 v[188:191], v[48:51], v[40:43], v[188:191]
    v_mfma_f32_16x16x32_bf16 v[192:195], v[48:51], v[44:47], v[192:195]
    s_add_u32 s52, s52, 4096
    buffer_load_dwordx4 v[48:51], v2, s[36:39], s52 offen offset:0
    s_waitcnt vmcnt(20) lgkmcnt(0)
    v_mfma_f32_16x16x32_bf16 v[132:135], v[52:55], v[16:19], v[132:135]
    ds_read_b128 v[32:35], v5 offset:1024
    v_mfma_f32_16x16x32_bf16 v[136:139], v[52:55], v[20:23], v[136:139]
    ds_read_b128 v[36:39], v5 offset:19456
    v_mfma_f32_16x16x32_bf16 v[140:143], v[52:55], v[24:27], v[140:143]
    ds_read_b128 v[40:43], v5 offset:37888
    v_mfma_f32_16x16x32_bf16 v[144:147], v[52:55], v[28:31], v[144:147]
    ds_read_b128 v[44:47], v5 offset:56320
    buffer_load_dwordx4 v[52:55], v2, s[36:39], s52 offen offset:1024
    s_waitcnt vmcnt(20)
    v_mfma_f32_16x16x32_bf16 v[148:151], v[56:59], v[16:19], v[148:151]
    v_mfma_f32_16x16x32_bf16 v[152:155], v[56:59], v[20:23], v[152:155]
    v_mfma_f32_16x16x32_bf16 v[156:159], v[56:59], v[24:27], v[156:159]
    v_mfma_f32_16x16x32_bf16 v[160:163], v[56:59], v[28:31], v[160:163]
    buffer_load_dwordx4 v[56:59], v2, s[36:39], s52 offen offset:2048
    s_waitcnt vmcnt(20)
    v_mfma_f32_16x16x32_bf16 v[164:167], v[60:63], v[16:19], v[164:167]
    v_mfma_f32_16x16x32_bf16 v[168:171], v[60:63], v[20:23], v[168:171]
    v_mfma_f32_16x16x32_bf16 v[172:175], v[60:63], v[24:27], v[172:175]
    v_mfma_f32_16x16x32_bf16 v[176:179], v[60:63], v[28:31], v[176:179]
    buffer_load_dwordx4 v[60:63], v2, s[36:39], s52 offen offset:3072
    s_waitcnt vmcnt(20)
    v_mfma_f32_16x16x32_bf16 v[180:183], v[64:67], v[16:19], v[180:183]
    v_mfma_f32_16x16x32_bf16 v[184:187], v[64:67], v[20:23], v[184:187]
    v_mfma_f32_16x16x32_bf16 v[188:191], v[64:67], v[24:27], v[188:191]
    v_mfma_f32_16x16x32_bf16 v[192:195], v[64:67], v[28:31], v[192:195]
    s_add_u32 s52, s52, 4096
    buffer_load_dwordx4 v[64:67], v2, s[36:39], s52 offen offset:0
    s_waitcnt vmcnt(20) lgkmcnt(0)
    v_mfma_f32_16x16x32_bf16 v[132:135], v[68:71], v[32:35], v[132:135]
    v_mfma_f32_16x16x32_bf16 v[136:139], v[68:71], v[36:39], v[136:139]
    v_mfma_f32_16x16x32_bf16 v[140:143], v[68:71], v[40:43], v[140:143]
    v_mfma_f32_16x16x32_bf16 v[144:147], v[68:71], v[44:47], v[144:147]
    buffer_load_dwordx4 v[68:71], v2, s[36:39], s52 offen offset:1024
    s_waitcnt vmcnt(20)
    v_mfma_f32_16x16x32_bf16 v[148:151], v[72:75], v[32:35], v[148:151]
    v_mfma_f32_16x16x32_bf16 v[152:155], v[72:75], v[36:39], v[152:155]
    v_mfma_f32_16x16x32_bf16 v[156:159], v[72:75], v[40:43], v[156:159]
    v_mfma_f32_16x16x32_bf16 v[160:163], v[72:75], v[44:47], v[160:163]
    buffer_load_dwordx4 v[72:75], v2, s[36:39], s52 offen offset:2048
    s_waitcnt vmcnt(20)
    v_mfma_f32_16x16x32_bf16 v[164:167], v[76:79], v[32:35], v[164:167]
    v_mfma_f32_16x16x32_bf16 v[168:171], v[76:79], v[36:39], v[168:171]
    v_mfma_f32_16x16x32_bf16 v[172:175], v[76:79], v[40:43], v[172:175]
    v_mfma_f32_16x16x32_bf16 v[176:179], v[76:79], v[44:47], v[176:179]
    buffer_load_dwordx4 v[76:79], v2, s[36:39], s52 offen offset:3072
    s_waitcnt vmcnt(20)
    v_mfma_f32_16x16x32_bf16 v[180:183], v[80:83], v[32:35], v[180:183]
    v_mfma_f32_16x16x32_bf16 v[184:187], v[80:83], v[36:39], v[184:187]
    v_mfma_f32_16x16x32_bf16 v[188:191], v[80:83], v[40:43], v[188:191]
    v_mfma_f32_16x16x32_bf16 v[192:195], v[80:83], v[44:47], v[192:195]
    s_add_u32 s52, s52, 4096
    buffer_load_dwordx4 v[80:83], v2, s[36:39], s52 offen offset:0
    s_nop 7
    v_mul_f32 v232, v132, v132
    v_mul_f32 v233, v133, v133
    v_mul_f32 v234, v148, v148
    v_mul_f32 v235, v149, v149
    v_mul_f32 v236, v164, v164
    v_mul_f32 v237, v165, v165
    v_mul_f32 v238, v180, v180
    v_mul_f32 v239, v181, v181
    v_fma_f32 v232, v232, s57, v11
    v_fma_f32 v233, v233, s57, v11
    v_fma_f32 v234, v234, s57, v11
    v_fma_f32 v235, v235, s57, v11
    v_fma_f32 v236, v236, s57, v11
    v_fma_f32 v237, v237, s57, v11
    v_fma_f32 v238, v238, s57, v11
    v_fma_f32 v239, v239, s57, v11
    v_mul_f32 v232, v232, v132
    v_mul_f32 v233, v233, v133
    v_mul_f32 v234, v234, v148
    v_mul_f32 v235, v235, v149
    v_mul_f32 v236, v236, v164
    v_mul_f32 v237, v237, v165
    v_mul_f32 v238, v238, v180
    v_mul_f32 v239, v239, v181
    v_exp_f32 v232, v232
    v_exp_f32 v233, v233
    v_exp_f32 v234, v234
    v_exp_f32 v235, v235
    v_exp_f32 v236, v236
    v_exp_f32 v237, v237
    v_exp_f32 v238, v238
    v_exp_f32 v239, v239
    v_mul_f32 v240, v132, v134
    v_mul_f32 v241, v133, v135
    v_mul_f32 v242, v148, v150
    v_mul_f32 v243, v149, v151
    v_mul_f32 v244, v164, v166
    v_mul_f32 v245, v165, v167
    v_mul_f32 v246, v180, v182
    v_mul_f32 v247, v181, v183
    v_add_f32 v232, 1.0, v232
    v_add_f32 v233, 1.0, v233
    v_add_f32 v234, 1.0, v234
    v_add_f32 v235, 1.0, v235
    v_add_f32 v236, 1.0, v236
    v_add_f32 v237, 1.0, v237
    v_add_f32 v238, 1.0, v238
    v_add_f32 v239, 1.0, v239
    v_rcp_f32 v232, v232
    v_rcp_f32 v233, v233
    v_rcp_f32 v234, v234
    v_rcp_f32 v235, v235
    v_rcp_f32 v236, v236
    v_rcp_f32 v237, v237
    v_rcp_f32 v238, v238
    v_rcp_f32 v239, v239
    v_mul_f32 v240, v240, v232
    v_mul_f32 v241, v241, v233
    v_mul_f32 v242, v242, v234
    v_mul_f32 v243, v243, v235
    v_mul_f32 v244, v244, v236
    v_mul_f32 v245, v245, v237
    v_mul_f32 v246, v246, v238
    v_mul_f32 v247, v247, v239
    v_cvt_pk_bf16_f32 v248, v240, v241
    v_cvt_pk_bf16_f32 v249, v242, v243
    v_cvt_pk_bf16_f32 v250, v244, v245
    v_cvt_pk_bf16_f32 v251, v246, v247
    ds_write_b128 v8, v[248:251] offset:0
    v_mul_f32 v232, v136, v136
    v_mul_f32 v233, v137, v137
    v_mul_f32 v234, v152, v152
    v_mul_f32 v235, v153, v153
    v_mul_f32 v236, v168, v168
    v_mul_f32 v237, v169, v169
    v_mul_f32 v238, v184, v184
    v_mul_f32 v239, v185, v185
    v_fma_f32 v232, v232, s57, v11
    v_fma_f32 v233, v233, s57, v11
    v_fma_f32 v234, v234, s57, v11
    v_fma_f32 v235, v235, s57, v11
    v_fma_f32 v236, v236, s57, v11
    v_fma_f32 v237, v237, s57, v11
    v_fma_f32 v238, v238, s57, v11
    v_fma_f32 v239, v239, s57, v11
    v_mul_f32 v232, v232, v136
    v_mul_f32 v233, v233, v137
    v_mul_f32 v234, v234, v152
    v_mul_f32 v235, v235, v153
    v_mul_f32 v236, v236, v168
    v_mul_f32 v237, v237, v169
    v_mul_f32 v238, v238, v184
    v_mul_f32 v239, v239, v185
    v_exp_f32 v232, v232
    v_exp_f32 v233, v233
    v_exp_f32 v234, v234
    v_exp_f32 v235, v235
    v_exp_f32 v236, v236
    v_exp_f32 v237, v237
    v_exp_f32 v238, v238
    v_exp_f32 v239, v239
    v_mul_f32 v240, v136, v138
    v_mul_f32 v241, v137, v139
    v_mul_f32 v242, v152, v154
    v_mul_f32 v243, v153, v155
    v_mul_f32 v244, v168, v170
    v_mul_f32 v245, v169, v171
    v_mul_f32 v246, v184, v186
    v_mul_f32 v247, v185, v187
    v_add_f32 v232, 1.0, v232
    v_add_f32 v233, 1.0, v233
    v_add_f32 v234, 1.0, v234
    v_add_f32 v235, 1.0, v235
    v_add_f32 v236, 1.0, v236
    v_add_f32 v237, 1.0, v237
    v_add_f32 v238, 1.0, v238
    v_add_f32 v239, 1.0, v239
    v_rcp_f32 v232, v232
    v_rcp_f32 v233, v233
    v_rcp_f32 v234, v234
    v_rcp_f32 v235, v235
    v_rcp_f32 v236, v236
    v_rcp_f32 v237, v237
    v_rcp_f32 v238, v238
    v_rcp_f32 v239, v239
    v_mul_f32 v240, v240, v232
    v_mul_f32 v241, v241, v233
    v_mul_f32 v242, v242, v234
    v_mul_f32 v243, v243, v235
    v_mul_f32 v244, v244, v236
    v_mul_f32 v245, v245, v237
    v_mul_f32 v246, v246, v238
    v_mul_f32 v247, v247, v239
    v_cvt_pk_bf16_f32 v252, v240, v241
    v_cvt_pk_bf16_f32 v253, v242, v243
    v_cvt_pk_bf16_f32 v254, v244, v245
    v_cvt_pk_bf16_f32 v255, v246, v247
    ds_write_b128 v8, v[252:255] offset:18432
    v_mul_f32 v232, v140, v140
    v_mul_f32 v233, v141, v141
    v_mul_f32 v234, v156, v156
    v_mul_f32 v235, v157, v157
    v_mul_f32 v236, v172, v172
    v_mul_f32 v237, v173, v173
    v_mul_f32 v238, v188, v188
    v_mul_f32 v239, v189, v189
    v_fma_f32 v232, v232, s57, v11
    v_fma_f32 v233, v233, s57, v11
    v_fma_f32 v234, v234, s57, v11
    v_fma_f32 v235, v235, s57, v11
    v_fma_f32 v236, v236, s57, v11
    v_fma_f32 v237, v237, s57, v11
    v_fma_f32 v238, v238, s57, v11
    v_fma_f32 v239, v239, s57, v11
    v_mul_f32 v232, v232, v140
    v_mul_f32 v233, v233, v141
    v_mul_f32 v234, v234, v156
    v_mul_f32 v235, v235, v157
    v_mul_f32 v236, v236, v172
    v_mul_f32 v237, v237, v173
    v_mul_f32 v238, v238, v188
    v_mul_f32 v239, v239, v189
    v_exp_f32 v232, v232
    v_exp_f32 v233, v233
    v_exp_f32 v234, v234
    v_exp_f32 v235, v235
    v_exp_f32 v236, v236
    v_exp_f32 v237, v237
    v_exp_f32 v238, v238
    v_exp_f32 v239, v239
    v_mul_f32 v240, v140, v142
    v_mul_f32 v241, v141, v143
    v_mul_f32 v242, v156, v158
    v_mul_f32 v243, v157, v159
    v_mul_f32 v244, v172, v174
    v_mul_f32 v245, v173, v175
    v_mul_f32 v246, v188, v190
    v_mul_f32 v247, v189, v191
    v_add_f32 v232, 1.0, v232
    v_add_f32 v233, 1.0, v233
    v_add_f32 v234, 1.0, v234
    v_add_f32 v235, 1.0, v235
    v_add_f32 v236, 1.0, v236
    v_add_f32 v237, 1.0, v237
    v_add_f32 v238, 1.0, v238
    v_add_f32 v239, 1.0, v239
    v_rcp_f32 v232, v232
    v_rcp_f32 v233, v233
    v_rcp_f32 v234, v234
    v_rcp_f32 v235, v235
    v_rcp_f32 v236, v236
    v_rcp_f32 v237, v237
    v_rcp_f32 v238, v238
    v_rcp_f32 v239, v239
    v_mul_f32 v240, v240, v232
    v_mul_f32 v241, v241, v233
    v_mul_f32 v242, v242, v234
    v_mul_f32 v243, v243, v235
    v_mul_f32 v244, v244, v236
    v_mul_f32 v245, v245, v237
    v_mul_f32 v246, v246, v238
    v_mul_f32 v247, v247, v239
    v_cvt_pk_bf16_f32 v248, v240, v241
    v_cvt_pk_bf16_f32 v249, v242, v243
    v_cvt_pk_bf16_f32 v250, v244, v245
    v_cvt_pk_bf16_f32 v251, v246, v247
    ds_write_b128 v8, v[248:251] offset:36864
    v_mul_f32 v232, v144, v144
    v_mul_f32 v233, v145, v145
    v_mul_f32 v234, v160, v160
    v_mul_f32 v235, v161, v161
    v_mul_f32 v236, v176, v176
    v_mul_f32 v237, v177, v177
    v_mul_f32 v238, v192, v192
    v_mul_f32 v239, v193, v193
    v_fma_f32 v232, v232, s57, v11
    v_fma_f32 v233, v233, s57, v11
    v_fma_f32 v234, v234, s57, v11
    v_fma_f32 v235, v235, s57, v11
    v_fma_f32 v236, v236, s57, v11
    v_fma_f32 v237, v237, s57, v11
    v_fma_f32 v238, v238, s57, v11
    v_fma_f32 v239, v239, s57, v11
    v_mul_f32 v232, v232, v144
    v_mul_f32 v233, v233, v145
    v_mul_f32 v234, v234, v160
    v_mul_f32 v235, v235, v161
    v_mul_f32 v236, v236, v176
    v_mul_f32 v237, v237, v177
    v_mul_f32 v238, v238, v192
    v_mul_f32 v239, v239, v193
    v_exp_f32 v232, v232
    v_exp_f32 v233, v233
    v_exp_f32 v234, v234
    v_exp_f32 v235, v235
    v_exp_f32 v236, v236
    v_exp_f32 v237, v237
    v_exp_f32 v238, v238
    v_exp_f32 v239, v239
    v_mul_f32 v240, v144, v146
    v_mul_f32 v241, v145, v147
    v_mul_f32 v242, v160, v162
    v_mul_f32 v243, v161, v163
    v_mul_f32 v244, v176, v178
    v_mul_f32 v245, v177, v179
    v_mul_f32 v246, v192, v194
    v_mul_f32 v247, v193, v195
    v_add_f32 v232, 1.0, v232
    v_add_f32 v233, 1.0, v233
    v_add_f32 v234, 1.0, v234
    v_add_f32 v235, 1.0, v235
    v_add_f32 v236, 1.0, v236
    v_add_f32 v237, 1.0, v237
    v_add_f32 v238, 1.0, v238
    v_add_f32 v239, 1.0, v239
    v_rcp_f32 v232, v232
    v_rcp_f32 v233, v233
    v_rcp_f32 v234, v234
    v_rcp_f32 v235, v235
    v_rcp_f32 v236, v236
    v_rcp_f32 v237, v237
    v_rcp_f32 v238, v238
    v_rcp_f32 v239, v239
    v_mul_f32 v240, v240, v232
    v_mul_f32 v241, v241, v233
    v_mul_f32 v242, v242, v234
    v_mul_f32 v243, v243, v235
    v_mul_f32 v244, v244, v236
    v_mul_f32 v245, v245, v237
    v_mul_f32 v246, v246, v238
    v_mul_f32 v247, v247, v239
    v_cvt_pk_bf16_f32 v252, v240, v241
    v_cvt_pk_bf16_f32 v253, v242, v243
    v_cvt_pk_bf16_f32 v254, v244, v245
    v_cvt_pk_bf16_f32 v255, v246, v247
    ds_write_b128 v8, v[252:255] offset:55296
    ds_read_b128 v[16:19], v4 offset:0
    ds_read_b128 v[20:23], v4 offset:18432
    ds_read_b128 v[24:27], v4 offset:36864
    ds_read_b128 v[28:31], v4 offset:55296
    s_cmp_lt_u32 s26, 4
    s_cbranch_scc1 ap19a
    s_setprio 1
    s_branch ap19b
ap19a:
    s_setprio 0
ap19b:
    s_waitcnt vmcnt(20) lgkmcnt(0)
    v_mfma_f32_16x16x32_bf16 v[132:135], v[84:87], v[16:19], 0
    ds_read_b128 v[32:35], v5 offset:0
    v_mfma_f32_16x16x32_bf16 v[136:139], v[84:87], v[20:23], 0
    ds_read_b128 v[36:39], v5 offset:18432
    v_mfma_f32_16x16x32_bf16 v[140:143], v[84:87], v[24:27], 0
    ds_read_b128 v[40:43], v5 offset:36864
    v_mfma_f32_16x16x32_bf16 v[144:147], v[84:87], v[28:31], 0
    ds_read_b128 v[44:47], v5 offset:55296
    buffer_load_dwordx4 v[84:87], v2, s[36:39], s52 offen offset:1024
    s_waitcnt vmcnt(20)
    v_mfma_f32_16x16x32_bf16 v[148:151], v[88:91], v[16:19], 0
    v_mfma_f32_16x16x32_bf16 v[152:155], v[88:91], v[20:23], 0
    v_mfma_f32_16x16x32_bf16 v[156:159], v[88:91], v[24:27], 0
    v_mfma_f32_16x16x32_bf16 v[160:163], v[88:91], v[28:31], 0
    buffer_load_dwordx4 v[88:91], v2, s[36:39], s52 offen offset:2048
    s_waitcnt vmcnt(20)
    v_mfma_f32_16x16x32_bf16 v[164:167], v[92:95], v[16:19], 0
    v_mfma_f32_16x16x32_bf16 v[168:171], v[92:95], v[20:23], 0
    v_mfma_f32_16x16x32_bf16 v[172:175], v[92:95], v[24:27], 0
    v_mfma_f32_16x16x32_bf16 v[176:179], v[92:95], v[28:31], 0
    buffer_load_dwordx4 v[92:95], v2, s[36:39], s52 offen offset:3072
    s_waitcnt vmcnt(20)
    v_mfma_f32_16x16x32_bf16 v[180:183], v[96:99], v[16:19], 0
    v_mfma_f32_16x16x32_bf16 v[184:187], v[96:99], v[20:23], 0
    v_mfma_f32_16x16x32_bf16 v[188:191], v[96:99], v[24:27], 0
    v_mfma_f32_16x16x32_bf16 v[192:195], v[96:99], v[28:31], 0
    s_add_u32 s52, s52, 4096
    buffer_load_dwordx4 v[96:99], v2, s[36:39], s52 offen offset:0
    s_waitcnt vmcnt(20)
    v_mfma_f32_16x16x32_bf16 v[196:199], v[100:103], v[16:19], 0
    v_mfma_f32_16x16x32_bf16 v[200:203], v[100:103], v[20:23], 0
    v_mfma_f32_16x16x32_bf16 v[204:207], v[100:103], v[24:27], 0
    v_mfma_f32_16x16x32_bf16 v[208:211], v[100:103], v[28:31], 0
    buffer_load_dwordx4 v[100:103], v2, s[36:39], s52 offen offset:1024
    s_waitcnt vmcnt(20) lgkmcnt(0)
    v_mfma_f32_16x16x32_bf16 v[132:135], v[104:107], v[32:35], v[132:135]
    ds_read_b128 v[16:19], v4 offset:128
    v_mfma_f32_16x16x32_bf16 v[136:139], v[104:107], v[36:39], v[136:139]
    ds_read_b128 v[20:23], v4 offset:18560
    v_mfma_f32_16x16x32_bf16 v[140:143], v[104:107], v[40:43], v[140:143]
    ds_read_b128 v[24:27], v4 offset:36992
    v_mfma_f32_16x16x32_bf16 v[144:147], v[104:107], v[44:47], v[144:147]
    ds_read_b128 v[28:31], v4 offset:55424
    buffer_load_dwordx4 v[104:107], v2, s[36:39], s52 offen offset:2048
    s_waitcnt vmcnt(20)
    v_mfma_f32_16x16x32_bf16 v[148:151], v[108:111], v[32:35], v[148:151]
    v_mfma_f32_16x16x32_bf16 v[152:155], v[108:111], v[36:39], v[152:155]
    v_mfma_f32_16x16x32_bf16 v[156:159], v[108:111], v[40:43], v[156:159]
    v_mfma_f32_16x16x32_bf16 v[160:163], v[108:111], v[44:47], v[160:163]
    buffer_load_dwordx4 v[108:111], v2, s[36:39], s52 offen offset:3072
    s_waitcnt vmcnt(20)
    v_mfma_f32_16x16x32_bf16 v[164:167], v[112:115], v[32:35], v[164:167]
    v_mfma_f32_16x16x32_bf16 v[168:171], v[112:115], v[36:39], v[168:171]
    v_mfma_f32_16x16x32_bf16 v[172:175], v[112:115], v[40:43], v[172:175]
    v_mfma_f32_16x16x32_bf16 v[176:179], v[112:115], v[44:47], v[176:179]
    s_add_u32 s52, s52, 4096
    buffer_load_dwordx4 v[112:115], v2, s[36:39], s52 offen offset:0
    s_waitcnt vmcnt(20)
    v_mfma_f32_16x16x32_bf16 v[180:183], v[116:119], v[32:35], v[180:183]
    v_mfma_f32_16x16x32_bf16 v[184:187], v[116:119], v[36:39], v[184:187]
    v_mfma_f32_16x16x32_bf16 v[188:191], v[116:119], v[40:43], v[188:191]
    v_mfma_f32_16x16x32_bf16 v[192:195], v[116:119], v[44:47], v[192:195]
    buffer_load_dwordx4 v[116:119], v2, s[36:39], s52 offen offset:1024
    s_waitcnt vmcnt(20)
    v_mfma_f32_16x16x32_bf16 v[196:199], v[120:123], v[32:35], v[196:199]
    v_mfma_f32_16x16x32_bf16 v[200:203], v[120:123], v[36:39], v[200:203]
    v_mfma_f32_16x16x32_bf16 v[204:207], v[120:123], v[40:43], v[204:207]
    v_mfma_f32_16x16x32_bf16 v[208:211], v[120:123], v[44:47], v[208:211]
    buffer_load_dwordx4 v[120:123], v2, s[36:39], s52 offen offset:2048
    s_waitcnt vmcnt(20) lgkmcnt(0)
    v_mfma_f32_16x16x32_bf16 v[132:135], v[124:127], v[16:19], v[132:135]
    ds_read_b128 v[32:35], v5 offset:128
    v_mfma_f32_16x16x32_bf16 v[136:139], v[124:127], v[20:23], v[136:139]
    ds_read_b128 v[36:39], v5 offset:18560
    v_mfma_f32_16x16x32_bf16 v[140:143], v[124:127], v[24:27], v[140:143]
    ds_read_b128 v[40:43], v5 offset:36992
    v_mfma_f32_16x16x32_bf16 v[144:147], v[124:127], v[28:31], v[144:147]
    ds_read_b128 v[44:47], v5 offset:55424
    buffer_load_dwordx4 v[124:127], v2, s[36:39], s52 offen offset:3072
    s_waitcnt vmcnt(20)
    v_mfma_f32_16x16x32_bf16 v[148:151], v[128:131], v[16:19], v[148:151]
    v_mfma_f32_16x16x32_bf16 v[152:155], v[128:131], v[20:23], v[152:155]
    v_mfma_f32_16x16x32_bf16 v[156:159], v[128:131], v[24:27], v[156:159]
    v_mfma_f32_16x16x32_bf16 v[160:163], v[128:131], v[28:31], v[160:163]
    s_add_u32 s52, s52, 4096
    buffer_load_dwordx4 v[128:131], v2, s[36:39], s52 offen offset:0
    s_waitcnt vmcnt(20)
    v_mfma_f32_16x16x32_bf16 v[164:167], v[48:51], v[16:19], v[164:167]
    v_mfma_f32_16x16x32_bf16 v[168:171], v[48:51], v[20:23], v[168:171]
    v_mfma_f32_16x16x32_bf16 v[172:175], v[48:51], v[24:27], v[172:175]
    v_mfma_f32_16x16x32_bf16 v[176:179], v[48:51], v[28:31], v[176:179]
    buffer_load_dwordx4 v[48:51], v2, s[36:39], s52 offen offset:1024
    s_waitcnt vmcnt(20)
    v_mfma_f32_16x16x32_bf16 v[180:183], v[52:55], v[16:19], v[180:183]
    v_mfma_f32_16x16x32_bf16 v[184:187], v[52:55], v[20:23], v[184:187]
    v_mfma_f32_16x16x32_bf16 v[188:191], v[52:55], v[24:27], v[188:191]
    v_mfma_f32_16x16x32_bf16 v[192:195], v[52:55], v[28:31], v[192:195]
    buffer_load_dwordx4 v[52:55], v2, s[36:39], s52 offen offset:2048
    s_waitcnt vmcnt(20)
    v_mfma_f32_16x16x32_bf16 v[196:199], v[56:59], v[16:19], v[196:199]
    v_mfma_f32_16x16x32_bf16 v[200:203], v[56:59], v[20:23], v[200:203]
    v_mfma_f32_16x16x32_bf16 v[204:207], v[56:59], v[24:27], v[204:207]
    v_mfma_f32_16x16x32_bf16 v[208:211], v[56:59], v[28:31], v[208:211]
    buffer_load_dwordx4 v[56:59], v2, s[36:39], s52 offen offset:3072
    s_cmp_lt_u32 s26, 4
    s_cbranch_scc1 ap20a
    s_setprio 0
    s_branch ap20b
ap20a:
    s_setprio 1
ap20b:
    s_waitcnt vmcnt(20) lgkmcnt(0)
    v_mfma_f32_16x16x32_bf16 v[132:135], v[60:63], v[32:35], v[132:135]
    ds_read_b128 v[16:19], v4 offset:256
    v_mfma_f32_16x16x32_bf16 v[136:139], v[60:63], v[36:39], v[136:139]
    ds_read_b128 v[20:23], v4 offset:18688
    v_mfma_f32_16x16x32_bf16 v[140:143], v[60:63], v[40:43], v[140:143]
    ds_read_b128 v[24:27], v4 offset:37120
    v_mfma_f32_16x16x32_bf16 v[144:147], v[60:63], v[44:47], v[144:147]
    ds_read_b128 v[28:31], v4 offset:55552
    s_add_u32 s52, s52, 4096
    buffer_load_dwordx4 v[60:63], v2, s[36:39], s52 offen offset:0
    s_waitcnt vmcnt(20)
    v_mfma_f32_16x16x32_bf16 v[148:151], v[64:67], v[32:35], v[148:151]
    v_mfma_f32_16x16x32_bf16 v[152:155], v[64:67], v[36:39], v[152:155]
    v_mfma_f32_16x16x32_bf16 v[156:159], v[64:67], v[40:43], v[156:159]
    v_mfma_f32_16x16x32_bf16 v[160:163], v[64:67], v[44:47], v[160:163]
    buffer_load_dwordx4 v[64:67], v2, s[36:39], s52 offen offset:1024
    s_waitcnt vmcnt(20)
    v_mfma_f32_16x16x32_bf16 v[164:167], v[68:71], v[32:35], v[164:167]
    v_mfma_f32_16x16x32_bf16 v[168:171], v[68:71], v[36:39], v[168:171]
    v_mfma_f32_16x16x32_bf16 v[172:175], v[68:71], v[40:43], v[172:175]
    v_mfma_f32_16x16x32_bf16 v[176:179], v[68:71], v[44:47], v[176:179]
    buffer_load_dwordx4 v[68:71], v2, s[36:39], s52 offen offset:2048
    s_waitcnt vmcnt(20)
    v_mfma_f32_16x16x32_bf16 v[180:183], v[72:75], v[32:35], v[180:183]
    v_mfma_f32_16x16x32_bf16 v[184:187], v[72:75], v[36:39], v[184:187]
    v_mfma_f32_16x16x32_bf16 v[188:191], v[72:75], v[40:43], v[188:191]
    v_mfma_f32_16x16x32_bf16 v[192:195], v[72:75], v[44:47], v[192:195]
    buffer_load_dwordx4 v[72:75], v2, s[36:39], s52 offen offset:3072
    s_waitcnt vmcnt(20)
    v_mfma_f32_16x16x32_bf16 v[196:199], v[76:79], v[32:35], v[196:199]
    v_mfma_f32_16x16x32_bf16 v[200:203], v[76:79], v[36:39], v[200:203]
    v_mfma_f32_16x16x32_bf16 v[204:207], v[76:79], v[40:43], v[204:207]
    v_mfma_f32_16x16x32_bf16 v[208:211], v[76:79], v[44:47], v[208:211]
    s_add_u32 s52, s52, 4096
    buffer_load_dwordx4 v[76:79], v2, s[36:39], s52 offen offset:0
    s_waitcnt vmcnt(20) lgkmcnt(0)
    v_mfma_f32_16x16x32_bf16 v[132:135], v[80:83], v[16:19], v[132:135]
    ds_read_b128 v[32:35], v5 offset:256
    v_mfma_f32_16x16x32_bf16 v[136:139], v[80:83], v[20:23], v[136:139]
    ds_read_b128 v[36:39], v5 offset:18688
    v_mfma_f32_16x16x32_bf16 v[140:143], v[80:83], v[24:27], v[140:143]
    ds_read_b128 v[40:43], v5 offset:37120
    v_mfma_f32_16x16x32_bf16 v[144:147], v[80:83], v[28:31], v[144:147]
    ds_read_b128 v[44:47], v5 offset:55552
    buffer_load_dwordx4 v[80:83], v2, s[36:39], s52 offen offset:1024
    s_waitcnt vmcnt(20)
    v_mfma_f32_16x16x32_bf16 v[148:151], v[84:87], v[16:19], v[148:151]
    v_mfma_f32_16x16x32_bf16 v[152:155], v[84:87], v[20:23], v[152:155]
    v_mfma_f32_16x16x32_bf16 v[156:159], v[84:87], v[24:27], v[156:159]
    v_mfma_f32_16x16x32_bf16 v[160:163], v[84:87], v[28:31], v[160:163]
    buffer_load_dwordx4 v[84:87], v2, s[36:39], s52 offen offset:2048
    s_waitcnt vmcnt(20)
    v_mfma_f32_16x16x32_bf16 v[164:167], v[88:91], v[16:19], v[164:167]
    v_mfma_f32_16x16x32_bf16 v[168:171], v[88:91], v[20:23], v[168:171]
    v_mfma_f32_16x16x32_bf16 v[172:175], v[88:91], v[24:27], v[172:175]
    v_mfma_f32_16x16x32_bf16 v[176:179], v[88:91], v[28:31], v[176:179]
    buffer_load_dwordx4 v[88:91], v2, s[36:39], s52 offen offset:3072
    s_waitcnt vmcnt(20)
    v_mfma_f32_16x16x32_bf16 v[180:183], v[92:95], v[16:19], v[180:183]
    v_mfma_f32_16x16x32_bf16 v[184:187], v[92:95], v[20:23], v[184:187]
    v_mfma_f32_16x16x32_bf16 v[188:191], v[92:95], v[24:27], v[188:191]
    v_mfma_f32_16x16x32_bf16 v[192:195], v[92:95], v[28:31], v[192:195]
    s_add_u32 s52, s52, 4096
    buffer_load_dwordx4 v[92:95], v2, s[36:39], s52 offen offset:0
    s_waitcnt vmcnt(20)
    v_mfma_f32_16x16x32_bf16 v[196:199], v[96:99], v[16:19], v[196:199]
    v_mfma_f32_16x16x32_bf16 v[200:203], v[96:99], v[20:23], v[200:203]
    v_mfma_f32_16x16x32_bf16 v[204:207], v[96:99], v[24:27], v[204:207]
    v_mfma_f32_16x16x32_bf16 v[208:211], v[96:99], v[28:31], v[208:211]
    buffer_load_dwordx4 v[96:99], v2, s[36:39], s52 offen offset:1024
    s_waitcnt vmcnt(20) lgkmcnt(0)
    v_mfma_f32_16x16x32_bf16 v[132:135], v[100:103], v[32:35], v[132:135]
    ds_read_b128 v[16:19], v4 offset:384
    v_mfma_f32_16x16x32_bf16 v[136:139], v[100:103], v[36:39], v[136:139]
    ds_read_b128 v[20:23], v4 offset:18816
    v_mfma_f32_16x16x32_bf16 v[140:143], v[100:103], v[40:43], v[140:143]
    ds_read_b128 v[24:27], v4 offset:37248
    v_mfma_f32_16x16x32_bf16 v[144:147], v[100:103], v[44:47], v[144:147]
    ds_read_b128 v[28:31], v4 offset:55680
    buffer_load_dwordx4 v[100:103], v2, s[36:39], s52 offen offset:2048
    s_waitcnt vmcnt(20)
    v_mfma_f32_16x16x32_bf16 v[148:151], v[104:107], v[32:35], v[148:151]
    v_mfma_f32_16x16x32_bf16 v[152:155], v[104:107], v[36:39], v[152:155]
    v_mfma_f32_16x16x32_bf16 v[156:159], v[104:107], v[40:43], v[156:159]
    v_mfma_f32_16x16x32_bf16 v[160:163], v[104:107], v[44:47], v[160:163]
    buffer_load_dwordx4 v[104:107], v2, s[36:39], s52 offen offset:3072
    s_waitcnt vmcnt(20)
    v_mfma_f32_16x16x32_bf16 v[164:167], v[108:111], v[32:35], v[164:167]
    v_mfma_f32_16x16x32_bf16 v[168:171], v[108:111], v[36:39], v[168:171]
    v_mfma_f32_16x16x32_bf16 v[172:175], v[108:111], v[40:43], v[172:175]
    v_mfma_f32_16x16x32_bf16 v[176:179], v[108:111], v[44:47], v[176:179]
    s_add_u32 s52, s52, 4096
    buffer_load_dwordx4 v[108:111], v2, s[36:39], s52 offen offset:0
    s_waitcnt vmcnt(20)
    v_mfma_f32_16x16x32_bf16 v[180:183], v[112:115], v[32:35], v[180:183]
    v_mfma_f32_16x16x32_bf16 v[184:187], v[112:115], v[36:39], v[184:187]
    v_mfma_f32_16x16x32_bf16 v[188:191], v[112:115], v[40:43], v[188:191]
    v_mfma_f32_16x16x32_bf16 v[192:195], v[112:115], v[44:47], v[192:195]
    buffer_load_dwordx4 v[112:115], v2, s[36:39], s52 offen offset:1024
    s_waitcnt vmcnt(20)
    v_mfma_f32_16x16x32_bf16 v[196:199], v[116:119], v[32:35], v[196:199]
    v_mfma_f32_16x16x32_bf16 v[200:203], v[116:119], v[36:39], v[200:203]
    v_mfma_f32_16x16x32_bf16 v[204:207], v[116:119], v[40:43], v[204:207]
    v_mfma_f32_16x16x32_bf16 v[208:211], v[116:119], v[44:47], v[208:211]
    buffer_load_dwordx4 v[116:119], v2, s[36:39], s52 offen offset:2048
    s_cmp_lt_u32 s26, 4
    s_cbranch_scc1 ap21a
    s_setprio 1
    s_branch ap21b
ap21a:
    s_setprio 0
ap21b:
    s_waitcnt vmcnt(20) lgkmcnt(0)
    v_mfma_f32_16x16x32_bf16 v[132:135], v[120:123], v[16:19], v[132:135]
    ds_read_b128 v[32:35], v5 offset:384
    v_mfma_f32_16x16x32_bf16 v[136:139], v[120:123], v[20:23], v[136:139]
    ds_read_b128 v[36:39], v5 offset:18816
    v_mfma_f32_16x16x32_bf16 v[140:143], v[120:123], v[24:27], v[140:143]
    ds_read_b128 v[40:43], v5 offset:37248
    v_mfma_f32_16x16x32_bf16 v[144:147], v[120:123], v[28:31], v[144:147]
    ds_read_b128 v[44:47], v5 offset:55680
    buffer_load_dwordx4 v[120:123], v2, s[36:39], s52 offen offset:3072
    s_waitcnt vmcnt(20)
    v_mfma_f32_16x16x32_bf16 v[148:151], v[124:127], v[16:19], v[148:151]
    v_mfma_f32_16x16x32_bf16 v[152:155], v[124:127], v[20:23], v[152:155]
    v_mfma_f32_16x16x32_bf16 v[156:159], v[124:127], v[24:27], v[156:159]
    v_mfma_f32_16x16x32_bf16 v[160:163], v[124:127], v[28:31], v[160:163]
    s_add_u32 s52, s52, 4096
    buffer_load_dwordx4 v[124:127], v2, s[36:39], s52 offen offset:0
    s_waitcnt vmcnt(20)
    v_mfma_f32_16x16x32_bf16 v[164:167], v[128:131], v[16:19], v[164:167]
    v_mfma_f32_16x16x32_bf16 v[168:171], v[128:131], v[20:23], v[168:171]
    v_mfma_f32_16x16x32_bf16 v[172:175], v[128:131], v[24:27], v[172:175]
    v_mfma_f32_16x16x32_bf16 v[176:179], v[128:131], v[28:31], v[176:179]
    buffer_load_dwordx4 v[128:131], v2, s[36:39], s52 offen offset:1024
    s_waitcnt vmcnt(20)
    v_mfma_f32_16x16x32_bf16 v[180:183], v[48:51], v[16:19], v[180:183]
    v_mfma_f32_16x16x32_bf16 v[184:187], v[48:51], v[20:23], v[184:187]
    v_mfma_f32_16x16x32_bf16 v[188:191], v[48:51], v[24:27], v[188:191]
    v_mfma_f32_16x16x32_bf16 v[192:195], v[48:51], v[28:31], v[192:195]
    buffer_load_dwordx4 v[48:51], v2, s[36:39], s52 offen offset:2048
    s_waitcnt vmcnt(20)
    v_mfma_f32_16x16x32_bf16 v[196:199], v[52:55], v[16:19], v[196:199]
    v_mfma_f32_16x16x32_bf16 v[200:203], v[52:55], v[20:23], v[200:203]
    v_mfma_f32_16x16x32_bf16 v[204:207], v[52:55], v[24:27], v[204:207]
    v_mfma_f32_16x16x32_bf16 v[208:211], v[52:55], v[28:31], v[208:211]
    buffer_load_dwordx4 v[52:55], v2, s[36:39], s52 offen offset:3072
    s_waitcnt vmcnt(20) lgkmcnt(0)
    v_mfma_f32_16x16x32_bf16 v[132:135], v[56:59], v[32:35], v[132:135]
    ds_read_b128 v[16:19], v4 offset:512
    v_mfma_f32_16x16x32_bf16 v[136:139], v[56:59], v[36:39], v[136:139]
    ds_read_b128 v[20:23], v4 offset:18944
    v_mfma_f32_16x16x32_bf16 v[140:143], v[56:59], v[40:43], v[140:143]
    ds_read_b128 v[24:27], v4 offset:37376
    v_mfma_f32_16x16x32_bf16 v[144:147], v[56:59], v[44:47], v[144:147]
    ds_read_b128 v[28:31], v4 offset:55808
    s_add_u32 s52, s52, 4096
    buffer_load_dwordx4 v[56:59], v2, s[36:39], s52 offen offset:0
    s_waitcnt vmcnt(20)
    v_mfma_f32_16x16x32_bf16 v[148:151], v[60:63], v[32:35], v[148:151]
    v_mfma_f32_16x16x32_bf16 v[152:155], v[60:63], v[36:39], v[152:155]
    v_mfma_f32_16x16x32_bf16 v[156:159], v[60:63], v[40:43], v[156:159]
    v_mfma_f32_16x16x32_bf16 v[160:163], v[60:63], v[44:47], v[160:163]
    buffer_load_dwordx4 v[60:63], v2, s[36:39], s52 offen offset:1024
    s_waitcnt vmcnt(20)
    v_mfma_f32_16x16x32_bf16 v[164:167], v[64:67], v[32:35], v[164:167]
    v_mfma_f32_16x16x32_bf16 v[168:171], v[64:67], v[36:39], v[168:171]
    v_mfma_f32_16x16x32_bf16 v[172:175], v[64:67], v[40:43], v[172:175]
    v_mfma_f32_16x16x32_bf16 v[176:179], v[64:67], v[44:47], v[176:179]
    buffer_load_dwordx4 v[64:67], v2, s[36:39], s52 offen offset:2048
    s_waitcnt vmcnt(20)
    v_mfma_f32_16x16x32_bf16 v[180:183], v[68:71], v[32:35], v[180:183]
    v_mfma_f32_16x16x32_bf16 v[184:187], v[68:71], v[36:39], v[184:187]
    v_mfma_f32_16x16x32_bf16 v[188:191], v[68:71], v[40:43], v[188:191]
    v_mfma_f32_16x16x32_bf16 v[192:195], v[68:71], v[44:47], v[192:195]
    buffer_load_dwordx4 v[68:71], v2, s[36:39], s52 offen offset:3072
    s_waitcnt vmcnt(20)
    v_mfma_f32_16x16x32_bf16 v[196:199], v[72:75], v[32:35], v[196:199]
    v_mfma_f32_16x16x32_bf16 v[200:203], v[72:75], v[36:39], v[200:203]
    v_mfma_f32_16x16x32_bf16 v[204:207], v[72:75], v[40:43], v[204:207]
    v_mfma_f32_16x16x32_bf16 v[208:211], v[72:75], v[44:47], v[208:211]
    s_add_u32 s52, s52, 4096
    buffer_load_dwordx4 v[72:75], v2, s[36:39], s52 offen offset:0
    s_waitcnt vmcnt(20) lgkmcnt(0)
    v_mfma_f32_16x16x32_bf16 v[132:135], v[76:79], v[16:19], v[132:135]
    ds_read_b128 v[32:35], v5 offset:512
    v_mfma_f32_16x16x32_bf16 v[136:139], v[76:79], v[20:23], v[136:139]
    ds_read_b128 v[36:39], v5 offset:18944
    v_mfma_f32_16x16x32_bf16 v[140:143], v[76:79], v[24:27], v[140:143]
    ds_read_b128 v[40:43], v5 offset:37376
    v_mfma_f32_16x16x32_bf16 v[144:147], v[76:79], v[28:31], v[144:147]
    ds_read_b128 v[44:47], v5 offset:55808
    buffer_load_dwordx4 v[76:79], v2, s[36:39], s52 offen offset:1024
    s_waitcnt vmcnt(20)
    v_mfma_f32_16x16x32_bf16 v[148:151], v[80:83], v[16:19], v[148:151]
    v_mfma_f32_16x16x32_bf16 v[152:155], v[80:83], v[20:23], v[152:155]
    v_mfma_f32_16x16x32_bf16 v[156:159], v[80:83], v[24:27], v[156:159]
    v_mfma_f32_16x16x32_bf16 v[160:163], v[80:83], v[28:31], v[160:163]
    buffer_load_dwordx4 v[80:83], v2, s[36:39], s52 offen offset:2048
    s_waitcnt vmcnt(20)
    v_mfma_f32_16x16x32_bf16 v[164:167], v[84:87], v[16:19], v[164:167]
    v_mfma_f32_16x16x32_bf16 v[168:171], v[84:87], v[20:23], v[168:171]
    v_mfma_f32_16x16x32_bf16 v[172:175], v[84:87], v[24:27], v[172:175]
    v_mfma_f32_16x16x32_bf16 v[176:179], v[84:87], v[28:31], v[176:179]
    buffer_load_dwordx4 v[84:87], v2, s[36:39], s52 offen offset:3072
    s_waitcnt vmcnt(20)
    v_mfma_f32_16x16x32_bf16 v[180:183], v[88:91], v[16:19], v[180:183]
    v_mfma_f32_16x16x32_bf16 v[184:187], v[88:91], v[20:23], v[184:187]
    v_mfma_f32_16x16x32_bf16 v[188:191], v[88:91], v[24:27], v[188:191]
    v_mfma_f32_16x16x32_bf16 v[192:195], v[88:91], v[28:31], v[192:195]
    s_add_u32 s52, s52, 4096
    buffer_load_dwordx4 v[88:91], v2, s[36:39], s52 offen offset:0
    s_waitcnt vmcnt(20)
    v_mfma_f32_16x16x32_bf16 v[196:199], v[92:95], v[16:19], v[196:199]
    v_mfma_f32_16x16x32_bf16 v[200:203], v[92:95], v[20:23], v[200:203]
    v_mfma_f32_16x16x32_bf16 v[204:207], v[92:95], v[24:27], v[204:207]
    v_mfma_f32_16x16x32_bf16 v[208:211], v[92:95], v[28:31], v[208:211]
    buffer_load_dwordx4 v[92:95], v2, s[36:39], s52 offen offset:1024
    s_cmp_lt_u32 s26, 4
    s_cbranch_scc1 ap22a
    s_setprio 0
    s_branch ap22b
ap22a:
    s_setprio 1
ap22b:
    s_waitcnt vmcnt(20) lgkmcnt(0)
    v_mfma_f32_16x16x32_bf16 v[132:135], v[96:99], v[32:35], v[132:135]
    ds_read_b128 v[16:19], v4 offset:640
    v_mfma_f32_16x16x32_bf16 v[136:139], v[96:99], v[36:39], v[136:139]
    ds_read_b128 v[20:23], v4 offset:19072
    v_mfma_f32_16x16x32_bf16 v[140:143], v[96:99], v[40:43], v[140:143]
    ds_read_b128 v[24:27], v4 offset:37504
    v_mfma_f32_16x16x32_bf16 v[144:147], v[96:99], v[44:47], v[144:147]
    ds_read_b128 v[28:31], v4 offset:55936
    buffer_load_dwordx4 v[96:99], v2, s[36:39], s52 offen offset:2048
    s_waitcnt vmcnt(20)
    v_mfma_f32_16x16x32_bf16 v[148:151], v[100:103], v[32:35], v[148:151]
    v_mfma_f32_16x16x32_bf16 v[152:155], v[100:103], v[36:39], v[152:155]
    v_mfma_f32_16x16x32_bf16 v[156:159], v[100:103], v[40:43], v[156:159]
    v_mfma_f32_16x16x32_bf16 v[160:163], v[100:103], v[44:47], v[160:163]
    buffer_load_dwordx4 v[100:103], v2, s[36:39], s52 offen offset:3072
    s_waitcnt vmcnt(20)
    v_mfma_f32_16x16x32_bf16 v[164:167], v[104:107], v[32:35], v[164:167]
    v_mfma_f32_16x16x32_bf16 v[168:171], v[104:107], v[36:39], v[168:171]
    v_mfma_f32_16x16x32_bf16 v[172:175], v[104:107], v[40:43], v[172:175]
    v_mfma_f32_16x16x32_bf16 v[176:179], v[104:107], v[44:47], v[176:179]
    s_add_u32 s52, s52, 4096
    buffer_load_dwordx4 v[104:107], v2, s[36:39], s52 offen offset:0
    s_waitcnt vmcnt(20)
    v_mfma_f32_16x16x32_bf16 v[180:183], v[108:111], v[32:35], v[180:183]
    v_mfma_f32_16x16x32_bf16 v[184:187], v[108:111], v[36:39], v[184:187]
    v_mfma_f32_16x16x32_bf16 v[188:191], v[108:111], v[40:43], v[188:191]
    v_mfma_f32_16x16x32_bf16 v[192:195], v[108:111], v[44:47], v[192:195]
    buffer_load_dwordx4 v[108:111], v2, s[36:39], s52 offen offset:1024
    s_waitcnt vmcnt(20)
    v_mfma_f32_16x16x32_bf16 v[196:199], v[112:115], v[32:35], v[196:199]
    v_mfma_f32_16x16x32_bf16 v[200:203], v[112:115], v[36:39], v[200:203]
    v_mfma_f32_16x16x32_bf16 v[204:207], v[112:115], v[40:43], v[204:207]
    v_mfma_f32_16x16x32_bf16 v[208:211], v[112:115], v[44:47], v[208:211]
    buffer_load_dwordx4 v[112:115], v2, s[36:39], s52 offen offset:2048
    s_waitcnt vmcnt(20) lgkmcnt(0)
    v_mfma_f32_16x16x32_bf16 v[132:135], v[116:119], v[16:19], v[132:135]
    ds_read_b128 v[32:35], v5 offset:640
    v_mfma_f32_16x16x32_bf16 v[136:139], v[116:119], v[20:23], v[136:139]
    ds_read_b128 v[36:39], v5 offset:19072
    v_mfma_f32_16x16x32_bf16 v[140:143], v[116:119], v[24:27], v[140:143]
    ds_read_b128 v[40:43], v5 offset:37504
    v_mfma_f32_16x16x32_bf16 v[144:147], v[116:119], v[28:31], v[144:147]
    ds_read_b128 v[44:47], v5 offset:55936
    buffer_load_dwordx4 v[116:119], v2, s[36:39], s52 offen offset:3072
    s_waitcnt vmcnt(20)
    v_mfma_f32_16x16x32_bf16 v[148:151], v[120:123], v[16:19], v[148:151]
    v_mfma_f32_16x16x32_bf16 v[152:155], v[120:123], v[20:23], v[152:155]
    v_mfma_f32_16x16x32_bf16 v[156:159], v[120:123], v[24:27], v[156:159]
    v_mfma_f32_16x16x32_bf16 v[160:163], v[120:123], v[28:31], v[160:163]
    s_add_u32 s52, s52, 4096
    buffer_load_dwordx4 v[120:123], v2, s[36:39], s52 offen offset:0
    s_waitcnt vmcnt(20)
    v_mfma_f32_16x16x32_bf16 v[164:167], v[124:127], v[16:19], v[164:167]
    v_mfma_f32_16x16x32_bf16 v[168:171], v[124:127], v[20:23], v[168:171]
    v_mfma_f32_16x16x32_bf16 v[172:175], v[124:127], v[24:27], v[172:175]
    v_mfma_f32_16x16x32_bf16 v[176:179], v[124:127], v[28:31], v[176:179]
    buffer_load_dwordx4 v[124:127], v2, s[36:39], s52 offen offset:1024
    s_waitcnt vmcnt(20)
    v_mfma_f32_16x16x32_bf16 v[180:183], v[128:131], v[16:19], v[180:183]
    v_mfma_f32_16x16x32_bf16 v[184:187], v[128:131], v[20:23], v[184:187]
    v_mfma_f32_16x16x32_bf16 v[188:191], v[128:131], v[24:27], v[188:191]
    v_mfma_f32_16x16x32_bf16 v[192:195], v[128:131], v[28:31], v[192:195]
    buffer_load_dwordx4 v[128:131], v2, s[36:39], s52 offen offset:2048
    s_waitcnt vmcnt(20)
    v_mfma_f32_16x16x32_bf16 v[196:199], v[48:51], v[16:19], v[196:199]
    v_mfma_f32_16x16x32_bf16 v[200:203], v[48:51], v[20:23], v[200:203]
    v_mfma_f32_16x16x32_bf16 v[204:207], v[48:51], v[24:27], v[204:207]
    v_mfma_f32_16x16x32_bf16 v[208:211], v[48:51], v[28:31], v[208:211]
    buffer_load_dwordx4 v[48:51], v2, s[36:39], s52 offen offset:3072
    s_waitcnt vmcnt(20) lgkmcnt(0)
    v_mfma_f32_16x16x32_bf16 v[132:135], v[52:55], v[32:35], v[132:135]
    ds_read_b128 v[16:19], v4 offset:768
    v_mfma_f32_16x16x32_bf16 v[136:139], v[52:55], v[36:39], v[136:139]
    ds_read_b128 v[20:23], v4 offset:19200
    v_mfma_f32_16x16x32_bf16 v[140:143], v[52:55], v[40:43], v[140:143]
    ds_read_b128 v[24:27], v4 offset:37632
    v_mfma_f32_16x16x32_bf16 v[144:147], v[52:55], v[44:47], v[144:147]
    ds_read_b128 v[28:31], v4 offset:56064
    s_add_u32 s52, s52, 4096
    buffer_load_dwordx4 v[52:55], v2, s[36:39], s52 offen offset:0
    s_waitcnt vmcnt(20)
    v_mfma_f32_16x16x32_bf16 v[148:151], v[56:59], v[32:35], v[148:151]
    v_mfma_f32_16x16x32_bf16 v[152:155], v[56:59], v[36:39], v[152:155]
    v_mfma_f32_16x16x32_bf16 v[156:159], v[56:59], v[40:43], v[156:159]
    v_mfma_f32_16x16x32_bf16 v[160:163], v[56:59], v[44:47], v[160:163]
    buffer_load_dwordx4 v[56:59], v2, s[36:39], s52 offen offset:1024
    s_waitcnt vmcnt(20)
    v_mfma_f32_16x16x32_bf16 v[164:167], v[60:63], v[32:35], v[164:167]
    v_mfma_f32_16x16x32_bf16 v[168:171], v[60:63], v[36:39], v[168:171]
    v_mfma_f32_16x16x32_bf16 v[172:175], v[60:63], v[40:43], v[172:175]
    v_mfma_f32_16x16x32_bf16 v[176:179], v[60:63], v[44:47], v[176:179]
    buffer_load_dwordx4 v[60:63], v2, s[36:39], s52 offen offset:2048
    s_waitcnt vmcnt(20)
    v_mfma_f32_16x16x32_bf16 v[180:183], v[64:67], v[32:35], v[180:183]
    v_mfma_f32_16x16x32_bf16 v[184:187], v[64:67], v[36:39], v[184:187]
    v_mfma_f32_16x16x32_bf16 v[188:191], v[64:67], v[40:43], v[188:191]
    v_mfma_f32_16x16x32_bf16 v[192:195], v[64:67], v[44:47], v[192:195]
    buffer_load_dwordx4 v[64:67], v2, s[36:39], s52 offen offset:3072
    s_waitcnt vmcnt(20)
    v_mfma_f32_16x16x32_bf16 v[196:199], v[68:71], v[32:35], v[196:199]
    v_mfma_f32_16x16x32_bf16 v[200:203], v[68:71], v[36:39], v[200:203]
    v_mfma_f32_16x16x32_bf16 v[204:207], v[68:71], v[40:43], v[204:207]
    v_mfma_f32_16x16x32_bf16 v[208:211], v[68:71], v[44:47], v[208:211]
    s_add_u32 s52, s52, 4096
    buffer_load_dwordx4 v[68:71], v2, s[36:39], s52 offen offset:0
    s_cmp_lt_u32 s26, 4
    s_cbranch_scc1 ap23a
    s_setprio 1
    s_branch ap23b
ap23a:
    s_setprio 0
ap23b:
    s_waitcnt vmcnt(20) lgkmcnt(0)
    v_mfma_f32_16x16x32_bf16 v[132:135], v[72:75], v[16:19], v[132:135]
    ds_read_b128 v[32:35], v5 offset:768
    v_mfma_f32_16x16x32_bf16 v[136:139], v[72:75], v[20:23], v[136:139]
    ds_read_b128 v[36:39], v5 offset:19200
    v_mfma_f32_16x16x32_bf16 v[140:143], v[72:75], v[24:27], v[140:143]
    ds_read_b128 v[40:43], v5 offset:37632
    v_mfma_f32_16x16x32_bf16 v[144:147], v[72:75], v[28:31], v[144:147]
    ds_read_b128 v[44:47], v5 offset:56064
    buffer_load_dwordx4 v[72:75], v2, s[36:39], s52 offen offset:1024
    s_waitcnt vmcnt(20)
    v_mfma_f32_16x16x32_bf16 v[148:151], v[76:79], v[16:19], v[148:151]
    v_mfma_f32_16x16x32_bf16 v[152:155], v[76:79], v[20:23], v[152:155]
    v_mfma_f32_16x16x32_bf16 v[156:159], v[76:79], v[24:27], v[156:159]
    v_mfma_f32_16x16x32_bf16 v[160:163], v[76:79], v[28:31], v[160:163]
    buffer_load_dwordx4 v[76:79], v2, s[36:39], s52 offen offset:2048
    s_waitcnt vmcnt(20)
    v_mfma_f32_16x16x32_bf16 v[164:167], v[80:83], v[16:19], v[164:167]
    v_mfma_f32_16x16x32_bf16 v[168:171], v[80:83], v[20:23], v[168:171]
    v_mfma_f32_16x16x32_bf16 v[172:175], v[80:83], v[24:27], v[172:175]
    v_mfma_f32_16x16x32_bf16 v[176:179], v[80:83], v[28:31], v[176:179]
    buffer_load_dwordx4 v[80:83], v2, s[36:39], s52 offen offset:3072
    s_waitcnt vmcnt(20)
    v_mfma_f32_16x16x32_bf16 v[180:183], v[84:87], v[16:19], v[180:183]
    v_mfma_f32_16x16x32_bf16 v[184:187], v[84:87], v[20:23], v[184:187]
    v_mfma_f32_16x16x32_bf16 v[188:191], v[84:87], v[24:27], v[188:191]
    v_mfma_f32_16x16x32_bf16 v[192:195], v[84:87], v[28:31], v[192:195]
    s_add_u32 s52, s52, 4096
    buffer_load_dwordx4 v[84:87], v2, s[36:39], s52 offen offset:0
    s_waitcnt vmcnt(20)
    v_mfma_f32_16x16x32_bf16 v[196:199], v[88:91], v[16:19], v[196:199]
    v_mfma_f32_16x16x32_bf16 v[200:203], v[88:91], v[20:23], v[200:203]
    v_mfma_f32_16x16x32_bf16 v[204:207], v[88:91], v[24:27], v[204:207]
    v_mfma_f32_16x16x32_bf16 v[208:211], v[88:91], v[28:31], v[208:211]
    buffer_load_dwordx4 v[88:91], v2, s[36:39], s52 offen offset:1024
    s_waitcnt vmcnt(20) lgkmcnt(0)
    v_mfma_f32_16x16x32_bf16 v[132:135], v[92:95], v[32:35], v[132:135]
    ds_read_b128 v[16:19], v4 offset:896
    v_mfma_f32_16x16x32_bf16 v[136:139], v[92:95], v[36:39], v[136:139]
    ds_read_b128 v[20:23], v4 offset:19328
    v_mfma_f32_16x16x32_bf16 v[140:143], v[92:95], v[40:43], v[140:143]
    ds_read_b128 v[24:27], v4 offset:37760
    v_mfma_f32_16x16x32_bf16 v[144:147], v[92:95], v[44:47], v[144:147]
    ds_read_b128 v[28:31], v4 offset:56192
    buffer_load_dwordx4 v[92:95], v2, s[36:39], s52 offen offset:2048
    s_waitcnt vmcnt(20)
    v_mfma_f32_16x16x32_bf16 v[148:151], v[96:99], v[32:35], v[148:151]
    v_mfma_f32_16x16x32_bf16 v[152:155], v[96:99], v[36:39], v[152:155]
    v_mfma_f32_16x16x32_bf16 v[156:159], v[96:99], v[40:43], v[156:159]
    v_mfma_f32_16x16x32_bf16 v[160:163], v[96:99], v[44:47], v[160:163]
    buffer_load_dwordx4 v[96:99], v2, s[36:39], s52 offen offset:3072
    s_waitcnt vmcnt(20)
    v_mfma_f32_16x16x32_bf16 v[164:167], v[100:103], v[32:35], v[164:167]
    v_mfma_f32_16x16x32_bf16 v[168:171], v[100:103], v[36:39], v[168:171]
    v_mfma_f32_16x16x32_bf16 v[172:175], v[100:103], v[40:43], v[172:175]
    v_mfma_f32_16x16x32_bf16 v[176:179], v[100:103], v[44:47], v[176:179]
    s_add_u32 s52, s52, 4096
    buffer_load_dwordx4 v[100:103], v2, s[36:39], s52 offen offset:0
    s_waitcnt vmcnt(20)
    v_mfma_f32_16x16x32_bf16 v[180:183], v[104:107], v[32:35], v[180:183]
    v_mfma_f32_16x16x32_bf16 v[184:187], v[104:107], v[36:39], v[184:187]
    v_mfma_f32_16x16x32_bf16 v[188:191], v[104:107], v[40:43], v[188:191]
    v_mfma_f32_16x16x32_bf16 v[192:195], v[104:107], v[44:47], v[192:195]
    buffer_load_dwordx4 v[104:107], v2, s[36:39], s52 offen offset:1024
    s_waitcnt vmcnt(20)
    v_mfma_f32_16x16x32_bf16 v[196:199], v[108:111], v[32:35], v[196:199]
    v_mfma_f32_16x16x32_bf16 v[200:203], v[108:111], v[36:39], v[200:203]
    v_mfma_f32_16x16x32_bf16 v[204:207], v[108:111], v[40:43], v[204:207]
    v_mfma_f32_16x16x32_bf16 v[208:211], v[108:111], v[44:47], v[208:211]
    buffer_load_dwordx4 v[108:111], v2, s[36:39], s52 offen offset:2048
    s_waitcnt vmcnt(20) lgkmcnt(0)
    v_mfma_f32_16x16x32_bf16 v[132:135], v[112:115], v[16:19], v[132:135]
    ds_read_b128 v[32:35], v5 offset:896
    v_mfma_f32_16x16x32_bf16 v[136:139], v[112:115], v[20:23], v[136:139]
    ds_read_b128 v[36:39], v5 offset:19328
    v_mfma_f32_16x16x32_bf16 v[140:143], v[112:115], v[24:27], v[140:143]
    ds_read_b128 v[40:43], v5 offset:37760
    v_mfma_f32_16x16x32_bf16 v[144:147], v[112:115], v[28:31], v[144:147]
    ds_read_b128 v[44:47], v5 offset:56192
    buffer_load_dwordx4 v[112:115], v2, s[36:39], s52 offen offset:3072
    s_waitcnt vmcnt(20)
    v_mfma_f32_16x16x32_bf16 v[148:151], v[116:119], v[16:19], v[148:151]
    v_mfma_f32_16x16x32_bf16 v[152:155], v[116:119], v[20:23], v[152:155]
    v_mfma_f32_16x16x32_bf16 v[156:159], v[116:119], v[24:27], v[156:159]
    v_mfma_f32_16x16x32_bf16 v[160:163], v[116:119], v[28:31], v[160:163]
    s_add_u32 s52, s52, 4096
    buffer_load_dwordx4 v[116:119], v2, s[36:39], s52 offen offset:0
    s_waitcnt vmcnt(20)
    v_mfma_f32_16x16x32_bf16 v[164:167], v[120:123], v[16:19], v[164:167]
    v_mfma_f32_16x16x32_bf16 v[168:171], v[120:123], v[20:23], v[168:171]
    v_mfma_f32_16x16x32_bf16 v[172:175], v[120:123], v[24:27], v[172:175]
    v_mfma_f32_16x16x32_bf16 v[176:179], v[120:123], v[28:31], v[176:179]
    buffer_load_dwordx4 v[120:123], v2, s[36:39], s52 offen offset:1024
    s_waitcnt vmcnt(20)
    v_mfma_f32_16x16x32_bf16 v[180:183], v[124:127], v[16:19], v[180:183]
    v_mfma_f32_16x16x32_bf16 v[184:187], v[124:127], v[20:23], v[184:187]
    v_mfma_f32_16x16x32_bf16 v[188:191], v[124:127], v[24:27], v[188:191]
    v_mfma_f32_16x16x32_bf16 v[192:195], v[124:127], v[28:31], v[192:195]
    buffer_load_dwordx4 v[124:127], v2, s[36:39], s52 offen offset:2048
    s_waitcnt vmcnt(20)
    v_mfma_f32_16x16x32_bf16 v[196:199], v[128:131], v[16:19], v[196:199]
    v_mfma_f32_16x16x32_bf16 v[200:203], v[128:131], v[20:23], v[200:203]
    v_mfma_f32_16x16x32_bf16 v[204:207], v[128:131], v[24:27], v[204:207]
    v_mfma_f32_16x16x32_bf16 v[208:211], v[128:131], v[28:31], v[208:211]
    buffer_load_dwordx4 v[128:131], v2, s[36:39], s52 offen offset:3072
    s_cmp_lt_u32 s26, 4
    s_cbranch_scc1 ap24a
    s_setprio 0
    s_branch ap24b
ap24a:
    s_setprio 1
ap24b:
    s_waitcnt vmcnt(20) lgkmcnt(0)
    v_mfma_f32_16x16x32_bf16 v[132:135], v[48:51], v[32:35], v[132:135]
    ds_read_b128 v[16:19], v4 offset:1024
    v_mfma_f32_16x16x32_bf16 v[136:139], v[48:51], v[36:39], v[136:139]
    ds_read_b128 v[20:23], v4 offset:19456
    v_mfma_f32_16x16x32_bf16 v[140:143], v[48:51], v[40:43], v[140:143]
    ds_read_b128 v[24:27], v4 offset:37888
    v_mfma_f32_16x16x32_bf16 v[144:147], v[48:51], v[44:47], v[144:147]
    ds_read_b128 v[28:31], v4 offset:56320
    s_add_u32 s52, s52, 4096
    buffer_load_dwordx4 v[48:51], v2, s[36:39], s52 offen offset:0
    s_waitcnt vmcnt(20)
    v_mfma_f32_16x16x32_bf16 v[148:151], v[52:55], v[32:35], v[148:151]
    v_mfma_f32_16x16x32_bf16 v[152:155], v[52:55], v[36:39], v[152:155]
    v_mfma_f32_16x16x32_bf16 v[156:159], v[52:55], v[40:43], v[156:159]
    v_mfma_f32_16x16x32_bf16 v[160:163], v[52:55], v[44:47], v[160:163]
    buffer_load_dwordx4 v[52:55], v2, s[36:39], s52 offen offset:1024
    s_waitcnt vmcnt(20)
    v_mfma_f32_16x16x32_bf16 v[164:167], v[56:59], v[32:35], v[164:167]
    v_mfma_f32_16x16x32_bf16 v[168:171], v[56:59], v[36:39], v[168:171]
    v_mfma_f32_16x16x32_bf16 v[172:175], v[56:59], v[40:43], v[172:175]
    v_mfma_f32_16x16x32_bf16 v[176:179], v[56:59], v[44:47], v[176:179]
    buffer_load_dwordx4 v[56:59], v2, s[36:39], s52 offen offset:2048
    s_waitcnt vmcnt(20)
    v_mfma_f32_16x16x32_bf16 v[180:183], v[60:63], v[32:35], v[180:183]
    v_mfma_f32_16x16x32_bf16 v[184:187], v[60:63], v[36:39], v[184:187]
    v_mfma_f32_16x16x32_bf16 v[188:191], v[60:63], v[40:43], v[188:191]
    v_mfma_f32_16x16x32_bf16 v[192:195], v[60:63], v[44:47], v[192:195]
    buffer_load_dwordx4 v[60:63], v2, s[36:39], s52 offen offset:3072
    s_waitcnt vmcnt(20)
    v_mfma_f32_16x16x32_bf16 v[196:199], v[64:67], v[32:35], v[196:199]
    v_mfma_f32_16x16x32_bf16 v[200:203], v[64:67], v[36:39], v[200:203]
    v_mfma_f32_16x16x32_bf16 v[204:207], v[64:67], v[40:43], v[204:207]
    v_mfma_f32_16x16x32_bf16 v[208:211], v[64:67], v[44:47], v[208:211]
    s_add_u32 s52, s52, 4096
    buffer_load_dwordx4 v[64:67], v2, s[36:39], s52 offen offset:0
    s_waitcnt vmcnt(20) lgkmcnt(0)
    v_mfma_f32_16x16x32_bf16 v[132:135], v[68:71], v[16:19], v[132:135]
    ds_read_b128 v[32:35], v5 offset:1024
    v_mfma_f32_16x16x32_bf16 v[136:139], v[68:71], v[20:23], v[136:139]
    ds_read_b128 v[36:39], v5 offset:19456
    v_mfma_f32_16x16x32_bf16 v[140:143], v[68:71], v[24:27], v[140:143]
    ds_read_b128 v[40:43], v5 offset:37888
    v_mfma_f32_16x16x32_bf16 v[144:147], v[68:71], v[28:31], v[144:147]
    ds_read_b128 v[44:47], v5 offset:56320
    buffer_load_dwordx4 v[68:71], v2, s[36:39], s52 offen offset:1024
    s_waitcnt vmcnt(20)
    v_mfma_f32_16x16x32_bf16 v[148:151], v[72:75], v[16:19], v[148:151]
    v_mfma_f32_16x16x32_bf16 v[152:155], v[72:75], v[20:23], v[152:155]
    v_mfma_f32_16x16x32_bf16 v[156:159], v[72:75], v[24:27], v[156:159]
    v_mfma_f32_16x16x32_bf16 v[160:163], v[72:75], v[28:31], v[160:163]
    buffer_load_dwordx4 v[72:75], v2, s[36:39], s52 offen offset:2048
    s_waitcnt vmcnt(20)
    v_mfma_f32_16x16x32_bf16 v[164:167], v[76:79], v[16:19], v[164:167]
    v_mfma_f32_16x16x32_bf16 v[168:171], v[76:79], v[20:23], v[168:171]
    v_mfma_f32_16x16x32_bf16 v[172:175], v[76:79], v[24:27], v[172:175]
    v_mfma_f32_16x16x32_bf16 v[176:179], v[76:79], v[28:31], v[176:179]
    buffer_load_dwordx4 v[76:79], v2, s[36:39], s52 offen offset:3072
    s_waitcnt vmcnt(20)
    v_mfma_f32_16x16x32_bf16 v[180:183], v[80:83], v[16:19], v[180:183]
    v_mfma_f32_16x16x32_bf16 v[184:187], v[80:83], v[20:23], v[184:187]
    v_mfma_f32_16x16x32_bf16 v[188:191], v[80:83], v[24:27], v[188:191]
    v_mfma_f32_16x16x32_bf16 v[192:195], v[80:83], v[28:31], v[192:195]
    s_add_u32 s52, s52, 4096
    buffer_load_dwordx4 v[80:83], v2, s[36:39], s52 offen offset:0
    s_waitcnt vmcnt(20)
    v_mfma_f32_16x16x32_bf16 v[196:199], v[84:87], v[16:19], v[196:199]
    v_mfma_f32_16x16x32_bf16 v[200:203], v[84:87], v[20:23], v[200:203]
    v_mfma_f32_16x16x32_bf16 v[204:207], v[84:87], v[24:27], v[204:207]
    v_mfma_f32_16x16x32_bf16 v[208:211], v[84:87], v[28:31], v[208:211]
    buffer_load_dwordx4 v[84:87], v2, s[36:39], s52 offen offset:1024
    s_waitcnt vmcnt(20) lgkmcnt(0)
    v_mfma_f32_16x16x32_bf16 v[132:135], v[88:91], v[32:35], v[132:135]
    v_mfma_f32_16x16x32_bf16 v[136:139], v[88:91], v[36:39], v[136:139]
    v_mfma_f32_16x16x32_bf16 v[140:143], v[88:91], v[40:43], v[140:143]
    v_mfma_f32_16x16x32_bf16 v[144:147], v[88:91], v[44:47], v[144:147]
    buffer_load_dwordx4 v[88:91], v2, s[36:39], s52 offen offset:2048
    s_waitcnt vmcnt(20)
    v_mfma_f32_16x16x32_bf16 v[148:151], v[92:95], v[32:35], v[148:151]
    v_mfma_f32_16x16x32_bf16 v[152:155], v[92:95], v[36:39], v[152:155]
    v_mfma_f32_16x16x32_bf16 v[156:159], v[92:95], v[40:43], v[156:159]
    v_mfma_f32_16x16x32_bf16 v[160:163], v[92:95], v[44:47], v[160:163]
    buffer_load_dwordx4 v[92:95], v2, s[36:39], s52 offen offset:3072
    s_waitcnt vmcnt(20)
    v_mfma_f32_16x16x32_bf16 v[164:167], v[96:99], v[32:35], v[164:167]
    v_mfma_f32_16x16x32_bf16 v[168:171], v[96:99], v[36:39], v[168:171]
    v_mfma_f32_16x16x32_bf16 v[172:175], v[96:99], v[40:43], v[172:175]
    v_mfma_f32_16x16x32_bf16 v[176:179], v[96:99], v[44:47], v[176:179]
    s_add_u32 s52, s52, 4096
    buffer_load_dwordx4 v[96:99], v2, s[36:39], s52 offen offset:0
    s_waitcnt vmcnt(20)
    v_mfma_f32_16x16x32_bf16 v[180:183], v[100:103], v[32:35], v[180:183]
    v_mfma_f32_16x16x32_bf16 v[184:187], v[100:103], v[36:39], v[184:187]
    v_mfma_f32_16x16x32_bf16 v[188:191], v[100:103], v[40:43], v[188:191]
    v_mfma_f32_16x16x32_bf16 v[192:195], v[100:103], v[44:47], v[192:195]
    buffer_load_dwordx4 v[100:103], v2, s[36:39], s52 offen offset:1024
    s_waitcnt vmcnt(20)
    v_mfma_f32_16x16x32_bf16 v[196:199], v[104:107], v[32:35], v[196:199]
    v_mfma_f32_16x16x32_bf16 v[200:203], v[104:107], v[36:39], v[200:203]
    v_mfma_f32_16x16x32_bf16 v[204:207], v[104:107], v[40:43], v[204:207]
    v_mfma_f32_16x16x32_bf16 v[208:211], v[104:107], v[44:47], v[208:211]
    buffer_load_dwordx4 v[104:107], v2, s[36:39], s52 offen offset:2048
    s_nop 7
    v_mul_f32 v232, v132, v132
    v_mul_f32 v233, v133, v133
    v_mul_f32 v234, v148, v148
    v_mul_f32 v235, v149, v149
    v_mul_f32 v236, v164, v164
    v_mul_f32 v237, v165, v165
    v_mul_f32 v238, v180, v180
    v_mul_f32 v239, v181, v181
    v_fma_f32 v232, v232, s57, v11
    v_fma_f32 v233, v233, s57, v11
    v_fma_f32 v234, v234, s57, v11
    v_fma_f32 v235, v235, s57, v11
    v_fma_f32 v236, v236, s57, v11
    v_fma_f32 v237, v237, s57, v11
    v_fma_f32 v238, v238, s57, v11
    v_fma_f32 v239, v239, s57, v11
    v_mul_f32 v232, v232, v132
    v_mul_f32 v233, v233, v133
    v_mul_f32 v234, v234, v148
    v_mul_f32 v235, v235, v149
    v_mul_f32 v236, v236, v164
    v_mul_f32 v237, v237, v165
    v_mul_f32 v238, v238, v180
    v_mul_f32 v239, v239, v181
    v_exp_f32 v232, v232
    v_exp_f32 v233, v233
    v_exp_f32 v234, v234
    v_exp_f32 v235, v235
    v_exp_f32 v236, v236
    v_exp_f32 v237, v237
    v_exp_f32 v238, v238
    v_exp_f32 v239, v239
    v_mul_f32 v240, v132, v134
    v_mul_f32 v241, v133, v135
    v_mul_f32 v242, v148, v150
    v_mul_f32 v243, v149, v151
    v_mul_f32 v244, v164, v166
    v_mul_f32 v245, v165, v167
    v_mul_f32 v246, v180, v182
    v_mul_f32 v247, v181, v183
    v_add_f32 v232, 1.0, v232
    v_add_f32 v233, 1.0, v233
    v_add_f32 v234, 1.0, v234
    v_add_f32 v235, 1.0, v235
    v_add_f32 v236, 1.0, v236
    v_add_f32 v237, 1.0, v237
    v_add_f32 v238, 1.0, v238
    v_add_f32 v239, 1.0, v239
    v_rcp_f32 v232, v232
    v_rcp_f32 v233, v233
    v_rcp_f32 v234, v234
    v_rcp_f32 v235, v235
    v_rcp_f32 v236, v236
    v_rcp_f32 v237, v237
    v_rcp_f32 v238, v238
    v_rcp_f32 v239, v239
    v_mul_f32 v240, v240, v232
    v_mul_f32 v241, v241, v233
    v_mul_f32 v242, v242, v234
    v_mul_f32 v243, v243, v235
    v_mul_f32 v244, v244, v236
    v_mul_f32 v245, v245, v237
    v_mul_f32 v246, v246, v238
    v_mul_f32 v247, v247, v239
    v_cvt_pk_bf16_f32 v248, v240, v241
    v_cvt_pk_bf16_f32 v249, v242, v243
    v_cvt_pk_bf16_f32 v250, v244, v245
    v_cvt_pk_bf16_f32 v251, v246, v247
    ds_write_b128 v9, v[248:251] offset:0
    v_mul_f32 v232, v136, v136
    v_mul_f32 v233, v137, v137
    v_mul_f32 v234, v152, v152
    v_mul_f32 v235, v153, v153
    v_mul_f32 v236, v168, v168
    v_mul_f32 v237, v169, v169
    v_mul_f32 v238, v184, v184
    v_mul_f32 v239, v185, v185
    v_fma_f32 v232, v232, s57, v11
    v_fma_f32 v233, v233, s57, v11
    v_fma_f32 v234, v234, s57, v11
    v_fma_f32 v235, v235, s57, v11
    v_fma_f32 v236, v236, s57, v11
    v_fma_f32 v237, v237, s57, v11
    v_fma_f32 v238, v238, s57, v11
    v_fma_f32 v239, v239, s57, v11
    v_mul_f32 v232, v232, v136
    v_mul_f32 v233, v233, v137
    v_mul_f32 v234, v234, v152
    v_mul_f32 v235, v235, v153
    v_mul_f32 v236, v236, v168
    v_mul_f32 v237, v237, v169
    v_mul_f32 v238, v238, v184
    v_mul_f32 v239, v239, v185
    v_exp_f32 v232, v232
    v_exp_f32 v233, v233
    v_exp_f32 v234, v234
    v_exp_f32 v235, v235
    v_exp_f32 v236, v236
    v_exp_f32 v237, v237
    v_exp_f32 v238, v238
    v_exp_f32 v239, v239
    v_mul_f32 v240, v136, v138
    v_mul_f32 v241, v137, v139
    v_mul_f32 v242, v152, v154
    v_mul_f32 v243, v153, v155
    v_mul_f32 v244, v168, v170
    v_mul_f32 v245, v169, v171
    v_mul_f32 v246, v184, v186
    v_mul_f32 v247, v185, v187
    v_add_f32 v232, 1.0, v232
    v_add_f32 v233, 1.0, v233
    v_add_f32 v234, 1.0, v234
    v_add_f32 v235, 1.0, v235
    v_add_f32 v236, 1.0, v236
    v_add_f32 v237, 1.0, v237
    v_add_f32 v238, 1.0, v238
    v_add_f32 v239, 1.0, v239
    v_rcp_f32 v232, v232
    v_rcp_f32 v233, v233
    v_rcp_f32 v234, v234
    v_rcp_f32 v235, v235
    v_rcp_f32 v236, v236
    v_rcp_f32 v237, v237
    v_rcp_f32 v238, v238
    v_rcp_f32 v239, v239
    v_mul_f32 v240, v240, v232
    v_mul_f32 v241, v241, v233
    v_mul_f32 v242, v242, v234
    v_mul_f32 v243, v243, v235
    v_mul_f32 v244, v244, v236
    v_mul_f32 v245, v245, v237
    v_mul_f32 v246, v246, v238
    v_mul_f32 v247, v247, v239
    v_cvt_pk_bf16_f32 v252, v240, v241
    v_cvt_pk_bf16_f32 v253, v242, v243
    v_cvt_pk_bf16_f32 v254, v244, v245
    v_cvt_pk_bf16_f32 v255, v246, v247
    ds_write_b128 v9, v[252:255] offset:18432
    v_mul_f32 v232, v140, v140
    v_mul_f32 v233, v141, v141
    v_mul_f32 v234, v156, v156
    v_mul_f32 v235, v157, v157
    v_mul_f32 v236, v172, v172
    v_mul_f32 v237, v173, v173
    v_mul_f32 v238, v188, v188
    v_mul_f32 v239, v189, v189
    v_fma_f32 v232, v232, s57, v11
    v_fma_f32 v233, v233, s57, v11
    v_fma_f32 v234, v234, s57, v11
    v_fma_f32 v235, v235, s57, v11
    v_fma_f32 v236, v236, s57, v11
    v_fma_f32 v237, v237, s57, v11
    v_fma_f32 v238, v238, s57, v11
    v_fma_f32 v239, v239, s57, v11
    v_mul_f32 v232, v232, v140
    v_mul_f32 v233, v233, v141
    v_mul_f32 v234, v234, v156
    v_mul_f32 v235, v235, v157
    v_mul_f32 v236, v236, v172
    v_mul_f32 v237, v237, v173
    v_mul_f32 v238, v238, v188
    v_mul_f32 v239, v239, v189
    v_exp_f32 v232, v232
    v_exp_f32 v233, v233
    v_exp_f32 v234, v234
    v_exp_f32 v235, v235
    v_exp_f32 v236, v236
    v_exp_f32 v237, v237
    v_exp_f32 v238, v238
    v_exp_f32 v239, v239
    v_mul_f32 v240, v140, v142
    v_mul_f32 v241, v141, v143
    v_mul_f32 v242, v156, v158
    v_mul_f32 v243, v157, v159
    v_mul_f32 v244, v172, v174
    v_mul_f32 v245, v173, v175
    v_mul_f32 v246, v188, v190
    v_mul_f32 v247, v189, v191
    v_add_f32 v232, 1.0, v232
    v_add_f32 v233, 1.0, v233
    v_add_f32 v234, 1.0, v234
    v_add_f32 v235, 1.0, v235
    v_add_f32 v236, 1.0, v236
    v_add_f32 v237, 1.0, v237
    v_add_f32 v238, 1.0, v238
    v_add_f32 v239, 1.0, v239
    v_rcp_f32 v232, v232
    v_rcp_f32 v233, v233
    v_rcp_f32 v234, v234
    v_rcp_f32 v235, v235
    v_rcp_f32 v236, v236
    v_rcp_f32 v237, v237
    v_rcp_f32 v238, v238
    v_rcp_f32 v239, v239
    v_mul_f32 v240, v240, v232
    v_mul_f32 v241, v241, v233
    v_mul_f32 v242, v242, v234
    v_mul_f32 v243, v243, v235
    v_mul_f32 v244, v244, v236
    v_mul_f32 v245, v245, v237
    v_mul_f32 v246, v246, v238
    v_mul_f32 v247, v247, v239
    v_cvt_pk_bf16_f32 v248, v240, v241
    v_cvt_pk_bf16_f32 v249, v242, v243
    v_cvt_pk_bf16_f32 v250, v244, v245
    v_cvt_pk_bf16_f32 v251, v246, v247
    ds_write_b128 v9, v[248:251] offset:36864
    v_mul_f32 v232, v144, v144
    v_mul_f32 v233, v145, v145
    v_mul_f32 v234, v160, v160
    v_mul_f32 v235, v161, v161
    v_mul_f32 v236, v176, v176
    v_mul_f32 v237, v177, v177
    v_mul_f32 v238, v192, v192
    v_mul_f32 v239, v193, v193
    v_fma_f32 v232, v232, s57, v11
    v_fma_f32 v233, v233, s57, v11
    v_fma_f32 v234, v234, s57, v11
    v_fma_f32 v235, v235, s57, v11
    v_fma_f32 v236, v236, s57, v11
    v_fma_f32 v237, v237, s57, v11
    v_fma_f32 v238, v238, s57, v11
    v_fma_f32 v239, v239, s57, v11
    v_mul_f32 v232, v232, v144
    v_mul_f32 v233, v233, v145
    v_mul_f32 v234, v234, v160
    v_mul_f32 v235, v235, v161
    v_mul_f32 v236, v236, v176
    v_mul_f32 v237, v237, v177
    v_mul_f32 v238, v238, v192
    v_mul_f32 v239, v239, v193
    v_exp_f32 v232, v232
    v_exp_f32 v233, v233
    v_exp_f32 v234, v234
    v_exp_f32 v235, v235
    v_exp_f32 v236, v236
    v_exp_f32 v237, v237
    v_exp_f32 v238, v238
    v_exp_f32 v239, v239
    v_mul_f32 v240, v144, v146
    v_mul_f32 v241, v145, v147
    v_mul_f32 v242, v160, v162
    v_mul_f32 v243, v161, v163
    v_mul_f32 v244, v176, v178
    v_mul_f32 v245, v177, v179
    v_mul_f32 v246, v192, v194
    v_mul_f32 v247, v193, v195
    v_add_f32 v232, 1.0, v232
    v_add_f32 v233, 1.0, v233
    v_add_f32 v234, 1.0, v234
    v_add_f32 v235, 1.0, v235
    v_add_f32 v236, 1.0, v236
    v_add_f32 v237, 1.0, v237
    v_add_f32 v238, 1.0, v238
    v_add_f32 v239, 1.0, v239
    v_rcp_f32 v232, v232
    v_rcp_f32 v233, v233
    v_rcp_f32 v234, v234
    v_rcp_f32 v235, v235
    v_rcp_f32 v236, v236
    v_rcp_f32 v237, v237
    v_rcp_f32 v238, v238
    v_rcp_f32 v239, v239
    v_mul_f32 v240, v240, v232
    v_mul_f32 v241, v241, v233
    v_mul_f32 v242, v242, v234
    v_mul_f32 v243, v243, v235
    v_mul_f32 v244, v244, v236
    v_mul_f32 v245, v245, v237
    v_mul_f32 v246, v246, v238
    v_mul_f32 v247, v247, v239
    v_cvt_pk_bf16_f32 v252, v240, v241
    v_cvt_pk_bf16_f32 v253, v242, v243
    v_cvt_pk_bf16_f32 v254, v244, v245
    v_cvt_pk_bf16_f32 v255, v246, v247
    ds_write_b128 v9, v[252:255] offset:55296
    v_mul_f32 v232, v196, v196
    v_mul_f32 v233, v197, v197
    v_fma_f32 v232, v232, s57, v11
    v_fma_f32 v233, v233, s57, v11
    v_mul_f32 v232, v232, v196
    v_mul_f32 v233, v233, v197
    v_exp_f32 v232, v232
    v_exp_f32 v233, v233
    v_mul_f32 v240, v196, v198
    v_mul_f32 v241, v197, v199
    v_add_f32 v232, 1.0, v232
    v_add_f32 v233, 1.0, v233
    v_rcp_f32 v232, v232
    v_rcp_f32 v233, v233
    s_nop 0
    v_mul_f32 v240, v240, v232
    v_mul_f32 v241, v241, v233
    v_cvt_pk_bf16_f32 v248, v240, v241
    ds_write_b32 v10, v248 offset:0
    v_mul_f32 v232, v200, v200
    v_mul_f32 v233, v201, v201
    v_fma_f32 v232, v232, s57, v11
    v_fma_f32 v233, v233, s57, v11
    v_mul_f32 v232, v232, v200
    v_mul_f32 v233, v233, v201
    v_exp_f32 v232, v232
    v_exp_f32 v233, v233
    v_mul_f32 v240, v200, v202
    v_mul_f32 v241, v201, v203
    v_add_f32 v232, 1.0, v232
    v_add_f32 v233, 1.0, v233
    v_rcp_f32 v232, v232
    v_rcp_f32 v233, v233
    s_nop 0
    v_mul_f32 v240, v240, v232
    v_mul_f32 v241, v241, v233
    v_cvt_pk_bf16_f32 v252, v240, v241
    ds_write_b32 v10, v252 offset:18432
    v_mul_f32 v232, v204, v204
    v_mul_f32 v233, v205, v205
    v_fma_f32 v232, v232, s57, v11
    v_fma_f32 v233, v233, s57, v11
    v_mul_f32 v232, v232, v204
    v_mul_f32 v233, v233, v205
    v_exp_f32 v232, v232
    v_exp_f32 v233, v233
    v_mul_f32 v240, v204, v206
    v_mul_f32 v241, v205, v207
    v_add_f32 v232, 1.0, v232
    v_add_f32 v233, 1.0, v233
    v_rcp_f32 v232, v232
    v_rcp_f32 v233, v233
    s_nop 0
    v_mul_f32 v240, v240, v232
    v_mul_f32 v241, v241, v233
    v_cvt_pk_bf16_f32 v248, v240, v241
    ds_write_b32 v10, v248 offset:36864
    v_mul_f32 v232, v208, v208
    v_mul_f32 v233, v209, v209
    v_fma_f32 v232, v232, s57, v11
    v_fma_f32 v233, v233, s57, v11
    v_mul_f32 v232, v232, v208
    v_mul_f32 v233, v233, v209
    v_exp_f32 v232, v232
    v_exp_f32 v233, v233
    v_mul_f32 v240, v208, v210
    v_mul_f32 v241, v209, v211
    v_add_f32 v232, 1.0, v232
    v_add_f32 v233, 1.0, v233
    v_rcp_f32 v232, v232
    v_rcp_f32 v233, v233
    s_nop 0
    v_mul_f32 v240, v240, v232
    v_mul_f32 v241, v241, v233
    v_cvt_pk_bf16_f32 v252, v240, v241
    ds_write_b32 v10, v252 offset:55296
    s_waitcnt lgkmcnt(0)
    s_cmp_lt_u32 s26, 4
    s_cselect_b32 s58, 0, 4
    s_add_u32 s58, s58, 147456
    v_mov_b32 v14, s58
    v_mov_b32 v15, 1
    s_mov_b64 exec, 1
    ds_add_u32 v14, v15
    s_mov_b64 exec, -1
    s_cmp_ge_u32 s26, 4
    s_cbranch_scc1 p3_c1
p3_wa0:
    ds_read_b32 v15, v12
    s_waitcnt lgkmcnt(0)
    v_readfirstlane_b32 s58, v15
    s_cmp_ge_u32 s58, 4
    s_cbranch_scc1 p3_wa0_ok
    s_cmp_eq_u32 s28, 0
    s_cbranch_scc1 p3_wa0_ok
    s_sub_u32 s28, s28, 1
    s_sleep 1
    s_branch p3_wa0
p3_wa0_ok:
    ds_read_b128 v[16:19], v6 offset:0
    ds_read_b128 v[20:23], v6 offset:18432
    ds_read_b128 v[24:27], v6 offset:36864
    ds_read_b128 v[28:31], v6 offset:55296
    ds_read_b128 v[32:35], v7 offset:0
    ds_read_b128 v[36:39], v7 offset:18432
    ds_read_b128 v[40:43], v7 offset:36864
    ds_read_b128 v[44:47], v7 offset:55296
    s_setprio 0
    s_waitcnt vmcnt(20) lgkmcnt(4)
    v_mfma_f32_16x16x32_bf16 v[132:135], v[108:111], v[16:19], 0
    ds_read_b128 v[212:215], v6 offset:128
    v_mfma_f32_16x16x32_bf16 v[136:139], v[108:111], v[20:23], 0
    v_mfma_f32_16x16x32_bf16 v[140:143], v[108:111], v[24:27], 0
    ds_read_b128 v[216:219], v6 offset:18560
    v_mfma_f32_16x16x32_bf16 v[144:147], v[108:111], v[28:31], 0
    buffer_load_dwordx4 v[108:111], v2, s[36:39], s52 offen offset:3072
    s_waitcnt vmcnt(20)
    v_mfma_f32_16x16x32_bf16 v[148:151], v[112:115], v[16:19], 0
    ds_read_b128 v[220:223], v6 offset:36992
    v_mfma_f32_16x16x32_bf16 v[152:155], v[112:115], v[20:23], 0
    v_mfma_f32_16x16x32_bf16 v[156:159], v[112:115], v[24:27], 0
    ds_read_b128 v[224:227], v6 offset:55424
    v_mfma_f32_16x16x32_bf16 v[160:163], v[112:115], v[28:31], 0
    s_add_u32 s52, s52, 4096
    buffer_load_dwordx4 v[112:115], v2, s[36:39], s52 offen offset:0
    s_waitcnt vmcnt(20) lgkmcnt(4)
    v_mfma_f32_16x16x32_bf16 v[132:135], v[116:119], v[32:35], v[132:135]
    ds_read_b128 v[16:19], v7 offset:128
    v_mfma_f32_16x16x32_bf16 v[136:139], v[116:119], v[36:39], v[136:139]
    v_mfma_f32_16x16x32_bf16 v[140:143], v[116:119], v[40:43], v[140:143]
    ds_read_b128 v[20:23], v7 offset:18560
    v_mfma_f32_16x16x32_bf16 v[144:147], v[116:119], v[44:47], v[144:147]
    buffer_load_dwordx4 v[116:119], v2, s[36:39], s52 offen offset:1024
    s_waitcnt vmcnt(20)
    v_mfma_f32_16x16x32_bf16 v[148:151], v[120:123], v[32:35], v[148:151]
    ds_read_b128 v[24:27], v7 offset:36992
    v_mfma_f32_16x16x32_bf16 v[152:155], v[120:123], v[36:39], v[152:155]
    v_mfma_f32_16x16x32_bf16 v[156:159], v[120:123], v[40:43], v[156:159]
    ds_read_b128 v[28:31], v7 offset:55424
    v_mfma_f32_16x16x32_bf16 v[160:163], v[120:123], v[44:47], v[160:163]
    buffer_load_dwordx4 v[120:123], v2, s[36:39], s52 offen offset:2048
    s_waitcnt vmcnt(20) lgkmcnt(4)
    v_mfma_f32_16x16x32_bf16 v[132:135], v[124:127], v[212:215], v[132:135]
    ds_read_b128 v[32:35], v6 offset:256
    v_mfma_f32_16x16x32_bf16 v[136:139], v[124:127], v[216:219], v[136:139]
    v_mfma_f32_16x16x32_bf16 v[140:143], v[124:127], v[220:223], v[140:143]
    ds_read_b128 v[36:39], v6 offset:18688
    v_mfma_f32_16x16x32_bf16 v[144:147], v[124:127], v[224:227], v[144:147]
    buffer_load_dwordx4 v[124:127], v2, s[36:39], s52 offen offset:3072
    s_waitcnt vmcnt(20)
    v_mfma_f32_16x16x32_bf16 v[148:151], v[128:131], v[212:215], v[148:151]
    ds_read_b128 v[40:43], v6 offset:37120
    v_mfma_f32_16x16x32_bf16 v[152:155], v[128:131], v[216:219], v[152:155]
    v_mfma_f32_16x16x32_bf16 v[156:159], v[128:131], v[220:223], v[156:159]
    ds_read_b128 v[44:47], v6 offset:55552
    v_mfma_f32_16x16x32_bf16 v[160:163], v[128:131], v[224:227], v[160:163]
    s_add_u32 s52, s52, 4096
    buffer_load_dwordx4 v[128:131], v2, s[36:39], s52 offen offset:0
    s_setprio 1
    s_waitcnt vmcnt(20) lgkmcnt(4)
    v_mfma_f32_16x16x32_bf16 v[132:135], v[48:51], v[16:19], v[132:135]
    ds_read_b128 v[212:215], v7 offset:256
    v_mfma_f32_16x16x32_bf16 v[136:139], v[48:51], v[20:23], v[136:139]
    v_mfma_f32_16x16x32_bf16 v[140:143], v[48:51], v[24:27], v[140:143]
    ds_read_b128 v[216:219], v7 offset:18688
    v_mfma_f32_16x16x32_bf16 v[144:147], v[48:51], v[28:31], v[144:147]
    buffer_load_dwordx4 v[48:51], v2, s[36:39], s52 offen offset:1024
    s_waitcnt vmcnt(20)
    v_mfma_f32_16x16x32_bf16 v[148:151], v[52:55], v[16:19], v[148:151]
    ds_read_b128 v[220:223], v7 offset:37120
    v_mfma_f32_16x16x32_bf16 v[152:155], v[52:55], v[20:23], v[152:155]
    v_mfma_f32_16x16x32_bf16 v[156:159], v[52:55], v[24:27], v[156:159]
    ds_read_b128 v[224:227], v7 offset:55552
    v_mfma_f32_16x16x32_bf16 v[160:163], v[52:55], v[28:31], v[160:163]
    buffer_load_dwordx4 v[52:55], v2, s[36:39], s52 offen offset:2048
    s_waitcnt vmcnt(20) lgkmcnt(4)
    v_mfma_f32_16x16x32_bf16 v[132:135], v[56:59], v[32:35], v[132:135]
    ds_read_b128 v[16:19], v6 offset:384
    v_mfma_f32_16x16x32_bf16 v[136:139], v[56:59], v[36:39], v[136:139]
    v_mfma_f32_16x16x32_bf16 v[140:143], v[56:59], v[40:43], v[140:143]
    ds_read_b128 v[20:23], v6 offset:18816
    v_mfma_f32_16x16x32_bf16 v[144:147], v[56:59], v[44:47], v[144:147]
    buffer_load_dwordx4 v[56:59], v2, s[36:39], s52 offen offset:3072
    s_waitcnt vmcnt(20)
    v_mfma_f32_16x16x32_bf16 v[148:151], v[60:63], v[32:35], v[148:151]
    ds_read_b128 v[24:27], v6 offset:37248
    v_mfma_f32_16x16x32_bf16 v[152:155], v[60:63], v[36:39], v[152:155]
    v_mfma_f32_16x16x32_bf16 v[156:159], v[60:63], v[40:43], v[156:159]
    ds_read_b128 v[28:31], v6 offset:55680
    v_mfma_f32_16x16x32_bf16 v[160:163], v[60:63], v[44:47], v[160:163]
    s_add_u32 s52, s52, 4096
    buffer_load_dwordx4 v[60:63], v2, s[36:39], s52 offen offset:0
    s_waitcnt vmcnt(20) lgkmcnt(4)
    v_mfma_f32_16x16x32_bf16 v[132:135], v[64:67], v[212:215], v[132:135]
    ds_read_b128 v[32:35], v7 offset:384
    v_mfma_f32_16x16x32_bf16 v[136:139], v[64:67], v[216:219], v[136:139]
    v_mfma_f32_16x16x32_bf16 v[140:143], v[64:67], v[220:223], v[140:143]
    ds_read_b128 v[36:39], v7 offset:18816
    v_mfma_f32_16x16x32_bf16 v[144:147], v[64:67], v[224:227], v[144:147]
    buffer_load_dwordx4 v[64:67], v2, s[36:39], s52 offen offset:1024
    s_waitcnt vmcnt(20)
    v_mfma_f32_16x16x32_bf16 v[148:151], v[68:71], v[212:215], v[148:151]
    ds_read_b128 v[40:43], v7 offset:37248
    v_mfma_f32_16x16x32_bf16 v[152:155], v[68:71], v[216:219], v[152:155]
    v_mfma_f32_16x16x32_bf16 v[156:159], v[68:71], v[220:223], v[156:159]
    ds_read_b128 v[44:47], v7 offset:55680
    v_mfma_f32_16x16x32_bf16 v[160:163], v[68:71], v[224:227], v[160:163]
    buffer_load_dwordx4 v[68:71], v2, s[36:39], s52 offen offset:2048
    s_setprio 0
    s_waitcnt vmcnt(20) lgkmcnt(4)
    v_mfma_f32_16x16x32_bf16 v[132:135], v[72:75], v[16:19], v[132:135]
    ds_read_b128 v[212:215], v6 offset:512
    v_mfma_f32_16x16x32_bf16 v[136:139], v[72:75], v[20:23], v[136:139]
    v_mfma_f32_16x16x32_bf16 v[140:143], v[72:75], v[24:27], v[140:143]
    ds_read_b128 v[216:219], v6 offset:18944
    v_mfma_f32_16x16x32_bf16 v[144:147], v[72:75], v[28:31], v[144:147]
    buffer_load_dwordx4 v[72:75], v2, s[36:39], s52 offen offset:3072
    s_waitcnt vmcnt(20)
    v_mfma_f32_16x16x32_bf16 v[148:151], v[76:79], v[16:19], v[148:151]
    ds_read_b128 v[220:223], v6 offset:37376
    v_mfma_f32_16x16x32_bf16 v[152:155], v[76:79], v[20:23], v[152:155]
    v_mfma_f32_16x16x32_bf16 v[156:159], v[76:79], v[24:27], v[156:159]
    ds_read_b128 v[224:227], v6 offset:55808
    v_mfma_f32_16x16x32_bf16 v[160:163], v[76:79], v[28:31], v[160:163]
    s_add_u32 s52, s52, 4096
    buffer_load_dwordx4 v[76:79], v2, s[36:39], s52 offen offset:0
    s_waitcnt vmcnt(20) lgkmcnt(4)
    v_mfma_f32_16x16x32_bf16 v[132:135], v[80:83], v[32:35], v[132:135]
    v_mfma_f32_16x16x32_bf16 v[136:139], v[80:83], v[36:39], v[136:139]
    v_mfma_f32_16x16x32_bf16 v[140:143], v[80:83], v[40:43], v[140:143]
    v_mfma_f32_16x16x32_bf16 v[144:147], v[80:83], v[44:47], v[144:147]
    buffer_load_dwordx4 v[80:83], v2, s[36:39], s52 offen offset:1024
    s_waitcnt vmcnt(20)
    v_mfma_f32_16x16x32_bf16 v[148:151], v[84:87], v[32:35], v[148:151]
    v_mfma_f32_16x16x32_bf16 v[152:155], v[84:87], v[36:39], v[152:155]
    v_mfma_f32_16x16x32_bf16 v[156:159], v[84:87], v[40:43], v[156:159]
    v_mfma_f32_16x16x32_bf16 v[160:163], v[84:87], v[44:47], v[160:163]
    buffer_load_dwordx4 v[84:87], v2, s[36:39], s52 offen offset:2048
    s_waitcnt vmcnt(20) lgkmcnt(0)
    v_mfma_f32_16x16x32_bf16 v[132:135], v[88:91], v[212:215], v[132:135]
    v_mfma_f32_16x16x32_bf16 v[136:139], v[88:91], v[216:219], v[136:139]
    v_mfma_f32_16x16x32_bf16 v[140:143], v[88:91], v[220:223], v[140:143]
    v_mfma_f32_16x16x32_bf16 v[144:147], v[88:91], v[224:227], v[144:147]
    buffer_load_dwordx4 v[88:91], v2, s[36:39], s52 offen offset:3072
    s_waitcnt vmcnt(20)
    v_mfma_f32_16x16x32_bf16 v[148:151], v[92:95], v[212:215], v[148:151]
    v_mfma_f32_16x16x32_bf16 v[152:155], v[92:95], v[216:219], v[152:155]
    v_mfma_f32_16x16x32_bf16 v[156:159], v[92:95], v[220:223], v[156:159]
    v_mfma_f32_16x16x32_bf16 v[160:163], v[92:95], v[224:227], v[160:163]
    s_add_u32 s52, s52, 4096
    buffer_load_dwordx4 v[92:95], v2, s[36:39], s52 offen offset:0
    ds_read_b128 v[16:19], v6 offset:0
    ds_read_b128 v[20:23], v6 offset:18432
    ds_read_b128 v[24:27], v6 offset:36864
    ds_read_b128 v[28:31], v6 offset:55296
    ds_read_b128 v[32:35], v7 offset:0
    ds_read_b128 v[36:39], v7 offset:18432
    ds_read_b128 v[40:43], v7 offset:36864
    ds_read_b128 v[44:47], v7 offset:55296
    s_setprio 0
    s_waitcnt vmcnt(20) lgkmcnt(4)
    v_mfma_f32_16x16x32_bf16 v[164:167], v[96:99], v[16:19], 0
    ds_read_b128 v[212:215], v6 offset:128
    v_mfma_f32_16x16x32_bf16 v[168:171], v[96:99], v[20:23], 0
    v_mfma_f32_16x16x32_bf16 v[172:175], v[96:99], v[24:27], 0
    ds_read_b128 v[216:219], v6 offset:18560
    v_mfma_f32_16x16x32_bf16 v[176:179], v[96:99], v[28:31], 0
    buffer_load_dwordx4 v[96:99], v2, s[36:39], s52 offen offset:1024
    s_waitcnt vmcnt(20)
    v_mfma_f32_16x16x32_bf16 v[180:183], v[100:103], v[16:19], 0
    ds_read_b128 v[220:223], v6 offset:36992
    v_mfma_f32_16x16x32_bf16 v[184:187], v[100:103], v[20:23], 0
    v_mfma_f32_16x16x32_bf16 v[188:191], v[100:103], v[24:27], 0
    ds_read_b128 v[224:227], v6 offset:55424
    v_mfma_f32_16x16x32_bf16 v[192:195], v[100:103], v[28:31], 0
    buffer_load_dwordx4 v[100:103], v2, s[36:39], s52 offen offset:2048
    s_waitcnt vmcnt(20)
    v_mfma_f32_16x16x32_bf16 v[196:199], v[104:107], v[16:19], 0
    v_mfma_f32_16x16x32_bf16 v[200:203], v[104:107], v[20:23], 0
    v_mfma_f32_16x16x32_bf16 v[204:207], v[104:107], v[24:27], 0
    v_mfma_f32_16x16x32_bf16 v[208:211], v[104:107], v[28:31], 0
    buffer_load_dwordx4 v[104:107], v2, s[36:39], s52 offen offset:3072
    s_waitcnt vmcnt(20) lgkmcnt(4)
    v_mfma_f32_16x16x32_bf16 v[164:167], v[108:111], v[32:35], v[164:167]
    ds_read_b128 v[16:19], v7 offset:128
    v_mfma_f32_16x16x32_bf16 v[168:171], v[108:111], v[36:39], v[168:171]
    v_mfma_f32_16x16x32_bf16 v[172:175], v[108:111], v[40:43], v[172:175]
    ds_read_b128 v[20:23], v7 offset:18560
    v_mfma_f32_16x16x32_bf16 v[176:179], v[108:111], v[44:47], v[176:179]
    s_add_u32 s52, s52, 4096
    buffer_load_dwordx4 v[108:111], v2, s[36:39], s52 offen offset:0
    s_waitcnt vmcnt(20)
    v_mfma_f32_16x16x32_bf16 v[180:183], v[112:115], v[32:35], v[180:183]
    ds_read_b128 v[24:27], v7 offset:36992
    v_mfma_f32_16x16x32_bf16 v[184:187], v[112:115], v[36:39], v[184:187]
    v_mfma_f32_16x16x32_bf16 v[188:191], v[112:115], v[40:43], v[188:191]
    ds_read_b128 v[28:31], v7 offset:55424
    v_mfma_f32_16x16x32_bf16 v[192:195], v[112:115], v[44:47], v[192:195]
    buffer_load_dwordx4 v[112:115], v2, s[36:39], s52 offen offset:1024
    s_waitcnt vmcnt(20)
    v_mfma_f32_16x16x32_bf16 v[196:199], v[116:119], v[32:35], v[196:199]
    v_mfma_f32_16x16x32_bf16 v[200:203], v[116:119], v[36:39], v[200:203]
    v_mfma_f32_16x16x32_bf16 v[204:207], v[116:119], v[40:43], v[204:207]
    v_mfma_f32_16x16x32_bf16 v[208:211], v[116:119], v[44:47], v[208:211]
    buffer_load_dwordx4 v[116:119], v2, s[36:39], s52 offen offset:2048
    s_waitcnt vmcnt(20) lgkmcnt(4)
    v_mfma_f32_16x16x32_bf16 v[164:167], v[120:123], v[212:215], v[164:167]
    ds_read_b128 v[32:35], v6 offset:256
    v_mfma_f32_16x16x32_bf16 v[168:171], v[120:123], v[216:219], v[168:171]
    v_mfma_f32_16x16x32_bf16 v[172:175], v[120:123], v[220:223], v[172:175]
    ds_read_b128 v[36:39], v6 offset:18688
    v_mfma_f32_16x16x32_bf16 v[176:179], v[120:123], v[224:227], v[176:179]
    buffer_load_dwordx4 v[120:123], v2, s[36:39], s52 offen offset:3072
    s_waitcnt vmcnt(20)
    v_mfma_f32_16x16x32_bf16 v[180:183], v[124:127], v[212:215], v[180:183]
    ds_read_b128 v[40:43], v6 offset:37120
    v_mfma_f32_16x16x32_bf16 v[184:187], v[124:127], v[216:219], v[184:187]
    v_mfma_f32_16x16x32_bf16 v[188:191], v[124:127], v[220:223], v[188:191]
    ds_read_b128 v[44:47], v6 offset:55552
    v_mfma_f32_16x16x32_bf16 v[192:195], v[124:127], v[224:227], v[192:195]
    s_add_u32 s52, s52, 4096
    buffer_load_dwordx4 v[124:127], v2, s[36:39], s52 offen offset:0
    s_waitcnt vmcnt(20)
    v_mfma_f32_16x16x32_bf16 v[196:199], v[128:131], v[212:215], v[196:199]
    v_mfma_f32_16x16x32_bf16 v[200:203], v[128:131], v[216:219], v[200:203]
    v_mfma_f32_16x16x32_bf16 v[204:207], v[128:131], v[220:223], v[204:207]
    v_mfma_f32_16x16x32_bf16 v[208:211], v[128:131], v[224:227], v[208:211]
    buffer_load_dwordx4 v[128:131], v2, s[36:39], s52 offen offset:1024
    s_setprio 1
    s_waitcnt vmcnt(20) lgkmcnt(4)
    v_mfma_f32_16x16x32_bf16 v[164:167], v[48:51], v[16:19], v[164:167]
    ds_read_b128 v[212:215], v7 offset:256
    v_mfma_f32_16x16x32_bf16 v[168:171], v[48:51], v[20:23], v[168:171]
    v_mfma_f32_16x16x32_bf16 v[172:175], v[48:51], v[24:27], v[172:175]
    ds_read_b128 v[216:219], v7 offset:18688
    v_mfma_f32_16x16x32_bf16 v[176:179], v[48:51], v[28:31], v[176:179]
    buffer_load_dwordx4 v[48:51], v2, s[36:39], s52 offen offset:2048
    s_waitcnt vmcnt(20)
    v_mfma_f32_16x16x32_bf16 v[180:183], v[52:55], v[16:19], v[180:183]
    ds_read_b128 v[220:223], v7 offset:37120
    v_mfma_f32_16x16x32_bf16 v[184:187], v[52:55], v[20:23], v[184:187]
    v_mfma_f32_16x16x32_bf16 v[188:191], v[52:55], v[24:27], v[188:191]
    ds_read_b128 v[224:227], v7 offset:55552
    v_mfma_f32_16x16x32_bf16 v[192:195], v[52:55], v[28:31], v[192:195]
    buffer_load_dwordx4 v[52:55], v2, s[36:39], s52 offen offset:3072
    s_waitcnt vmcnt(20)
    v_mfma_f32_16x16x32_bf16 v[196:199], v[56:59], v[16:19], v[196:199]
    v_mfma_f32_16x16x32_bf16 v[200:203], v[56:59], v[20:23], v[200:203]
    v_mfma_f32_16x16x32_bf16 v[204:207], v[56:59], v[24:27], v[204:207]
    v_mfma_f32_16x16x32_bf16 v[208:211], v[56:59], v[28:31], v[208:211]
    s_add_u32 s52, s52, 4096
    buffer_load_dwordx4 v[56:59], v2, s[36:39], s52 offen offset:0
    s_waitcnt vmcnt(20) lgkmcnt(4)
    v_mfma_f32_16x16x32_bf16 v[164:167], v[60:63], v[32:35], v[164:167]
    ds_read_b128 v[16:19], v6 offset:384
    v_mfma_f32_16x16x32_bf16 v[168:171], v[60:63], v[36:39], v[168:171]
    v_mfma_f32_16x16x32_bf16 v[172:175], v[60:63], v[40:43], v[172:175]
    ds_read_b128 v[20:23], v6 offset:18816
    v_mfma_f32_16x16x32_bf16 v[176:179], v[60:63], v[44:47], v[176:179]
    buffer_load_dwordx4 v[60:63], v2, s[36:39], s52 offen offset:1024
    s_waitcnt vmcnt(20)
    v_mfma_f32_16x16x32_bf16 v[180:183], v[64:67], v[32:35], v[180:183]
    ds_read_b128 v[24:27], v6 offset:37248
    v_mfma_f32_16x16x32_bf16 v[184:187], v[64:67], v[36:39], v[184:187]
    v_mfma_f32_16x16x32_bf16 v[188:191], v[64:67], v[40:43], v[188:191]
    ds_read_b128 v[28:31], v6 offset:55680
    v_mfma_f32_16x16x32_bf16 v[192:195], v[64:67], v[44:47], v[192:195]
    buffer_load_dwordx4 v[64:67], v2, s[36:39], s52 offen offset:2048
    s_waitcnt vmcnt(20)
    v_mfma_f32_16x16x32_bf16 v[196:199], v[68:71], v[32:35], v[196:199]
    v_mfma_f32_16x16x32_bf16 v[200:203], v[68:71], v[36:39], v[200:203]
    v_mfma_f32_16x16x32_bf16 v[204:207], v[68:71], v[40:43], v[204:207]
    v_mfma_f32_16x16x32_bf16 v[208:211], v[68:71], v[44:47], v[208:211]
    buffer_load_dwordx4 v[68:71], v2, s[36:39], s52 offen offset:3072
    s_waitcnt vmcnt(20) lgkmcnt(4)
    v_mfma_f32_16x16x32_bf16 v[164:167], v[72:75], v[212:215], v[164:167]
    ds_read_b128 v[32:35], v7 offset:384
    v_mfma_f32_16x16x32_bf16 v[168:171], v[72:75], v[216:219], v[168:171]
    v_mfma_f32_16x16x32_bf16 v[172:175], v[72:75], v[220:223], v[172:175]
    ds_read_b128 v[36:39], v7 offset:18816
    v_mfma_f32_16x16x32_bf16 v[176:179], v[72:75], v[224:227], v[176:179]
    s_add_u32 s52, s52, 4096
    buffer_load_dwordx4 v[72:75], v2, s[36:39], s52 offen offset:0
    s_waitcnt vmcnt(20)
    v_mfma_f32_16x16x32_bf16 v[180:183], v[76:79], v[212:215], v[180:183]
    ds_read_b128 v[40:43], v7 offset:37248
    v_mfma_f32_16x16x32_bf16 v[184:187], v[76:79], v[216:219], v[184:187]
    v_mfma_f32_16x16x32_bf16 v[188:191], v[76:79], v[220:223], v[188:191]
    ds_read_b128 v[44:47], v7 offset:55680
    v_mfma_f32_16x16x32_bf16 v[192:195], v[76:79], v[224:227], v[192:195]
    buffer_load_dwordx4 v[76:79], v2, s[36:39], s52 offen offset:1024
    s_waitcnt vmcnt(20)
    v_mfma_f32_16x16x32_bf16 v[196:199], v[80:83], v[212:215], v[196:199]
    v_mfma_f32_16x16x32_bf16 v[200:203], v[80:83], v[216:219], v[200:203]
    v_mfma_f32_16x16x32_bf16 v[204:207], v[80:83], v[220:223], v[204:207]
    v_mfma_f32_16x16x32_bf16 v[208:211], v[80:83], v[224:227], v[208:211]
    buffer_load_dwordx4 v[80:83], v2, s[36:39], s52 offen offset:2048
    s_setprio 0
    s_waitcnt vmcnt(20) lgkmcnt(4)
    v_mfma_f32_16x16x32_bf16 v[164:167], v[84:87], v[16:19], v[164:167]
    ds_read_b128 v[212:215], v6 offset:512
    v_mfma_f32_16x16x32_bf16 v[168:171], v[84:87], v[20:23], v[168:171]
    v_mfma_f32_16x16x32_bf16 v[172:175], v[84:87], v[24:27], v[172:175]
    ds_read_b128 v[216:219], v6 offset:18944
    v_mfma_f32_16x16x32_bf16 v[176:179], v[84:87], v[28:31], v[176:179]
    buffer_load_dwordx4 v[84:87], v2, s[36:39], s52 offen offset:3072
    s_waitcnt vmcnt(20)
    v_mfma_f32_16x16x32_bf16 v[180:183], v[88:91], v[16:19], v[180:183]
    ds_read_b128 v[220:223], v6 offset:37376
    v_mfma_f32_16x16x32_bf16 v[184:187], v[88:91], v[20:23], v[184:187]
    v_mfma_f32_16x16x32_bf16 v[188:191], v[88:91], v[24:27], v[188:191]
    ds_read_b128 v[224:227], v6 offset:55808
    v_mfma_f32_16x16x32_bf16 v[192:195], v[88:91], v[28:31], v[192:195]
    s_add_u32 s52, s52, 4096
    buffer_load_dwordx4 v[88:91], v2, s[36:39], s52 offen offset:0
    s_waitcnt vmcnt(20)
    v_mfma_f32_16x16x32_bf16 v[196:199], v[92:95], v[16:19], v[196:199]
    v_mfma_f32_16x16x32_bf16 v[200:203], v[92:95], v[20:23], v[200:203]
    v_mfma_f32_16x16x32_bf16 v[204:207], v[92:95], v[24:27], v[204:207]
    v_mfma_f32_16x16x32_bf16 v[208:211], v[92:95], v[28:31], v[208:211]
    buffer_load_dwordx4 v[92:95], v2, s[36:39], s52 offen offset:1024
    s_waitcnt vmcnt(20) lgkmcnt(4)
    v_mfma_f32_16x16x32_bf16 v[164:167], v[96:99], v[32:35], v[164:167]
    v_mfma_f32_16x16x32_bf16 v[168:171], v[96:99], v[36:39], v[168:171]
    v_mfma_f32_16x16x32_bf16 v[172:175], v[96:99], v[40:43], v[172:175]
    v_mfma_f32_16x16x32_bf16 v[176:179], v[96:99], v[44:47], v[176:179]
    buffer_load_dwordx4 v[96:99], v2, s[36:39], s52 offen offset:2048
    s_waitcnt vmcnt(20)
    v_mfma_f32_16x16x32_bf16 v[180:183], v[100:103], v[32:35], v[180:183]
    v_mfma_f32_16x16x32_bf16 v[184:187], v[100:103], v[36:39], v[184:187]
    v_mfma_f32_16x16x32_bf16 v[188:191], v[100:103], v[40:43], v[188:191]
    v_mfma_f32_16x16x32_bf16 v[192:195], v[100:103], v[44:47], v[192:195]
    buffer_load_dwordx4 v[100:103], v2, s[36:39], s52 offen offset:3072
    s_waitcnt vmcnt(20)
    v_mfma_f32_16x16x32_bf16 v[196:199], v[104:107], v[32:35], v[196:199]
    v_mfma_f32_16x16x32_bf16 v[200:203], v[104:107], v[36:39], v[200:203]
    v_mfma_f32_16x16x32_bf16 v[204:207], v[104:107], v[40:43], v[204:207]
    v_mfma_f32_16x16x32_bf16 v[208:211], v[104:107], v[44:47], v[208:211]
    s_add_u32 s52, s52, 4096
    buffer_load_dwordx4 v[104:107], v2, s[36:39], s52 offen offset:0
    s_waitcnt vmcnt(20) lgkmcnt(0)
    v_mfma_f32_16x16x32_bf16 v[164:167], v[108:111], v[212:215], v[164:167]
    v_mfma_f32_16x16x32_bf16 v[168:171], v[108:111], v[216:219], v[168:171]
    v_mfma_f32_16x16x32_bf16 v[172:175], v[108:111], v[220:223], v[172:175]
    v_mfma_f32_16x16x32_bf16 v[176:179], v[108:111], v[224:227], v[176:179]
    buffer_load_dwordx4 v[108:111], v2, s[36:39], s52 offen offset:1024
    s_waitcnt vmcnt(20)
    v_mfma_f32_16x16x32_bf16 v[180:183], v[112:115], v[212:215], v[180:183]
    v_mfma_f32_16x16x32_bf16 v[184:187], v[112:115], v[216:219], v[184:187]
    v_mfma_f32_16x16x32_bf16 v[188:191], v[112:115], v[220:223], v[188:191]
    v_mfma_f32_16x16x32_bf16 v[192:195], v[112:115], v[224:227], v[192:195]
    buffer_load_dwordx4 v[112:115], v2, s[36:39], s52 offen offset:2048
    s_waitcnt vmcnt(20)
    v_mfma_f32_16x16x32_bf16 v[196:199], v[116:119], v[212:215], v[196:199]
    v_mfma_f32_16x16x32_bf16 v[200:203], v[116:119], v[216:219], v[200:203]
    v_mfma_f32_16x16x32_bf16 v[204:207], v[116:119], v[220:223], v[204:207]
    v_mfma_f32_16x16x32_bf16 v[208:211], v[116:119], v[224:227], v[208:211]
    buffer_load_dwordx4 v[116:119], v2, s[36:39], s52 offen offset:3072
p3_wb0:
    ds_read_b32 v15, v13
    s_waitcnt lgkmcnt(0)
    v_readfirstlane_b32 s58, v15
    s_cmp_ge_u32 s58, 4
    s_cbranch_scc1 p3_wb0_ok
    s_cmp_eq_u32 s28, 0
    s_cbranch_scc1 p3_wb0_ok
    s_sub_u32 s28, s28, 1
    s_sleep 1
    s_branch p3_wb0
p3_wb0_ok:
    ds_read_b128 v[16:19], v7 offset:512
    ds_read_b128 v[20:23], v7 offset:18944
    ds_read_b128 v[24:27], v7 offset:37376
    ds_read_b128 v[28:31], v7 offset:55808
    ds_read_b128 v[32:35], v6 offset:640
    ds_read_b128 v[36:39], v6 offset:19072
    ds_read_b128 v[40:43], v6 offset:37504
    ds_read_b128 v[44:47], v6 offset:55936
    s_setprio 0
    s_waitcnt vmcnt(20) lgkmcnt(4)
    v_mfma_f32_16x16x32_bf16 v[132:135], v[120:123], v[16:19], v[132:135]
    ds_read_b128 v[212:215], v7 offset:640
    v_mfma_f32_16x16x32_bf16 v[136:139], v[120:123], v[20:23], v[136:139]
    v_mfma_f32_16x16x32_bf16 v[140:143], v[120:123], v[24:27], v[140:143]
    ds_read_b128 v[216:219], v7 offset:19072
    v_mfma_f32_16x16x32_bf16 v[144:147], v[120:123], v[28:31], v[144:147]
    s_add_u32 s52, s52, 4096
    buffer_load_dwordx4 v[120:123], v2, s[36:39], s52 offen offset:0
    s_waitcnt vmcnt(20)
    v_mfma_f32_16x16x32_bf16 v[148:151], v[124:127], v[16:19], v[148:151]
    ds_read_b128 v[220:223], v7 offset:37504
    v_mfma_f32_16x16x32_bf16 v[152:155], v[124:127], v[20:23], v[152:155]
    v_mfma_f32_16x16x32_bf16 v[156:159], v[124:127], v[24:27], v[156:159]
    ds_read_b128 v[224:227], v7 offset:55936
    v_mfma_f32_16x16x32_bf16 v[160:163], v[124:127], v[28:31], v[160:163]
    buffer_load_dwordx4 v[124:127], v2, s[36:39], s52 offen offset:1024
    s_waitcnt vmcnt(20) lgkmcnt(4)
    v_mfma_f32_16x16x32_bf16 v[132:135], v[128:131], v[32:35], v[132:135]
    ds_read_b128 v[16:19], v6 offset:768
    v_mfma_f32_16x16x32_bf16 v[136:139], v[128:131], v[36:39], v[136:139]
    v_mfma_f32_16x16x32_bf16 v[140:143], v[128:131], v[40:43], v[140:143]
    ds_read_b128 v[20:23], v6 offset:19200
    v_mfma_f32_16x16x32_bf16 v[144:147], v[128:131], v[44:47], v[144:147]
    buffer_load_dwordx4 v[128:131], v2, s[36:39], s52 offen offset:2048
    s_waitcnt vmcnt(20)
    v_mfma_f32_16x16x32_bf16 v[148:151], v[48:51], v[32:35], v[148:151]
    ds_read_b128 v[24:27], v6 offset:37632
    v_mfma_f32_16x16x32_bf16 v[152:155], v[48:51], v[36:39], v[152:155]
    v_mfma_f32_16x16x32_bf16 v[156:159], v[48:51], v[40:43], v[156:159]
    ds_read_b128 v[28:31], v6 offset:56064
    v_mfma_f32_16x16x32_bf16 v[160:163], v[48:51], v[44:47], v[160:163]
    buffer_load_dwordx4 v[48:51], v2, s[36:39], s52 offen offset:3072
    s_waitcnt vmcnt(20) lgkmcnt(4)
    v_mfma_f32_16x16x32_bf16 v[132:135], v[52:55], v[212:215], v[132:135]
    ds_read_b128 v[32:35], v7 offset:768
    v_mfma_f32_16x16x32_bf16 v[136:139], v[52:55], v[216:219], v[136:139]
    v_mfma_f32_16x16x32_bf16 v[140:143], v[52:55], v[220:223], v[140:143]
    ds_read_b128 v[36:39], v7 offset:19200
    v_mfma_f32_16x16x32_bf16 v[144:147], v[52:55], v[224:227], v[144:147]
    s_add_u32 s52, s52, 4096
    buffer_load_dwordx4 v[52:55], v2, s[36:39], s52 offen offset:0
    s_waitcnt vmcnt(20)
    v_mfma_f32_16x16x32_bf16 v[148:151], v[56:59], v[212:215], v[148:151]
    ds_read_b128 v[40:43], v7 offset:37632
    v_mfma_f32_16x16x32_bf16 v[152:155], v[56:59], v[216:219], v[152:155]
    v_mfma_f32_16x16x32_bf16 v[156:159], v[56:59], v[220:223], v[156:159]
    ds_read_b128 v[44:47], v7 offset:56064
    v_mfma_f32_16x16x32_bf16 v[160:163], v[56:59], v[224:227], v[160:163]
    buffer_load_dwordx4 v[56:59], v2, s[36:39], s52 offen offset:1024
    s_setprio 1
    s_waitcnt vmcnt(20) lgkmcnt(4)
    v_mfma_f32_16x16x32_bf16 v[132:135], v[60:63], v[16:19], v[132:135]
    ds_read_b128 v[212:215], v6 offset:896
    v_mfma_f32_16x16x32_bf16 v[136:139], v[60:63], v[20:23], v[136:139]
    v_mfma_f32_16x16x32_bf16 v[140:143], v[60:63], v[24:27], v[140:143]
    ds_read_b128 v[216:219], v6 offset:19328
    v_mfma_f32_16x16x32_bf16 v[144:147], v[60:63], v[28:31], v[144:147]
    buffer_load_dwordx4 v[60:63], v2, s[36:39], s52 offen offset:2048
    s_waitcnt vmcnt(20)
    v_mfma_f32_16x16x32_bf16 v[148:151], v[64:67], v[16:19], v[148:151]
    ds_read_b128 v[220:223], v6 offset:37760
    v_mfma_f32_16x16x32_bf16 v[152:155], v[64:67], v[20:23], v[152:155]
    v_mfma_f32_16x16x32_bf16 v[156:159], v[64:67], v[24:27], v[156:159]
    ds_read_b128 v[224:227], v6 offset:56192
    v_mfma_f32_16x16x32_bf16 v[160:163], v[64:67], v[28:31], v[160:163]
    buffer_load_dwordx4 v[64:67], v2, s[36:39], s52 offen offset:3072
    s_waitcnt vmcnt(20) lgkmcnt(4)
    v_mfma_f32_16x16x32_bf16 v[132:135], v[68:71], v[32:35], v[132:135]
    ds_read_b128 v[16:19], v7 offset:896
    v_mfma_f32_16x16x32_bf16 v[136:139], v[68:71], v[36:39], v[136:139]
    v_mfma_f32_16x16x32_bf16 v[140:143], v[68:71], v[40:43], v[140:143]
    ds_read_b128 v[20:23], v7 offset:19328
    v_mfma_f32_16x16x32_bf16 v[144:147], v[68:71], v[44:47], v[144:147]
    s_add_u32 s52, s52, 4096
    buffer_load_dwordx4 v[68:71], v2, s[36:39], s52 offen offset:0
    s_waitcnt vmcnt(20)
    v_mfma_f32_16x16x32_bf16 v[148:151], v[72:75], v[32:35], v[148:151]
    ds_read_b128 v[24:27], v7 offset:37760
    v_mfma_f32_16x16x32_bf16 v[152:155], v[72:75], v[36:39], v[152:155]
    v_mfma_f32_16x16x32_bf16 v[156:159], v[72:75], v[40:43], v[156:159]
    ds_read_b128 v[28:31], v7 offset:56192
    v_mfma_f32_16x16x32_bf16 v[160:163], v[72:75], v[44:47], v[160:163]
    buffer_load_dwordx4 v[72:75], v2, s[36:39], s52 offen offset:1024
    s_waitcnt vmcnt(20) lgkmcnt(4)
    v_mfma_f32_16x16x32_bf16 v[132:135], v[76:79], v[212:215], v[132:135]
    ds_read_b128 v[32:35], v6 offset:1024
    v_mfma_f32_16x16x32_bf16 v[136:139], v[76:79], v[216:219], v[136:139]
    v_mfma_f32_16x16x32_bf16 v[140:143], v[76:79], v[220:223], v[140:143]
    ds_read_b128 v[36:39], v6 offset:19456
    v_mfma_f32_16x16x32_bf16 v[144:147], v[76:79], v[224:227], v[144:147]
    buffer_load_dwordx4 v[76:79], v2, s[36:39], s52 offen offset:2048
    s_waitcnt vmcnt(20)
    v_mfma_f32_16x16x32_bf16 v[148:151], v[80:83], v[212:215], v[148:151]
    ds_read_b128 v[40:43], v6 offset:37888
    v_mfma_f32_16x16x32_bf16 v[152:155], v[80:83], v[216:219], v[152:155]
    v_mfma_f32_16x16x32_bf16 v[156:159], v[80:83], v[220:223], v[156:159]
    ds_read_b128 v[44:47], v6 offset:56320
    v_mfma_f32_16x16x32_bf16 v[160:163], v[80:83], v[224:227], v[160:163]
    buffer_load_dwordx4 v[80:83], v2, s[36:39], s52 offen offset:3072
    s_setprio 0
    s_waitcnt vmcnt(20) lgkmcnt(4)
    v_mfma_f32_16x16x32_bf16 v[132:135], v[84:87], v[16:19], v[132:135]
    ds_read_b128 v[212:215], v7 offset:1024
    v_mfma_f32_16x16x32_bf16 v[136:139], v[84:87], v[20:23], v[136:139]
    v_mfma_f32_16x16x32_bf16 v[140:143], v[84:87], v[24:27], v[140:143]
    ds_read_b128 v[216:219], v7 offset:19456
    v_mfma_f32_16x16x32_bf16 v[144:147], v[84:87], v[28:31], v[144:147]
    s_add_u32 s52, s52, 4096
    buffer_load_dwordx4 v[84:87], v2, s[36:39], s52 offen offset:0
    s_waitcnt vmcnt(20)
    v_mfma_f32_16x16x32_bf16 v[148:151], v[88:91], v[16:19], v[148:151]
    ds_read_b128 v[220:223], v7 offset:37888
    v_mfma_f32_16x16x32_bf16 v[152:155], v[88:91], v[20:23], v[152:155]
    v_mfma_f32_16x16x32_bf16 v[156:159], v[88:91], v[24:27], v[156:159]
    ds_read_b128 v[224:227], v7 offset:56320
    v_mfma_f32_16x16x32_bf16 v[160:163], v[88:91], v[28:31], v[160:163]
    buffer_load_dwordx4 v[88:91], v2, s[36:39], s52 offen offset:1024
    s_waitcnt vmcnt(20) lgkmcnt(4)
    v_mfma_f32_16x16x32_bf16 v[132:135], v[92:95], v[32:35], v[132:135]
    v_mfma_f32_16x16x32_bf16 v[136:139], v[92:95], v[36:39], v[136:139]
    v_mfma_f32_16x16x32_bf16 v[140:143], v[92:95], v[40:43], v[140:143]
    v_mfma_f32_16x16x32_bf16 v[144:147], v[92:95], v[44:47], v[144:147]
    buffer_load_dwordx4 v[92:95], v2, s[36:39], s52 offen offset:2048
    s_waitcnt vmcnt(20)
    v_mfma_f32_16x16x32_bf16 v[148:151], v[96:99], v[32:35], v[148:151]
    v_mfma_f32_16x16x32_bf16 v[152:155], v[96:99], v[36:39], v[152:155]
    v_mfma_f32_16x16x32_bf16 v[156:159], v[96:99], v[40:43], v[156:159]
    v_mfma_f32_16x16x32_bf16 v[160:163], v[96:99], v[44:47], v[160:163]
    buffer_load_dwordx4 v[96:99], v2, s[36:39], s52 offen offset:3072
    s_waitcnt vmcnt(20) lgkmcnt(0)
    v_mfma_f32_16x16x32_bf16 v[132:135], v[100:103], v[212:215], v[132:135]
    v_mfma_f32_16x16x32_bf16 v[136:139], v[100:103], v[216:219], v[136:139]
    v_mfma_f32_16x16x32_bf16 v[140:143], v[100:103], v[220:223], v[140:143]
    v_mfma_f32_16x16x32_bf16 v[144:147], v[100:103], v[224:227], v[144:147]
    s_add_u32 s52, s52, 4096
    buffer_load_dwordx4 v[100:103], v2, s[36:39], s52 offen offset:0
    s_waitcnt vmcnt(20)
    v_mfma_f32_16x16x32_bf16 v[148:151], v[104:107], v[212:215], v[148:151]
    v_mfma_f32_16x16x32_bf16 v[152:155], v[104:107], v[216:219], v[152:155]
    v_mfma_f32_16x16x32_bf16 v[156:159], v[104:107], v[220:223], v[156:159]
    v_mfma_f32_16x16x32_bf16 v[160:163], v[104:107], v[224:227], v[160:163]
    buffer_load_dwordx4 v[104:107], v2, s[36:39], s52 offen offset:1024
    s_lshl_b32 s53, s26, 13
    s_nop 7
    v_cvt_pk_bf16_f32 v232, v132, v148
    v_cvt_pk_bf16_f32 v233, v133, v149
    v_cvt_pk_bf16_f32 v234, v134, v150
    v_cvt_pk_bf16_f32 v235, v135, v151
    buffer_store_dwordx4 v[232:235], v2, s[44:47], s53 offen offset:0 sc0 sc1
    v_cvt_pk_bf16_f32 v236, v136, v152
    v_cvt_pk_bf16_f32 v237, v137, v153
    v_cvt_pk_bf16_f32 v238, v138, v154
    v_cvt_pk_bf16_f32 v239, v139, v155
    buffer_store_dwordx4 v[236:239], v2, s[44:47], s53 offen offset:1024 sc0 sc1
    v_cvt_pk_bf16_f32 v240, v140, v156
    v_cvt_pk_bf16_f32 v241, v141, v157
    v_cvt_pk_bf16_f32 v242, v142, v158
    v_cvt_pk_bf16_f32 v243, v143, v159
    buffer_store_dwordx4 v[240:243], v2, s[44:47], s53 offen offset:2048 sc0 sc1
    v_cvt_pk_bf16_f32 v244, v144, v160
    v_cvt_pk_bf16_f32 v245, v145, v161
    v_cvt_pk_bf16_f32 v246, v146, v162
    v_cvt_pk_bf16_f32 v247, v147, v163
    buffer_store_dwordx4 v[244:247], v2, s[44:47], s53 offen offset:3072 sc0 sc1
    ds_read_b128 v[16:19], v7 offset:512
    ds_read_b128 v[20:23], v7 offset:18944
    ds_read_b128 v[24:27], v7 offset:37376
    ds_read_b128 v[28:31], v7 offset:55808
    ds_read_b128 v[32:35], v6 offset:640
    ds_read_b128 v[36:39], v6 offset:19072
    ds_read_b128 v[40:43], v6 offset:37504
    ds_read_b128 v[44:47], v6 offset:55936
    s_setprio 0
    s_waitcnt vmcnt(24) lgkmcnt(4)
    v_mfma_f32_16x16x32_bf16 v[164:167], v[108:111], v[16:19], v[164:167]
    ds_read_b128 v[212:215], v7 offset:640
    v_mfma_f32_16x16x32_bf16 v[168:171], v[108:111], v[20:23], v[168:171]
    v_mfma_f32_16x16x32_bf16 v[172:175], v[108:111], v[24:27], v[172:175]
    ds_read_b128 v[216:219], v7 offset:19072
    v_mfma_f32_16x16x32_bf16 v[176:179], v[108:111], v[28:31], v[176:179]
    buffer_load_dwordx4 v[108:111], v2, s[36:39], s52 offen offset:2048
    s_waitcnt vmcnt(24)
    v_mfma_f32_16x16x32_bf16 v[180:183], v[112:115], v[16:19], v[180:183]
    ds_read_b128 v[220:223], v7 offset:37504
    v_mfma_f32_16x16x32_bf16 v[184:187], v[112:115], v[20:23], v[184:187]
    v_mfma_f32_16x16x32_bf16 v[188:191], v[112:115], v[24:27], v[188:191]
    ds_read_b128 v[224:227], v7 offset:55936
    v_mfma_f32_16x16x32_bf16 v[192:195], v[112:115], v[28:31], v[192:195]
    buffer_load_dwordx4 v[112:115], v2, s[36:39], s52 offen offset:3072
    s_waitcnt vmcnt(24)
    v_mfma_f32_16x16x32_bf16 v[196:199], v[116:119], v[16:19], v[196:199]
    v_mfma_f32_16x16x32_bf16 v[200:203], v[116:119], v[20:23], v[200:203]
    v_mfma_f32_16x16x32_bf16 v[204:207], v[116:119], v[24:27], v[204:207]
    v_mfma_f32_16x16x32_bf16 v[208:211], v[116:119], v[28:31], v[208:211]
    s_add_u32 s52, s52, 4096
    buffer_load_dwordx4 v[116:119], v2, s[36:39], s52 offen offset:0
    s_waitcnt vmcnt(24) lgkmcnt(4)
    v_mfma_f32_16x16x32_bf16 v[164:167], v[120:123], v[32:35], v[164:167]
    ds_read_b128 v[16:19], v6 offset:768
    v_mfma_f32_16x16x32_bf16 v[168:171], v[120:123], v[36:39], v[168:171]
    v_mfma_f32_16x16x32_bf16 v[172:175], v[120:123], v[40:43], v[172:175]
    ds_read_b128 v[20:23], v6 offset:19200
    v_mfma_f32_16x16x32_bf16 v[176:179], v[120:123], v[44:47], v[176:179]
    buffer_load_dwordx4 v[120:123], v2, s[36:39], s52 offen offset:1024
    s_waitcnt vmcnt(24)
    v_mfma_f32_16x16x32_bf16 v[180:183], v[124:127], v[32:35], v[180:183]
    ds_read_b128 v[24:27], v6 offset:37632
    v_mfma_f32_16x16x32_bf16 v[184:187], v[124:127], v[36:39], v[184:187]
    v_mfma_f32_16x16x32_bf16 v[188:191], v[124:127], v[40:43], v[188:191]
    ds_read_b128 v[28:31], v6 offset:56064
    v_mfma_f32_16x16x32_bf16 v[192:195], v[124:127], v[44:47], v[192:195]
    buffer_load_dwordx4 v[124:127], v2, s[36:39], s52 offen offset:2048
    s_waitcnt vmcnt(24)
    v_mfma_f32_16x16x32_bf16 v[196:199], v[128:131], v[32:35], v[196:199]
    v_mfma_f32_16x16x32_bf16 v[200:203], v[128:131], v[36:39], v[200:203]
    v_mfma_f32_16x16x32_bf16 v[204:207], v[128:131], v[40:43], v[204:207]
    v_mfma_f32_16x16x32_bf16 v[208:211], v[128:131], v[44:47], v[208:211]
    buffer_load_dwordx4 v[128:131], v2, s[36:39], s52 offen offset:3072
    s_waitcnt vmcnt(24) lgkmcnt(4)
    v_mfma_f32_16x16x32_bf16 v[164:167], v[48:51], v[212:215], v[164:167]
    ds_read_b128 v[32:35], v7 offset:768
    v_mfma_f32_16x16x32_bf16 v[168:171], v[48:51], v[216:219], v[168:171]
    v_mfma_f32_16x16x32_bf16 v[172:175], v[48:51], v[220:223], v[172:175]
    ds_read_b128 v[36:39], v7 offset:19200
    v_mfma_f32_16x16x32_bf16 v[176:179], v[48:51], v[224:227], v[176:179]
    s_waitcnt vmcnt(23)
    v_mfma_f32_16x16x32_bf16 v[180:183], v[52:55], v[212:215], v[180:183]
    ds_read_b128 v[40:43], v7 offset:37632
    v_mfma_f32_16x16x32_bf16 v[184:187], v[52:55], v[216:219], v[184:187]
    v_mfma_f32_16x16x32_bf16 v[188:191], v[52:55], v[220:223], v[188:191]
    ds_read_b128 v[44:47], v7 offset:56064
    v_mfma_f32_16x16x32_bf16 v[192:195], v[52:55], v[224:227], v[192:195]
    s_waitcnt vmcnt(22)
    v_mfma_f32_16x16x32_bf16 v[196:199], v[56:59], v[212:215], v[196:199]
    v_mfma_f32_16x16x32_bf16 v[200:203], v[56:59], v[216:219], v[200:203]
    v_mfma_f32_16x16x32_bf16 v[204:207], v[56:59], v[220:223], v[204:207]
    v_mfma_f32_16x16x32_bf16 v[208:211], v[56:59], v[224:227], v[208:211]
    s_setprio 1
    s_waitcnt vmcnt(21) lgkmcnt(4)
    v_mfma_f32_16x16x32_bf16 v[164:167], v[60:63], v[16:19], v[164:167]
    ds_read_b128 v[212:215], v6 offset:896
    v_mfma_f32_16x16x32_bf16 v[168:171], v[60:63], v[20:23], v[168:171]
    v_mfma_f32_16x16x32_bf16 v[172:175], v[60:63], v[24:27], v[172:175]
    ds_read_b128 v[216:219], v6 offset:19328
    v_mfma_f32_16x16x32_bf16 v[176:179], v[60:63], v[28:31], v[176:179]
    s_waitcnt vmcnt(20)
    v_mfma_f32_16x16x32_bf16 v[180:183], v[64:67], v[16:19], v[180:183]
    ds_read_b128 v[220:223], v6 offset:37760
    v_mfma_f32_16x16x32_bf16 v[184:187], v[64:67], v[20:23], v[184:187]
    v_mfma_f32_16x16x32_bf16 v[188:191], v[64:67], v[24:27], v[188:191]
    ds_read_b128 v[224:227], v6 offset:56192
    v_mfma_f32_16x16x32_bf16 v[192:195], v[64:67], v[28:31], v[192:195]
    s_waitcnt vmcnt(19)
    v_mfma_f32_16x16x32_bf16 v[196:199], v[68:71], v[16:19], v[196:199]
    v_mfma_f32_16x16x32_bf16 v[200:203], v[68:71], v[20:23], v[200:203]
    v_mfma_f32_16x16x32_bf16 v[204:207], v[68:71], v[24:27], v[204:207]
    v_mfma_f32_16x16x32_bf16 v[208:211], v[68:71], v[28:31], v[208:211]
    s_waitcnt vmcnt(18) lgkmcnt(4)
    v_mfma_f32_16x16x32_bf16 v[164:167], v[72:75], v[32:35], v[164:167]
    ds_read_b128 v[16:19], v7 offset:896
    v_mfma_f32_16x16x32_bf16 v[168:171], v[72:75], v[36:39], v[168:171]
    v_mfma_f32_16x16x32_bf16 v[172:175], v[72:75], v[40:43], v[172:175]
    ds_read_b128 v[20:23], v7 offset:19328
    v_mfma_f32_16x16x32_bf16 v[176:179], v[72:75], v[44:47], v[176:179]
    s_waitcnt vmcnt(17)
    v_mfma_f32_16x16x32_bf16 v[180:183], v[76:79], v[32:35], v[180:183]
    ds_read_b128 v[24:27], v7 offset:37760
    v_mfma_f32_16x16x32_bf16 v[184:187], v[76:79], v[36:39], v[184:187]
    v_mfma_f32_16x16x32_bf16 v[188:191], v[76:79], v[40:43], v[188:191]
    ds_read_b128 v[28:31], v7 offset:56192
    v_mfma_f32_16x16x32_bf16 v[192:195], v[76:79], v[44:47], v[192:195]
    s_waitcnt vmcnt(16)
    v_mfma_f32_16x16x32_bf16 v[196:199], v[80:83], v[32:35], v[196:199]
    v_mfma_f32_16x16x32_bf16 v[200:203], v[80:83], v[36:39], v[200:203]
    v_mfma_f32_16x16x32_bf16 v[204:207], v[80:83], v[40:43], v[204:207]
    v_mfma_f32_16x16x32_bf16 v[208:211], v[80:83], v[44:47], v[208:211]
    s_waitcnt vmcnt(15) lgkmcnt(4)
    v_mfma_f32_16x16x32_bf16 v[164:167], v[84:87], v[212:215], v[164:167]
    ds_read_b128 v[32:35], v6 offset:1024
    v_mfma_f32_16x16x32_bf16 v[168:171], v[84:87], v[216:219], v[168:171]
    v_mfma_f32_16x16x32_bf16 v[172:175], v[84:87], v[220:223], v[172:175]
    ds_read_b128 v[36:39], v6 offset:19456
    v_mfma_f32_16x16x32_bf16 v[176:179], v[84:87], v[224:227], v[176:179]
    s_waitcnt vmcnt(14)
    v_mfma_f32_16x16x32_bf16 v[180:183], v[88:91], v[212:215], v[180:183]
    ds_read_b128 v[40:43], v6 offset:37888
    v_mfma_f32_16x16x32_bf16 v[184:187], v[88:91], v[216:219], v[184:187]
    v_mfma_f32_16x16x32_bf16 v[188:191], v[88:91], v[220:223], v[188:191]
    ds_read_b128 v[44:47], v6 offset:56320
    v_mfma_f32_16x16x32_bf16 v[192:195], v[88:91], v[224:227], v[192:195]
    s_waitcnt vmcnt(13)
    v_mfma_f32_16x16x32_bf16 v[196:199], v[92:95], v[212:215], v[196:199]
    v_mfma_f32_16x16x32_bf16 v[200:203], v[92:95], v[216:219], v[200:203]
    v_mfma_f32_16x16x32_bf16 v[204:207], v[92:95], v[220:223], v[204:207]
    v_mfma_f32_16x16x32_bf16 v[208:211], v[92:95], v[224:227], v[208:211]
    s_setprio 0
    s_waitcnt vmcnt(12) lgkmcnt(4)
    v_mfma_f32_16x16x32_bf16 v[164:167], v[96:99], v[16:19], v[164:167]
    ds_read_b128 v[212:215], v7 offset:1024
    v_mfma_f32_16x16x32_bf16 v[168:171], v[96:99], v[20:23], v[168:171]
    v_mfma_f32_16x16x32_bf16 v[172:175], v[96:99], v[24:27], v[172:175]
    ds_read_b128 v[216:219], v7 offset:19456
    v_mfma_f32_16x16x32_bf16 v[176:179], v[96:99], v[28:31], v[176:179]
    s_waitcnt vmcnt(11)
    v_mfma_f32_16x16x32_bf16 v[180:183], v[100:103], v[16:19], v[180:183]
    ds_read_b128 v[220:223], v7 offset:37888
    v_mfma_f32_16x16x32_bf16 v[184:187], v[100:103], v[20:23], v[184:187]
    v_mfma_f32_16x16x32_bf16 v[188:191], v[100:103], v[24:27], v[188:191]
    ds_read_b128 v[224:227], v7 offset:56320
    v_mfma_f32_16x16x32_bf16 v[192:195], v[100:103], v[28:31], v[192:195]
    s_waitcnt vmcnt(10)
    v_mfma_f32_16x16x32_bf16 v[196:199], v[104:107], v[16:19], v[196:199]
    v_mfma_f32_16x16x32_bf16 v[200:203], v[104:107], v[20:23], v[200:203]
    v_mfma_f32_16x16x32_bf16 v[204:207], v[104:107], v[24:27], v[204:207]
    v_mfma_f32_16x16x32_bf16 v[208:211], v[104:107], v[28:31], v[208:211]
    s_waitcnt vmcnt(5) lgkmcnt(4)
    v_mfma_f32_16x16x32_bf16 v[164:167], v[108:111], v[32:35], v[164:167]
    v_mfma_f32_16x16x32_bf16 v[168:171], v[108:111], v[36:39], v[168:171]
    v_mfma_f32_16x16x32_bf16 v[172:175], v[108:111], v[40:43], v[172:175]
    v_mfma_f32_16x16x32_bf16 v[176:179], v[108:111], v[44:47], v[176:179]
    s_waitcnt vmcnt(4)
    v_mfma_f32_16x16x32_bf16 v[180:183], v[112:115], v[32:35], v[180:183]
    v_mfma_f32_16x16x32_bf16 v[184:187], v[112:115], v[36:39], v[184:187]
    v_mfma_f32_16x16x32_bf16 v[188:191], v[112:115], v[40:43], v[188:191]
    v_mfma_f32_16x16x32_bf16 v[192:195], v[112:115], v[44:47], v[192:195]
    s_waitcnt vmcnt(3)
    v_mfma_f32_16x16x32_bf16 v[196:199], v[116:119], v[32:35], v[196:199]
    v_mfma_f32_16x16x32_bf16 v[200:203], v[116:119], v[36:39], v[200:203]
    v_mfma_f32_16x16x32_bf16 v[204:207], v[116:119], v[40:43], v[204:207]
    v_mfma_f32_16x16x32_bf16 v[208:211], v[116:119], v[44:47], v[208:211]
    s_waitcnt vmcnt(2) lgkmcnt(0)
    v_mfma_f32_16x16x32_bf16 v[164:167], v[120:123], v[212:215], v[164:167]
    v_mfma_f32_16x16x32_bf16 v[168:171], v[120:123], v[216:219], v[168:171]
    v_mfma_f32_16x16x32_bf16 v[172:175], v[120:123], v[220:223], v[172:175]
    v_mfma_f32_16x16x32_bf16 v[176:179], v[120:123], v[224:227], v[176:179]
    s_waitcnt vmcnt(1)
    v_mfma_f32_16x16x32_bf16 v[180:183], v[124:127], v[212:215], v[180:183]
    v_mfma_f32_16x16x32_bf16 v[184:187], v[124:127], v[216:219], v[184:187]
    v_mfma_f32_16x16x32_bf16 v[188:191], v[124:127], v[220:223], v[188:191]
    v_mfma_f32_16x16x32_bf16 v[192:195], v[124:127], v[224:227], v[192:195]
    s_waitcnt vmcnt(0)
    v_mfma_f32_16x16x32_bf16 v[196:199], v[128:131], v[212:215], v[196:199]
    v_mfma_f32_16x16x32_bf16 v[200:203], v[128:131], v[216:219], v[200:203]
    v_mfma_f32_16x16x32_bf16 v[204:207], v[128:131], v[220:223], v[204:207]
    v_mfma_f32_16x16x32_bf16 v[208:211], v[128:131], v[224:227], v[208:211]
    s_nop 7
    s_add_u32 s53, s53, 4096
    v_cvt_pk_bf16_f32 v232, v164, v180
    v_cvt_pk_bf16_f32 v233, v165, v181
    v_cvt_pk_bf16_f32 v234, v166, v182
    v_cvt_pk_bf16_f32 v235, v167, v183
    buffer_store_dwordx4 v[232:235], v2, s[44:47], s53 offen offset:0 sc0 sc1
    v_cvt_pk_bf16_f32 v236, v168, v184
    v_cvt_pk_bf16_f32 v237, v169, v185
    v_cvt_pk_bf16_f32 v238, v170, v186
    v_cvt_pk_bf16_f32 v239, v171, v187
    buffer_store_dwordx4 v[236:239], v2, s[44:47], s53 offen offset:1024 sc0 sc1
    v_cvt_pk_bf16_f32 v240, v172, v188
    v_cvt_pk_bf16_f32 v241, v173, v189
    v_cvt_pk_bf16_f32 v242, v174, v190
    v_cvt_pk_bf16_f32 v243, v175, v191
    buffer_store_dwordx4 v[240:243], v2, s[44:47], s53 offen offset:2048 sc0 sc1
    v_cvt_pk_bf16_f32 v244, v176, v192
    v_cvt_pk_bf16_f32 v245, v177, v193
    v_cvt_pk_bf16_f32 v246, v178, v194
    v_cvt_pk_bf16_f32 v247, v179, v195
    buffer_store_dwordx4 v[244:247], v2, s[44:47], s53 offen offset:3072 sc0 sc1
    s_lshl_b32 s53, s26, 11
    s_add_u32 s53, s53, 65536
    v_cvt_pk_bf16_f32 v248, v196, v197
    buffer_store_dword v248, v3, s[44:47], s53 offen offset:0 sc0 sc1
    v_cvt_pk_bf16_f32 v249, v198, v199
    buffer_store_dword v249, v3, s[44:47], s53 offen offset:256 sc0 sc1
    v_cvt_pk_bf16_f32 v250, v200, v201
    buffer_store_dword v250, v3, s[44:47], s53 offen offset:512 sc0 sc1
    v_cvt_pk_bf16_f32 v251, v202, v203
    buffer_store_dword v251, v3, s[44:47], s53 offen offset:768 sc0 sc1
    v_cvt_pk_bf16_f32 v252, v204, v205
    buffer_store_dword v252, v3, s[44:47], s53 offen offset:1024 sc0 sc1
    v_cvt_pk_bf16_f32 v253, v206, v207
    buffer_store_dword v253, v3, s[44:47], s53 offen offset:1280 sc0 sc1
    v_cvt_pk_bf16_f32 v254, v208, v209
    buffer_store_dword v254, v3, s[44:47], s53 offen offset:1536 sc0 sc1
    v_cvt_pk_bf16_f32 v255, v210, v211
    buffer_store_dword v255, v3, s[44:47], s53 offen offset:1792 sc0 sc1
    s_branch p3_end
p3_c1:
p3_wa1:
    ds_read_b32 v15, v12
    s_waitcnt lgkmcnt(0)
    v_readfirstlane_b32 s58, v15
    s_cmp_ge_u32 s58, 4
    s_cbranch_scc1 p3_wa1_ok
    s_cmp_eq_u32 s28, 0
    s_cbranch_scc1 p3_wa1_ok
    s_sub_u32 s28, s28, 1
    s_sleep 1
    s_branch p3_wa1
p3_wa1_ok:
    ds_read_b128 v[16:19], v6 offset:0
    ds_read_b128 v[20:23], v6 offset:18432
    ds_read_b128 v[24:27], v6 offset:36864
    ds_read_b128 v[28:31], v6 offset:55296
    ds_read_b128 v[32:35], v7 offset:0
    ds_read_b128 v[36:39], v7 offset:18432
    ds_read_b128 v[40:43], v7 offset:36864
    ds_read_b128 v[44:47], v7 offset:55296
    s_setprio 1
    s_waitcnt vmcnt(20) lgkmcnt(4)
    v_mfma_f32_16x16x32_bf16 v[132:135], v[108:111], v[16:19], 0
    ds_read_b128 v[212:215], v6 offset:128
    v_mfma_f32_16x16x32_bf16 v[136:139], v[108:111], v[20:23], 0
    v_mfma_f32_16x16x32_bf16 v[140:143], v[108:111], v[24:27], 0
    ds_read_b128 v[216:219], v6 offset:18560
    v_mfma_f32_16x16x32_bf16 v[144:147], v[108:111], v[28:31], 0
    buffer_load_dwordx4 v[108:111], v2, s[36:39], s52 offen offset:3072
    s_waitcnt vmcnt(20)
    v_mfma_f32_16x16x32_bf16 v[148:151], v[112:115], v[16:19], 0
    ds_read_b128 v[220:223], v6 offset:36992
    v_mfma_f32_16x16x32_bf16 v[152:155], v[112:115], v[20:23], 0
    v_mfma_f32_16x16x32_bf16 v[156:159], v[112:115], v[24:27], 0
    ds_read_b128 v[224:227], v6 offset:55424
    v_mfma_f32_16x16x32_bf16 v[160:163], v[112:115], v[28:31], 0
    s_add_u32 s52, s52, 4096
    buffer_load_dwordx4 v[112:115], v2, s[36:39], s52 offen offset:0
    s_waitcnt vmcnt(20) lgkmcnt(4)
    v_mfma_f32_16x16x32_bf16 v[132:135], v[116:119], v[32:35], v[132:135]
    ds_read_b128 v[16:19], v7 offset:128
    v_mfma_f32_16x16x32_bf16 v[136:139], v[116:119], v[36:39], v[136:139]
    v_mfma_f32_16x16x32_bf16 v[140:143], v[116:119], v[40:43], v[140:143]
    ds_read_b128 v[20:23], v7 offset:18560
    v_mfma_f32_16x16x32_bf16 v[144:147], v[116:119], v[44:47], v[144:147]
    buffer_load_dwordx4 v[116:119], v2, s[36:39], s52 offen offset:1024
    s_waitcnt vmcnt(20)
    v_mfma_f32_16x16x32_bf16 v[148:151], v[120:123], v[32:35], v[148:151]
    ds_read_b128 v[24:27], v7 offset:36992
    v_mfma_f32_16x16x32_bf16 v[152:155], v[120:123], v[36:39], v[152:155]
    v_mfma_f32_16x16x32_bf16 v[156:159], v[120:123], v[40:43], v[156:159]
    ds_read_b128 v[28:31], v7 offset:55424
    v_mfma_f32_16x16x32_bf16 v[160:163], v[120:123], v[44:47], v[160:163]
    buffer_load_dwordx4 v[120:123], v2, s[36:39], s52 offen offset:2048
    s_waitcnt vmcnt(20) lgkmcnt(4)
    v_mfma_f32_16x16x32_bf16 v[132:135], v[124:127], v[212:215], v[132:135]
    ds_read_b128 v[32:35], v6 offset:256
    v_mfma_f32_16x16x32_bf16 v[136:139], v[124:127], v[216:219], v[136:139]
    v_mfma_f32_16x16x32_bf16 v[140:143], v[124:127], v[220:223], v[140:143]
    ds_read_b128 v[36:39], v6 offset:18688
    v_mfma_f32_16x16x32_bf16 v[144:147], v[124:127], v[224:227], v[144:147]
    buffer_load_dwordx4 v[124:127], v2, s[36:39], s52 offen offset:3072
    s_waitcnt vmcnt(20)
    v_mfma_f32_16x16x32_bf16 v[148:151], v[128:131], v[212:215], v[148:151]
    ds_read_b128 v[40:43], v6 offset:37120
    v_mfma_f32_16x16x32_bf16 v[152:155], v[128:131], v[216:219], v[152:155]
    v_mfma_f32_16x16x32_bf16 v[156:159], v[128:131], v[220:223], v[156:159]
    ds_read_b128 v[44:47], v6 offset:55552
    v_mfma_f32_16x16x32_bf16 v[160:163], v[128:131], v[224:227], v[160:163]
    s_add_u32 s52, s52, 4096
    buffer_load_dwordx4 v[128:131], v2, s[36:39], s52 offen offset:0
    s_setprio 0
    s_waitcnt vmcnt(20) lgkmcnt(4)
    v_mfma_f32_16x16x32_bf16 v[132:135], v[48:51], v[16:19], v[132:135]
    ds_read_b128 v[212:215], v7 offset:256
    v_mfma_f32_16x16x32_bf16 v[136:139], v[48:51], v[20:23], v[136:139]
    v_mfma_f32_16x16x32_bf16 v[140:143], v[48:51], v[24:27], v[140:143]
    ds_read_b128 v[216:219], v7 offset:18688
    v_mfma_f32_16x16x32_bf16 v[144:147], v[48:51], v[28:31], v[144:147]
    buffer_load_dwordx4 v[48:51], v2, s[36:39], s52 offen offset:1024
    s_waitcnt vmcnt(20)
    v_mfma_f32_16x16x32_bf16 v[148:151], v[52:55], v[16:19], v[148:151]
    ds_read_b128 v[220:223], v7 offset:37120
    v_mfma_f32_16x16x32_bf16 v[152:155], v[52:55], v[20:23], v[152:155]
    v_mfma_f32_16x16x32_bf16 v[156:159], v[52:55], v[24:27], v[156:159]
    ds_read_b128 v[224:227], v7 offset:55552
    v_mfma_f32_16x16x32_bf16 v[160:163], v[52:55], v[28:31], v[160:163]
    buffer_load_dwordx4 v[52:55], v2, s[36:39], s52 offen offset:2048
    s_waitcnt vmcnt(20) lgkmcnt(4)
    v_mfma_f32_16x16x32_bf16 v[132:135], v[56:59], v[32:35], v[132:135]
    ds_read_b128 v[16:19], v6 offset:384
    v_mfma_f32_16x16x32_bf16 v[136:139], v[56:59], v[36:39], v[136:139]
    v_mfma_f32_16x16x32_bf16 v[140:143], v[56:59], v[40:43], v[140:143]
    ds_read_b128 v[20:23], v6 offset:18816
    v_mfma_f32_16x16x32_bf16 v[144:147], v[56:59], v[44:47], v[144:147]
    buffer_load_dwordx4 v[56:59], v2, s[36:39], s52 offen offset:3072
    s_waitcnt vmcnt(20)
    v_mfma_f32_16x16x32_bf16 v[148:151], v[60:63], v[32:35], v[148:151]
    ds_read_b128 v[24:27], v6 offset:37248
    v_mfma_f32_16x16x32_bf16 v[152:155], v[60:63], v[36:39], v[152:155]
    v_mfma_f32_16x16x32_bf16 v[156:159], v[60:63], v[40:43], v[156:159]
    ds_read_b128 v[28:31], v6 offset:55680
    v_mfma_f32_16x16x32_bf16 v[160:163], v[60:63], v[44:47], v[160:163]
    s_add_u32 s52, s52, 4096
    buffer_load_dwordx4 v[60:63], v2, s[36:39], s52 offen offset:0
    s_waitcnt vmcnt(20) lgkmcnt(4)
    v_mfma_f32_16x16x32_bf16 v[132:135], v[64:67], v[212:215], v[132:135]
    ds_read_b128 v[32:35], v7 offset:384
    v_mfma_f32_16x16x32_bf16 v[136:139], v[64:67], v[216:219], v[136:139]
    v_mfma_f32_16x16x32_bf16 v[140:143], v[64:67], v[220:223], v[140:143]
    ds_read_b128 v[36:39], v7 offset:18816
    v_mfma_f32_16x16x32_bf16 v[144:147], v[64:67], v[224:227], v[144:147]
    buffer_load_dwordx4 v[64:67], v2, s[36:39], s52 offen offset:1024
    s_waitcnt vmcnt(20)
    v_mfma_f32_16x16x32_bf16 v[148:151], v[68:71], v[212:215], v[148:151]
    ds_read_b128 v[40:43], v7 offset:37248
    v_mfma_f32_16x16x32_bf16 v[152:155], v[68:71], v[216:219], v[152:155]
    v_mfma_f32_16x16x32_bf16 v[156:159], v[68:71], v[220:223], v[156:159]
    ds_read_b128 v[44:47], v7 offset:55680
    v_mfma_f32_16x16x32_bf16 v[160:163], v[68:71], v[224:227], v[160:163]
    buffer_load_dwordx4 v[68:71], v2, s[36:39], s52 offen offset:2048
    s_setprio 1
    s_waitcnt vmcnt(20) lgkmcnt(4)
    v_mfma_f32_16x16x32_bf16 v[132:135], v[72:75], v[16:19], v[132:135]
    ds_read_b128 v[212:215], v6 offset:512
    v_mfma_f32_16x16x32_bf16 v[136:139], v[72:75], v[20:23], v[136:139]
    v_mfma_f32_16x16x32_bf16 v[140:143], v[72:75], v[24:27], v[140:143]
    ds_read_b128 v[216:219], v6 offset:18944
    v_mfma_f32_16x16x32_bf16 v[144:147], v[72:75], v[28:31], v[144:147]
    buffer_load_dwordx4 v[72:75], v2, s[36:39], s52 offen offset:3072
    s_waitcnt vmcnt(20)
    v_mfma_f32_16x16x32_bf16 v[148:151], v[76:79], v[16:19], v[148:151]
    ds_read_b128 v[220:223], v6 offset:37376
    v_mfma_f32_16x16x32_bf16 v[152:155], v[76:79], v[20:23], v[152:155]
    v_mfma_f32_16x16x32_bf16 v[156:159], v[76:79], v[24:27], v[156:159]
    ds_read_b128 v[224:227], v6 offset:55808
    v_mfma_f32_16x16x32_bf16 v[160:163], v[76:79], v[28:31], v[160:163]
    s_add_u32 s52, s52, 4096
    buffer_load_dwordx4 v[76:79], v2, s[36:39], s52 offen offset:0
    s_waitcnt vmcnt(20) lgkmcnt(4)
    v_mfma_f32_16x16x32_bf16 v[132:135], v[80:83], v[32:35], v[132:135]
    v_mfma_f32_16x16x32_bf16 v[136:139], v[80:83], v[36:39], v[136:139]
    v_mfma_f32_16x16x32_bf16 v[140:143], v[80:83], v[40:43], v[140:143]
    v_mfma_f32_16x16x32_bf16 v[144:147], v[80:83], v[44:47], v[144:147]
    buffer_load_dwordx4 v[80:83], v2, s[36:39], s52 offen offset:1024
    s_waitcnt vmcnt(20)
    v_mfma_f32_16x16x32_bf16 v[148:151], v[84:87], v[32:35], v[148:151]
    v_mfma_f32_16x16x32_bf16 v[152:155], v[84:87], v[36:39], v[152:155]
    v_mfma_f32_16x16x32_bf16 v[156:159], v[84:87], v[40:43], v[156:159]
    v_mfma_f32_16x16x32_bf16 v[160:163], v[84:87], v[44:47], v[160:163]
    buffer_load_dwordx4 v[84:87], v2, s[36:39], s52 offen offset:2048
    s_waitcnt vmcnt(20) lgkmcnt(0)
    v_mfma_f32_16x16x32_bf16 v[132:135], v[88:91], v[212:215], v[132:135]
    v_mfma_f32_16x16x32_bf16 v[136:139], v[88:91], v[216:219], v[136:139]
    v_mfma_f32_16x16x32_bf16 v[140:143], v[88:91], v[220:223], v[140:143]
    v_mfma_f32_16x16x32_bf16 v[144:147], v[88:91], v[224:227], v[144:147]
    buffer_load_dwordx4 v[88:91], v2, s[36:39], s52 offen offset:3072
    s_waitcnt vmcnt(20)
    v_mfma_f32_16x16x32_bf16 v[148:151], v[92:95], v[212:215], v[148:151]
    v_mfma_f32_16x16x32_bf16 v[152:155], v[92:95], v[216:219], v[152:155]
    v_mfma_f32_16x16x32_bf16 v[156:159], v[92:95], v[220:223], v[156:159]
    v_mfma_f32_16x16x32_bf16 v[160:163], v[92:95], v[224:227], v[160:163]
    s_add_u32 s52, s52, 4096
    buffer_load_dwordx4 v[92:95], v2, s[36:39], s52 offen offset:0
    ds_read_b128 v[16:19], v6 offset:0
    ds_read_b128 v[20:23], v6 offset:18432
    ds_read_b128 v[24:27], v6 offset:36864
    ds_read_b128 v[28:31], v6 offset:55296
    ds_read_b128 v[32:35], v7 offset:0
    ds_read_b128 v[36:39], v7 offset:18432
    ds_read_b128 v[40:43], v7 offset:36864
    ds_read_b128 v[44:47], v7 offset:55296
    s_setprio 1
    s_waitcnt vmcnt(20) lgkmcnt(4)
    v_mfma_f32_16x16x32_bf16 v[164:167], v[96:99], v[16:19], 0
    ds_read_b128 v[212:215], v6 offset:128
    v_mfma_f32_16x16x32_bf16 v[168:171], v[96:99], v[20:23], 0
    v_mfma_f32_16x16x32_bf16 v[172:175], v[96:99], v[24:27], 0
    ds_read_b128 v[216:219], v6 offset:18560
    v_mfma_f32_16x16x32_bf16 v[176:179], v[96:99], v[28:31], 0
    buffer_load_dwordx4 v[96:99], v2, s[36:39], s52 offen offset:1024
    s_waitcnt vmcnt(20)
    v_mfma_f32_16x16x32_bf16 v[180:183], v[100:103], v[16:19], 0
    ds_read_b128 v[220:223], v6 offset:36992
    v_mfma_f32_16x16x32_bf16 v[184:187], v[100:103], v[20:23], 0
    v_mfma_f32_16x16x32_bf16 v[188:191], v[100:103], v[24:27], 0
    ds_read_b128 v[224:227], v6 offset:55424
    v_mfma_f32_16x16x32_bf16 v[192:195], v[100:103], v[28:31], 0
    buffer_load_dwordx4 v[100:103], v2, s[36:39], s52 offen offset:2048
    s_waitcnt vmcnt(20) lgkmcnt(4)
    v_mfma_f32_16x16x32_bf16 v[164:167], v[104:107], v[32:35], v[164:167]
    ds_read_b128 v[16:19], v7 offset:128
    v_mfma_f32_16x16x32_bf16 v[168:171], v[104:107], v[36:39], v[168:171]
    v_mfma_f32_16x16x32_bf16 v[172:175], v[104:107], v[40:43], v[172:175]
    ds_read_b128 v[20:23], v7 offset:18560
    v_mfma_f32_16x16x32_bf16 v[176:179], v[104:107], v[44:47], v[176:179]
    buffer_load_dwordx4 v[104:107], v2, s[36:39], s52 offen offset:3072
    s_waitcnt vmcnt(20)
    v_mfma_f32_16x16x32_bf16 v[180:183], v[108:111], v[32:35], v[180:183]
    ds_read_b128 v[24:27], v7 offset:36992
    v_mfma_f32_16x16x32_bf16 v[184:187], v[108:111], v[36:39], v[184:187]
    v_mfma_f32_16x16x32_bf16 v[188:191], v[108:111], v[40:43], v[188:191]
    ds_read_b128 v[28:31], v7 offset:55424
    v_mfma_f32_16x16x32_bf16 v[192:195], v[108:111], v[44:47], v[192:195]
    s_add_u32 s52, s52, 4096
    buffer_load_dwordx4 v[108:111], v2, s[36:39], s52 offen offset:0
    s_waitcnt vmcnt(20) lgkmcnt(4)
    v_mfma_f32_16x16x32_bf16 v[164:167], v[112:115], v[212:215], v[164:167]
    ds_read_b128 v[32:35], v6 offset:256
    v_mfma_f32_16x16x32_bf16 v[168:171], v[112:115], v[216:219], v[168:171]
    v_mfma_f32_16x16x32_bf16 v[172:175], v[112:115], v[220:223], v[172:175]
    ds_read_b128 v[36:39], v6 offset:18688
    v_mfma_f32_16x16x32_bf16 v[176:179], v[112:115], v[224:227], v[176:179]
    buffer_load_dwordx4 v[112:115], v2, s[36:39], s52 offen offset:1024
    s_waitcnt vmcnt(20)
    v_mfma_f32_16x16x32_bf16 v[180:183], v[116:119], v[212:215], v[180:183]
    ds_read_b128 v[40:43], v6 offset:37120
    v_mfma_f32_16x16x32_bf16 v[184:187], v[116:119], v[216:219], v[184:187]
    v_mfma_f32_16x16x32_bf16 v[188:191], v[116:119], v[220:223], v[188:191]
    ds_read_b128 v[44:47], v6 offset:55552
    v_mfma_f32_16x16x32_bf16 v[192:195], v[116:119], v[224:227], v[192:195]
    buffer_load_dwordx4 v[116:119], v2, s[36:39], s52 offen offset:2048
    s_setprio 0
    s_waitcnt vmcnt(20) lgkmcnt(4)
    v_mfma_f32_16x16x32_bf16 v[164:167], v[120:123], v[16:19], v[164:167]
    ds_read_b128 v[212:215], v7 offset:256
    v_mfma_f32_16x16x32_bf16 v[168:171], v[120:123], v[20:23], v[168:171]
    v_mfma_f32_16x16x32_bf16 v[172:175], v[120:123], v[24:27], v[172:175]
    ds_read_b128 v[216:219], v7 offset:18688
    v_mfma_f32_16x16x32_bf16 v[176:179], v[120:123], v[28:31], v[176:179]
    buffer_load_dwordx4 v[120:123], v2, s[36:39], s52 offen offset:3072
    s_waitcnt vmcnt(20)
    v_mfma_f32_16x16x32_bf16 v[180:183], v[124:127], v[16:19], v[180:183]
    ds_read_b128 v[220:223], v7 offset:37120
    v_mfma_f32_16x16x32_bf16 v[184:187], v[124:127], v[20:23], v[184:187]
    v_mfma_f32_16x16x32_bf16 v[188:191], v[124:127], v[24:27], v[188:191]
    ds_read_b128 v[224:227], v7 offset:55552
    v_mfma_f32_16x16x32_bf16 v[192:195], v[124:127], v[28:31], v[192:195]
    s_add_u32 s52, s52, 4096
    buffer_load_dwordx4 v[124:127], v2, s[36:39], s52 offen offset:0
    s_waitcnt vmcnt(20) lgkmcnt(4)
    v_mfma_f32_16x16x32_bf16 v[164:167], v[128:131], v[32:35], v[164:167]
    ds_read_b128 v[16:19], v6 offset:384
    v_mfma_f32_16x16x32_bf16 v[168:171], v[128:131], v[36:39], v[168:171]
    v_mfma_f32_16x16x32_bf16 v[172:175], v[128:131], v[40:43], v[172:175]
    ds_read_b128 v[20:23], v6 offset:18816
    v_mfma_f32_16x16x32_bf16 v[176:179], v[128:131], v[44:47], v[176:179]
    buffer_load_dwordx4 v[128:131], v2, s[36:39], s52 offen offset:1024
    s_waitcnt vmcnt(20)
    v_mfma_f32_16x16x32_bf16 v[180:183], v[48:51], v[32:35], v[180:183]
    ds_read_b128 v[24:27], v6 offset:37248
    v_mfma_f32_16x16x32_bf16 v[184:187], v[48:51], v[36:39], v[184:187]
    v_mfma_f32_16x16x32_bf16 v[188:191], v[48:51], v[40:43], v[188:191]
    ds_read_b128 v[28:31], v6 offset:55680
    v_mfma_f32_16x16x32_bf16 v[192:195], v[48:51], v[44:47], v[192:195]
    buffer_load_dwordx4 v[48:51], v2, s[36:39], s52 offen offset:2048
    s_waitcnt vmcnt(20) lgkmcnt(4)
    v_mfma_f32_16x16x32_bf16 v[164:167], v[52:55], v[212:215], v[164:167]
    ds_read_b128 v[32:35], v7 offset:384
    v_mfma_f32_16x16x32_bf16 v[168:171], v[52:55], v[216:219], v[168:171]
    v_mfma_f32_16x16x32_bf16 v[172:175], v[52:55], v[220:223], v[172:175]
    ds_read_b128 v[36:39], v7 offset:18816
    v_mfma_f32_16x16x32_bf16 v[176:179], v[52:55], v[224:227], v[176:179]
    buffer_load_dwordx4 v[52:55], v2, s[36:39], s52 offen offset:3072
    s_waitcnt vmcnt(20)
    v_mfma_f32_16x16x32_bf16 v[180:183], v[56:59], v[212:215], v[180:183]
    ds_read_b128 v[40:43], v7 offset:37248
    v_mfma_f32_16x16x32_bf16 v[184:187], v[56:59], v[216:219], v[184:187]
    v_mfma_f32_16x16x32_bf16 v[188:191], v[56:59], v[220:223], v[188:191]
    ds_read_b128 v[44:47], v7 offset:55680
    v_mfma_f32_16x16x32_bf16 v[192:195], v[56:59], v[224:227], v[192:195]
    s_add_u32 s52, s52, 4096
    buffer_load_dwordx4 v[56:59], v2, s[36:39], s52 offen offset:0
    s_setprio 1
    s_waitcnt vmcnt(20) lgkmcnt(4)
    v_mfma_f32_16x16x32_bf16 v[164:167], v[60:63], v[16:19], v[164:167]
    ds_read_b128 v[212:215], v6 offset:512
    v_mfma_f32_16x16x32_bf16 v[168:171], v[60:63], v[20:23], v[168:171]
    v_mfma_f32_16x16x32_bf16 v[172:175], v[60:63], v[24:27], v[172:175]
    ds_read_b128 v[216:219], v6 offset:18944
    v_mfma_f32_16x16x32_bf16 v[176:179], v[60:63], v[28:31], v[176:179]
    buffer_load_dwordx4 v[60:63], v2, s[36:39], s52 offen offset:1024
    s_waitcnt vmcnt(20)
    v_mfma_f32_16x16x32_bf16 v[180:183], v[64:67], v[16:19], v[180:183]
    ds_read_b128 v[220:223], v6 offset:37376
    v_mfma_f32_16x16x32_bf16 v[184:187], v[64:67], v[20:23], v[184:187]
    v_mfma_f32_16x16x32_bf16 v[188:191], v[64:67], v[24:27], v[188:191]
    ds_read_b128 v[224:227], v6 offset:55808
    v_mfma_f32_16x16x32_bf16 v[192:195], v[64:67], v[28:31], v[192:195]
    buffer_load_dwordx4 v[64:67], v2, s[36:39], s52 offen offset:2048
    s_waitcnt vmcnt(20) lgkmcnt(4)
    v_mfma_f32_16x16x32_bf16 v[164:167], v[68:71], v[32:35], v[164:167]
    v_mfma_f32_16x16x32_bf16 v[168:171], v[68:71], v[36:39], v[168:171]
    v_mfma_f32_16x16x32_bf16 v[172:175], v[68:71], v[40:43], v[172:175]
    v_mfma_f32_16x16x32_bf16 v[176:179], v[68:71], v[44:47], v[176:179]
    buffer_load_dwordx4 v[68:71], v2, s[36:39], s52 offen offset:3072
    s_waitcnt vmcnt(20)
    v_mfma_f32_16x16x32_bf16 v[180:183], v[72:75], v[32:35], v[180:183]
    v_mfma_f32_16x16x32_bf16 v[184:187], v[72:75], v[36:39], v[184:187]
    v_mfma_f32_16x16x32_bf16 v[188:191], v[72:75], v[40:43], v[188:191]
    v_mfma_f32_16x16x32_bf16 v[192:195], v[72:75], v[44:47], v[192:195]
    s_add_u32 s52, s52, 4096
    buffer_load_dwordx4 v[72:75], v2, s[36:39], s52 offen offset:0
    s_waitcnt vmcnt(20) lgkmcnt(0)
    v_mfma_f32_16x16x32_bf16 v[164:167], v[76:79], v[212:215], v[164:167]
    v_mfma_f32_16x16x32_bf16 v[168:171], v[76:79], v[216:219], v[168:171]
    v_mfma_f32_16x16x32_bf16 v[172:175], v[76:79], v[220:223], v[172:175]
    v_mfma_f32_16x16x32_bf16 v[176:179], v[76:79], v[224:227], v[176:179]
    buffer_load_dwordx4 v[76:79], v2, s[36:39], s52 offen offset:1024
    s_waitcnt vmcnt(20)
    v_mfma_f32_16x16x32_bf16 v[180:183], v[80:83], v[212:215], v[180:183]
    v_mfma_f32_16x16x32_bf16 v[184:187], v[80:83], v[216:219], v[184:187]
    v_mfma_f32_16x16x32_bf16 v[188:191], v[80:83], v[220:223], v[188:191]
    v_mfma_f32_16x16x32_bf16 v[192:195], v[80:83], v[224:227], v[192:195]
    buffer_load_dwordx4 v[80:83], v2, s[36:39], s52 offen offset:2048
p3_wb1:
    ds_read_b32 v15, v13
    s_waitcnt lgkmcnt(0)
    v_readfirstlane_b32 s58, v15
    s_cmp_ge_u32 s58, 4
    s_cbranch_scc1 p3_wb1_ok
    s_cmp_eq_u32 s28, 0
    s_cbranch_scc1 p3_wb1_ok
    s_sub_u32 s28, s28, 1
    s_sleep 1
    s_branch p3_wb1
p3_wb1_ok:
    ds_read_b128 v[16:19], v7 offset:512
    ds_read_b128 v[20:23], v7 offset:18944
    ds_read_b128 v[24:27], v7 offset:37376
    ds_read_b128 v[28:31], v7 offset:55808
    ds_read_b128 v[32:35], v6 offset:640
    ds_read_b128 v[36:39], v6 offset:19072
    ds_read_b128 v[40:43], v6 offset:37504
    ds_read_b128 v[44:47], v6 offset:55936
    s_setprio 1
    s_waitcnt vmcnt(20) lgkmcnt(4)
    v_mfma_f32_16x16x32_bf16 v[132:135], v[84:87], v[16:19], v[132:135]
    ds_read_b128 v[212:215], v7 offset:640
    v_mfma_f32_16x16x32_bf16 v[136:139], v[84:87], v[20:23], v[136:139]
    v_mfma_f32_16x16x32_bf16 v[140:143], v[84:87], v[24:27], v[140:143]
    ds_read_b128 v[216:219], v7 offset:19072
    v_mfma_f32_16x16x32_bf16 v[144:147], v[84:87], v[28:31], v[144:147]
    buffer_load_dwordx4 v[84:87], v2, s[36:39], s52 offen offset:3072
    s_waitcnt vmcnt(20)
    v_mfma_f32_16x16x32_bf16 v[148:151], v[88:91], v[16:19], v[148:151]
    ds_read_b128 v[220:223], v7 offset:37504
    v_mfma_f32_16x16x32_bf16 v[152:155], v[88:91], v[20:23], v[152:155]
    v_mfma_f32_16x16x32_bf16 v[156:159], v[88:91], v[24:27], v[156:159]
    ds_read_b128 v[224:227], v7 offset:55936
    v_mfma_f32_16x16x32_bf16 v[160:163], v[88:91], v[28:31], v[160:163]
    s_add_u32 s52, s52, 4096
    buffer_load_dwordx4 v[88:91], v2, s[36:39], s52 offen offset:0
    s_waitcnt vmcnt(20) lgkmcnt(4)
    v_mfma_f32_16x16x32_bf16 v[132:135], v[92:95], v[32:35], v[132:135]
    ds_read_b128 v[16:19], v6 offset:768
    v_mfma_f32_16x16x32_bf16 v[136:139], v[92:95], v[36:39], v[136:139]
    v_mfma_f32_16x16x32_bf16 v[140:143], v[92:95], v[40:43], v[140:143]
    ds_read_b128 v[20:23], v6 offset:19200
    v_mfma_f32_16x16x32_bf16 v[144:147], v[92:95], v[44:47], v[144:147]
    buffer_load_dwordx4 v[92:95], v2, s[36:39], s52 offen offset:1024
    s_waitcnt vmcnt(20)
    v_mfma_f32_16x16x32_bf16 v[148:151], v[96:99], v[32:35], v[148:151]
    ds_read_b128 v[24:27], v6 offset:37632
    v_mfma_f32_16x16x32_bf16 v[152:155], v[96:99], v[36:39], v[152:155]
    v_mfma_f32_16x16x32_bf16 v[156:159], v[96:99], v[40:43], v[156:159]
    ds_read_b128 v[28:31], v6 offset:56064
    v_mfma_f32_16x16x32_bf16 v[160:163], v[96:99], v[44:47], v[160:163]
    buffer_load_dwordx4 v[96:99], v2, s[36:39], s52 offen offset:2048
    s_waitcnt vmcnt(20) lgkmcnt(4)
    v_mfma_f32_16x16x32_bf16 v[132:135], v[100:103], v[212:215], v[132:135]
    ds_read_b128 v[32:35], v7 offset:768
    v_mfma_f32_16x16x32_bf16 v[136:139], v[100:103], v[216:219], v[136:139]
    v_mfma_f32_16x16x32_bf16 v[140:143], v[100:103], v[220:223], v[140:143]
    ds_read_b128 v[36:39], v7 offset:19200
    v_mfma_f32_16x16x32_bf16 v[144:147], v[100:103], v[224:227], v[144:147]
    buffer_load_dwordx4 v[100:103], v2, s[36:39], s52 offen offset:3072
    s_waitcnt vmcnt(20)
    v_mfma_f32_16x16x32_bf16 v[148:151], v[104:107], v[212:215], v[148:151]
    ds_read_b128 v[40:43], v7 offset:37632
    v_mfma_f32_16x16x32_bf16 v[152:155], v[104:107], v[216:219], v[152:155]
    v_mfma_f32_16x16x32_bf16 v[156:159], v[104:107], v[220:223], v[156:159]
    ds_read_b128 v[44:47], v7 offset:56064
    v_mfma_f32_16x16x32_bf16 v[160:163], v[104:107], v[224:227], v[160:163]
    s_add_u32 s52, s52, 4096
    buffer_load_dwordx4 v[104:107], v2, s[36:39], s52 offen offset:0
    s_setprio 0
    s_waitcnt vmcnt(20) lgkmcnt(4)
    v_mfma_f32_16x16x32_bf16 v[132:135], v[108:111], v[16:19], v[132:135]
    ds_read_b128 v[212:215], v6 offset:896
    v_mfma_f32_16x16x32_bf16 v[136:139], v[108:111], v[20:23], v[136:139]
    v_mfma_f32_16x16x32_bf16 v[140:143], v[108:111], v[24:27], v[140:143]
    ds_read_b128 v[216:219], v6 offset:19328
    v_mfma_f32_16x16x32_bf16 v[144:147], v[108:111], v[28:31], v[144:147]
    buffer_load_dwordx4 v[108:111], v2, s[36:39], s52 offen offset:1024
    s_waitcnt vmcnt(20)
    v_mfma_f32_16x16x32_bf16 v[148:151], v[112:115], v[16:19], v[148:151]
    ds_read_b128 v[220:223], v6 offset:37760
    v_mfma_f32_16x16x32_bf16 v[152:155], v[112:115], v[20:23], v[152:155]
    v_mfma_f32_16x16x32_bf16 v[156:159], v[112:115], v[24:27], v[156:159]
    ds_read_b128 v[224:227], v6 offset:56192
    v_mfma_f32_16x16x32_bf16 v[160:163], v[112:115], v[28:31], v[160:163]
    buffer_load_dwordx4 v[112:115], v2, s[36:39], s52 offen offset:2048
    s_waitcnt vmcnt(20) lgkmcnt(4)
    v_mfma_f32_16x16x32_bf16 v[132:135], v[116:119], v[32:35], v[132:135]
    ds_read_b128 v[16:19], v7 offset:896
    v_mfma_f32_16x16x32_bf16 v[136:139], v[116:119], v[36:39], v[136:139]
    v_mfma_f32_16x16x32_bf16 v[140:143], v[116:119], v[40:43], v[140:143]
    ds_read_b128 v[20:23], v7 offset:19328
    v_mfma_f32_16x16x32_bf16 v[144:147], v[116:119], v[44:47], v[144:147]
    buffer_load_dwordx4 v[116:119], v2, s[36:39], s52 offen offset:3072
    s_waitcnt vmcnt(20)
    v_mfma_f32_16x16x32_bf16 v[148:151], v[120:123], v[32:35], v[148:151]
    ds_read_b128 v[24:27], v7 offset:37760
    v_mfma_f32_16x16x32_bf16 v[152:155], v[120:123], v[36:39], v[152:155]
    v_mfma_f32_16x16x32_bf16 v[156:159], v[120:123], v[40:43], v[156:159]
    ds_read_b128 v[28:31], v7 offset:56192
    v_mfma_f32_16x16x32_bf16 v[160:163], v[120:123], v[44:47], v[160:163]
    s_add_u32 s52, s52, 4096
    buffer_load_dwordx4 v[120:123], v2, s[36:39], s52 offen offset:0
    s_waitcnt vmcnt(20) lgkmcnt(4)
    v_mfma_f32_16x16x32_bf16 v[132:135], v[124:127], v[212:215], v[132:135]
    ds_read_b128 v[32:35], v6 offset:1024
    v_mfma_f32_16x16x32_bf16 v[136:139], v[124:127], v[216:219], v[136:139]
    v_mfma_f32_16x16x32_bf16 v[140:143], v[124:127], v[220:223], v[140:143]
    ds_read_b128 v[36:39], v6 offset:19456
    v_mfma_f32_16x16x32_bf16 v[144:147], v[124:127], v[224:227], v[144:147]
    buffer_load_dwordx4 v[124:127], v2, s[36:39], s52 offen offset:1024
    s_waitcnt vmcnt(20)
    v_mfma_f32_16x16x32_bf16 v[148:151], v[128:131], v[212:215], v[148:151]
    ds_read_b128 v[40:43], v6 offset:37888
    v_mfma_f32_16x16x32_bf16 v[152:155], v[128:131], v[216:219], v[152:155]
    v_mfma_f32_16x16x32_bf16 v[156:159], v[128:131], v[220:223], v[156:159]
    ds_read_b128 v[44:47], v6 offset:56320
    v_mfma_f32_16x16x32_bf16 v[160:163], v[128:131], v[224:227], v[160:163]
    buffer_load_dwordx4 v[128:131], v2, s[36:39], s52 offen offset:2048
    s_setprio 1
    s_waitcnt vmcnt(20) lgkmcnt(4)
    v_mfma_f32_16x16x32_bf16 v[132:135], v[48:51], v[16:19], v[132:135]
    ds_read_b128 v[212:215], v7 offset:1024
    v_mfma_f32_16x16x32_bf16 v[136:139], v[48:51], v[20:23], v[136:139]
    v_mfma_f32_16x16x32_bf16 v[140:143], v[48:51], v[24:27], v[140:143]
    ds_read_b128 v[216:219], v7 offset:19456
    v_mfma_f32_16x16x32_bf16 v[144:147], v[48:51], v[28:31], v[144:147]
    buffer_load_dwordx4 v[48:51], v2, s[36:39], s52 offen offset:3072
    s_waitcnt vmcnt(20)
    v_mfma_f32_16x16x32_bf16 v[148:151], v[52:55], v[16:19], v[148:151]
    ds_read_b128 v[220:223], v7 offset:37888
    v_mfma_f32_16x16x32_bf16 v[152:155], v[52:55], v[20:23], v[152:155]
    v_mfma_f32_16x16x32_bf16 v[156:159], v[52:55], v[24:27], v[156:159]
    ds_read_b128 v[224:227], v7 offset:56320
    v_mfma_f32_16x16x32_bf16 v[160:163], v[52:55], v[28:31], v[160:163]
    s_add_u32 s52, s52, 4096
    buffer_load_dwordx4 v[52:55], v2, s[36:39], s52 offen offset:0
    s_waitcnt vmcnt(20) lgkmcnt(4)
    v_mfma_f32_16x16x32_bf16 v[132:135], v[56:59], v[32:35], v[132:135]
    v_mfma_f32_16x16x32_bf16 v[136:139], v[56:59], v[36:39], v[136:139]
    v_mfma_f32_16x16x32_bf16 v[140:143], v[56:59], v[40:43], v[140:143]
    v_mfma_f32_16x16x32_bf16 v[144:147], v[56:59], v[44:47], v[144:147]
    buffer_load_dwordx4 v[56:59], v2, s[36:39], s52 offen offset:1024
    s_waitcnt vmcnt(20)
    v_mfma_f32_16x16x32_bf16 v[148:151], v[60:63], v[32:35], v[148:151]
    v_mfma_f32_16x16x32_bf16 v[152:155], v[60:63], v[36:39], v[152:155]
    v_mfma_f32_16x16x32_bf16 v[156:159], v[60:63], v[40:43], v[156:159]
    v_mfma_f32_16x16x32_bf16 v[160:163], v[60:63], v[44:47], v[160:163]
    s_waitcnt vmcnt(19) lgkmcnt(0)
    v_mfma_f32_16x16x32_bf16 v[132:135], v[64:67], v[212:215], v[132:135]
    v_mfma_f32_16x16x32_bf16 v[136:139], v[64:67], v[216:219], v[136:139]
    v_mfma_f32_16x16x32_bf16 v[140:143], v[64:67], v[220:223], v[140:143]
    v_mfma_f32_16x16x32_bf16 v[144:147], v[64:67], v[224:227], v[144:147]
    s_waitcnt vmcnt(18)
    v_mfma_f32_16x16x32_bf16 v[148:151], v[68:71], v[212:215], v[148:151]
    v_mfma_f32_16x16x32_bf16 v[152:155], v[68:71], v[216:219], v[152:155]
    v_mfma_f32_16x16x32_bf16 v[156:159], v[68:71], v[220:223], v[156:159]
    v_mfma_f32_16x16x32_bf16 v[160:163], v[68:71], v[224:227], v[160:163]
    s_lshl_b32 s53, s26, 13
    s_nop 7
    v_cvt_pk_bf16_f32 v232, v132, v148
    v_cvt_pk_bf16_f32 v233, v133, v149
    v_cvt_pk_bf16_f32 v234, v134, v150
    v_cvt_pk_bf16_f32 v235, v135, v151
    buffer_store_dwordx4 v[232:235], v2, s[44:47], s53 offen offset:0 sc0 sc1
    v_cvt_pk_bf16_f32 v236, v136, v152
    v_cvt_pk_bf16_f32 v237, v137, v153
    v_cvt_pk_bf16_f32 v238, v138, v154
    v_cvt_pk_bf16_f32 v239, v139, v155
    buffer_store_dwordx4 v[236:239], v2, s[44:47], s53 offen offset:1024 sc0 sc1
    v_cvt_pk_bf16_f32 v240, v140, v156
    v_cvt_pk_bf16_f32 v241, v141, v157
    v_cvt_pk_bf16_f32 v242, v142, v158
    v_cvt_pk_bf16_f32 v243, v143, v159
    buffer_store_dwordx4 v[240:243], v2, s[44:47], s53 offen offset:2048 sc0 sc1
    v_cvt_pk_bf16_f32 v244, v144, v160
    v_cvt_pk_bf16_f32 v245, v145, v161
    v_cvt_pk_bf16_f32 v246, v146, v162
    v_cvt_pk_bf16_f32 v247, v147, v163
    buffer_store_dwordx4 v[244:247], v2, s[44:47], s53 offen offset:3072 sc0 sc1
    ds_read_b128 v[16:19], v7 offset:512
    ds_read_b128 v[20:23], v7 offset:18944
    ds_read_b128 v[24:27], v7 offset:37376
    ds_read_b128 v[28:31], v7 offset:55808
    ds_read_b128 v[32:35], v6 offset:640
    ds_read_b128 v[36:39], v6 offset:19072
    ds_read_b128 v[40:43], v6 offset:37504
    ds_read_b128 v[44:47], v6 offset:55936
    s_setprio 1
    s_waitcnt vmcnt(21) lgkmcnt(4)
    v_mfma_f32_16x16x32_bf16 v[164:167], v[72:75], v[16:19], v[164:167]
    ds_read_b128 v[212:215], v7 offset:640
    v_mfma_f32_16x16x32_bf16 v[168:171], v[72:75], v[20:23], v[168:171]
    v_mfma_f32_16x16x32_bf16 v[172:175], v[72:75], v[24:27], v[172:175]
    ds_read_b128 v[216:219], v7 offset:19072
    v_mfma_f32_16x16x32_bf16 v[176:179], v[72:75], v[28:31], v[176:179]
    s_waitcnt vmcnt(20)
    v_mfma_f32_16x16x32_bf16 v[180:183], v[76:79], v[16:19], v[180:183]
    ds_read_b128 v[220:223], v7 offset:37504
    v_mfma_f32_16x16x32_bf16 v[184:187], v[76:79], v[20:23], v[184:187]
    v_mfma_f32_16x16x32_bf16 v[188:191], v[76:79], v[24:27], v[188:191]
    ds_read_b128 v[224:227], v7 offset:55936
    v_mfma_f32_16x16x32_bf16 v[192:195], v[76:79], v[28:31], v[192:195]
    s_waitcnt vmcnt(19) lgkmcnt(4)
    v_mfma_f32_16x16x32_bf16 v[164:167], v[80:83], v[32:35], v[164:167]
    ds_read_b128 v[16:19], v6 offset:768
    v_mfma_f32_16x16x32_bf16 v[168:171], v[80:83], v[36:39], v[168:171]
    v_mfma_f32_16x16x32_bf16 v[172:175], v[80:83], v[40:43], v[172:175]
    ds_read_b128 v[20:23], v6 offset:19200
    v_mfma_f32_16x16x32_bf16 v[176:179], v[80:83], v[44:47], v[176:179]
    s_waitcnt vmcnt(18)
    v_mfma_f32_16x16x32_bf16 v[180:183], v[84:87], v[32:35], v[180:183]
    ds_read_b128 v[24:27], v6 offset:37632
    v_mfma_f32_16x16x32_bf16 v[184:187], v[84:87], v[36:39], v[184:187]
    v_mfma_f32_16x16x32_bf16 v[188:191], v[84:87], v[40:43], v[188:191]
    ds_read_b128 v[28:31], v6 offset:56064
    v_mfma_f32_16x16x32_bf16 v[192:195], v[84:87], v[44:47], v[192:195]
    s_waitcnt vmcnt(17) lgkmcnt(4)
    v_mfma_f32_16x16x32_bf16 v[164:167], v[88:91], v[212:215], v[164:167]
    ds_read_b128 v[32:35], v7 offset:768
    v_mfma_f32_16x16x32_bf16 v[168:171], v[88:91], v[216:219], v[168:171]
    v_mfma_f32_16x16x32_bf16 v[172:175], v[88:91], v[220:223], v[172:175]
    ds_read_b128 v[36:39], v7 offset:19200
    v_mfma_f32_16x16x32_bf16 v[176:179], v[88:91], v[224:227], v[176:179]
    s_waitcnt vmcnt(16)
    v_mfma_f32_16x16x32_bf16 v[180:183], v[92:95], v[212:215], v[180:183]
    ds_read_b128 v[40:43], v7 offset:37632
    v_mfma_f32_16x16x32_bf16 v[184:187], v[92:95], v[216:219], v[184:187]
    v_mfma_f32_16x16x32_bf16 v[188:191], v[92:95], v[220:223], v[188:191]
    ds_read_b128 v[44:47], v7 offset:56064
    v_mfma_f32_16x16x32_bf16 v[192:195], v[92:95], v[224:227], v[192:195]
    s_setprio 0
    s_waitcnt vmcnt(15) lgkmcnt(4)
    v_mfma_f32_16x16x32_bf16 v[164:167], v[96:99], v[16:19], v[164:167]
    ds_read_b128 v[212:215], v6 offset:896
    v_mfma_f32_16x16x32_bf16 v[168:171], v[96:99], v[20:23], v[168:171]
    v_mfma_f32_16x16x32_bf16 v[172:175], v[96:99], v[24:27], v[172:175]
    ds_read_b128 v[216:219], v6 offset:19328
    v_mfma_f32_16x16x32_bf16 v[176:179], v[96:99], v[28:31], v[176:179]
    s_waitcnt vmcnt(14)
    v_mfma_f32_16x16x32_bf16 v[180:183], v[100:103], v[16:19], v[180:183]
    ds_read_b128 v[220:223], v6 offset:37760
    v_mfma_f32_16x16x32_bf16 v[184:187], v[100:103], v[20:23], v[184:187]
    v_mfma_f32_16x16x32_bf16 v[188:191], v[100:103], v[24:27], v[188:191]
    ds_read_b128 v[224:227], v6 offset:56192
    v_mfma_f32_16x16x32_bf16 v[192:195], v[100:103], v[28:31], v[192:195]
    s_waitcnt vmcnt(13) lgkmcnt(4)
    v_mfma_f32_16x16x32_bf16 v[164:167], v[104:107], v[32:35], v[164:167]
    ds_read_b128 v[16:19], v7 offset:896
    v_mfma_f32_16x16x32_bf16 v[168:171], v[104:107], v[36:39], v[168:171]
    v_mfma_f32_16x16x32_bf16 v[172:175], v[104:107], v[40:43], v[172:175]
    ds_read_b128 v[20:23], v7 offset:19328
    v_mfma_f32_16x16x32_bf16 v[176:179], v[104:107], v[44:47], v[176:179]
    s_waitcnt vmcnt(12)
    v_mfma_f32_16x16x32_bf16 v[180:183], v[108:111], v[32:35], v[180:183]
    ds_read_b128 v[24:27], v7 offset:37760
    v_mfma_f32_16x16x32_bf16 v[184:187], v[108:111], v[36:39], v[184:187]
    v_mfma_f32_16x16x32_bf16 v[188:191], v[108:111], v[40:43], v[188:191]
    ds_read_b128 v[28:31], v7 offset:56192
    v_mfma_f32_16x16x32_bf16 v[192:195], v[108:111], v[44:47], v[192:195]
    s_waitcnt vmcnt(11) lgkmcnt(4)
    v_mfma_f32_16x16x32_bf16 v[164:167], v[112:115], v[212:215], v[164:167]
    ds_read_b128 v[32:35], v6 offset:1024
    v_mfma_f32_16x16x32_bf16 v[168:171], v[112:115], v[216:219], v[168:171]
    v_mfma_f32_16x16x32_bf16 v[172:175], v[112:115], v[220:223], v[172:175]
    ds_read_b128 v[36:39], v6 offset:19456
    v_mfma_f32_16x16x32_bf16 v[176:179], v[112:115], v[224:227], v[176:179]
    s_waitcnt vmcnt(10)
    v_mfma_f32_16x16x32_bf16 v[180:183], v[116:119], v[212:215], v[180:183]
    ds_read_b128 v[40:43], v6 offset:37888
    v_mfma_f32_16x16x32_bf16 v[184:187], v[116:119], v[216:219], v[184:187]
    v_mfma_f32_16x16x32_bf16 v[188:191], v[116:119], v[220:223], v[188:191]
    ds_read_b128 v[44:47], v6 offset:56320
    v_mfma_f32_16x16x32_bf16 v[192:195], v[116:119], v[224:227], v[192:195]
    s_setprio 1
    s_waitcnt vmcnt(9) lgkmcnt(4)
    v_mfma_f32_16x16x32_bf16 v[164:167], v[120:123], v[16:19], v[164:167]
    ds_read_b128 v[212:215], v7 offset:1024
    v_mfma_f32_16x16x32_bf16 v[168:171], v[120:123], v[20:23], v[168:171]
    v_mfma_f32_16x16x32_bf16 v[172:175], v[120:123], v[24:27], v[172:175]
    ds_read_b128 v[216:219], v7 offset:19456
    v_mfma_f32_16x16x32_bf16 v[176:179], v[120:123], v[28:31], v[176:179]
    s_waitcnt vmcnt(8)
    v_mfma_f32_16x16x32_bf16 v[180:183], v[124:127], v[16:19], v[180:183]
    ds_read_b128 v[220:223], v7 offset:37888
    v_mfma_f32_16x16x32_bf16 v[184:187], v[124:127], v[20:23], v[184:187]
    v_mfma_f32_16x16x32_bf16 v[188:191], v[124:127], v[24:27], v[188:191]
    ds_read_b128 v[224:227], v7 offset:56320
    v_mfma_f32_16x16x32_bf16 v[192:195], v[124:127], v[28:31], v[192:195]
    s_waitcnt vmcnt(7) lgkmcnt(4)
    v_mfma_f32_16x16x32_bf16 v[164:167], v[128:131], v[32:35], v[164:167]
    v_mfma_f32_16x16x32_bf16 v[168:171], v[128:131], v[36:39], v[168:171]
    v_mfma_f32_16x16x32_bf16 v[172:175], v[128:131], v[40:43], v[172:175]
    v_mfma_f32_16x16x32_bf16 v[176:179], v[128:131], v[44:47], v[176:179]
    s_waitcnt vmcnt(6)
    v_mfma_f32_16x16x32_bf16 v[180:183], v[48:51], v[32:35], v[180:183]
    v_mfma_f32_16x16x32_bf16 v[184:187], v[48:51], v[36:39], v[184:187]
    v_mfma_f32_16x16x32_bf16 v[188:191], v[48:51], v[40:43], v[188:191]
    v_mfma_f32_16x16x32_bf16 v[192:195], v[48:51], v[44:47], v[192:195]
    s_waitcnt vmcnt(5) lgkmcnt(0)
    v_mfma_f32_16x16x32_bf16 v[164:167], v[52:55], v[212:215], v[164:167]
    v_mfma_f32_16x16x32_bf16 v[168:171], v[52:55], v[216:219], v[168:171]
    v_mfma_f32_16x16x32_bf16 v[172:175], v[52:55], v[220:223], v[172:175]
    v_mfma_f32_16x16x32_bf16 v[176:179], v[52:55], v[224:227], v[176:179]
    s_waitcnt vmcnt(4)
    v_mfma_f32_16x16x32_bf16 v[180:183], v[56:59], v[212:215], v[180:183]
    v_mfma_f32_16x16x32_bf16 v[184:187], v[56:59], v[216:219], v[184:187]
    v_mfma_f32_16x16x32_bf16 v[188:191], v[56:59], v[220:223], v[188:191]
    v_mfma_f32_16x16x32_bf16 v[192:195], v[56:59], v[224:227], v[192:195]
    s_nop 7
    s_add_u32 s53, s53, 4096
    v_cvt_pk_bf16_f32 v232, v164, v180
    v_cvt_pk_bf16_f32 v233, v165, v181
    v_cvt_pk_bf16_f32 v234, v166, v182
    v_cvt_pk_bf16_f32 v235, v167, v183
    buffer_store_dwordx4 v[232:235], v2, s[44:47], s53 offen offset:0 sc0 sc1
    v_cvt_pk_bf16_f32 v236, v168, v184
    v_cvt_pk_bf16_f32 v237, v169, v185
    v_cvt_pk_bf16_f32 v238, v170, v186
    v_cvt_pk_bf16_f32 v239, v171, v187
    buffer_store_dwordx4 v[236:239], v2, s[44:47], s53 offen offset:1024 sc0 sc1
    v_cvt_pk_bf16_f32 v240, v172, v188
    v_cvt_pk_bf16_f32 v241, v173, v189
    v_cvt_pk_bf16_f32 v242, v174, v190
    v_cvt_pk_bf16_f32 v243, v175, v191
    buffer_store_dwordx4 v[240:243], v2, s[44:47], s53 offen offset:2048 sc0 sc1
    v_cvt_pk_bf16_f32 v244, v176, v192
    v_cvt_pk_bf16_f32 v245, v177, v193
    v_cvt_pk_bf16_f32 v246, v178, v194
    v_cvt_pk_bf16_f32 v247, v179, v195
    buffer_store_dwordx4 v[244:247], v2, s[44:47], s53 offen offset:3072 sc0 sc1
p3_end:
    s_setprio 0
    s_waitcnt vmcnt(0) lgkmcnt(0)
    s_barrier
    s_cmp_lg_u32 s26, 0
    s_cbranch_scc1 b3_s
    s_add_u32 s32, s24, 0x3418000
    s_addc_u32 s33, s25, 0
    s_mov_b32 s34, 0x8000
    s_mov_b32 s35, 0x20000
    s_lshl_b32 s29, s2, 7
    v_mov_b32 v4, s27
    v_mov_b32 v5, 0
    s_mov_b64 exec, 1
    buffer_store_dword v4, v5, s[32:35], s29 offen sc0 sc1
    s_mov_b64 exec, -1
b3_s:
    s_cmp_lg_u32 s26, 0
    s_cbranch_scc1 b3_join
    s_add_u32 s32, s24, 0x3418000
    s_addc_u32 s33, s25, 0
    s_mov_b32 s34, 0x8000
    s_mov_b32 s35, 0x20000
    s_lshr_b32 s53, s51, 4
    s_lshl_b32 s53, s53, 2
    s_and_b32 s54, s51, 15
    s_lshl_b32 s54, s54, 4
    s_add_u32 s53, s53, s54
    s_lshl_b32 s53, s53, 7
    v_lshrrev_b32 v4, 1, v1
    v_and_b32 v5, 1, v1
    v_lshl_add_u32 v4, v5, 3, v4
    v_lshlrev_b32 v4, 7, v4
    s_mov_b64 exec, 0xff
    buffer_load_dword v8, v4, s[32:35], s53 offen sc0 sc1
b3_p:
    buffer_load_dword v9, v4, s[32:35], s53 offen sc0 sc1
    s_waitcnt vmcnt(1)
    v_cmp_ne_u32 vcc, s27, v8
    s_cbranch_vccz b3_p_x
    buffer_load_dword v8, v4, s[32:35], s53 offen sc0 sc1
    s_waitcnt vmcnt(1)
    v_cmp_ne_u32 vcc, s27, v9
    s_cbranch_vccz b3_p_x
    s_cmp_eq_u32 s28, 0
    s_cbranch_scc1 b3_p_x
    s_sub_u32 s28, s28, 1
    s_branch b3_p
b3_p_x:
    s_waitcnt vmcnt(0)
    s_mov_b64 exec, -1
b3_join:
    s_barrier
    s_add_u32 s36, s24, 0x1400000
    s_addc_u32 s37, s25, 0
    s_mov_b32 s38, 0x1200000
    s_mov_b32 s39, 0x20000
    s_add_u32 s40, s24, 0x1000000
    s_addc_u32 s41, s25, 0
    s_mov_b32 s42, 0x240000
    s_mov_b32 s43, 0x20000
    s_mov_b32 s44, s20
    s_mov_b32 s45, s21
    s_mov_b32 s46, 0x240000
    s_mov_b32 s47, 0x20000
    s_cmp_ge_u32 s26, 4
    s_cbranch_scc1 p4_s
    s_mul_i32 s53, s51, 73728
    s_lshl_b32 s54, s50, 13
    s_add_u32 s53, s53, s54
    s_lshl_b32 s54, s26, 10
    s_add_u32 s53, s53, s54
    v_add_u32 v4, 4096, v2
    buffer_load_dwordx4 v[16:19], v2, s[36:39], s53 offen
    buffer_load_dwordx4 v[20:23], v4, s[36:39], s53 offen
    s_add_u32 s53, s53, 2359296
    buffer_load_dwordx4 v[24:27], v2, s[36:39], s53 offen
    buffer_load_dwordx4 v[28:31], v4, s[36:39], s53 offen
    s_add_u32 s53, s53, 2359296
    buffer_load_dwordx4 v[32:35], v2, s[36:39], s53 offen
    buffer_load_dwordx4 v[36:39], v4, s[36:39], s53 offen
    s_add_u32 s53, s53, 2359296
    buffer_load_dwordx4 v[40:43], v2, s[36:39], s53 offen
    buffer_load_dwordx4 v[44:47], v4, s[36:39], s53 offen
    s_add_u32 s53, s53, 2359296
    buffer_load_dwordx4 v[48:51], v2, s[36:39], s53 offen
    buffer_load_dwordx4 v[52:55], v4, s[36:39], s53 offen
    s_add_u32 s53, s53, 2359296
    buffer_load_dwordx4 v[56:59], v2, s[36:39], s53 offen
    buffer_load_dwordx4 v[60:63], v4, s[36:39], s53 offen
    s_add_u32 s53, s53, 2359296
    buffer_load_dwordx4 v[64:67], v2, s[36:39], s53 offen
    buffer_load_dwordx4 v[68:71], v4, s[36:39], s53 offen
    s_add_u32 s53, s53, 2359296
    buffer_load_dwordx4 v[72:75], v2, s[36:39], s53 offen
    buffer_load_dwordx4 v[76:79], v4, s[36:39], s53 offen
    v_and_b32 v5, 15, v1
    v_lshrrev_b32 v6, 4, v1
    v_mul_u32_u24 v7, 1152, v5
    v_lshl_add_u32 v7, v6, 5, v7
    s_lshl_b32 s54, s51, 6
    s_lshl_b32 s55, s26, 4
    s_add_u32 s54, s54, s55
    s_mul_i32 s54, s54, 1152
    s_lshl_b32 s55, s50, 7
    s_add_u32 s54, s54, s55
    buffer_load_dwordx4 v[80:83], v7, s[40:43], s54 offen
    buffer_load_dwordx4 v[84:87], v7, s[40:43], s54 offen offset:16
    s_waitcnt vmcnt(0)
    v_lshlrev_b32 v88, 16, v80
    v_and_b32 v89, 0xffff0000, v80
    v_lshlrev_b32 v90, 16, v81
    v_and_b32 v91, 0xffff0000, v81
    v_lshlrev_b32 v92, 16, v82
    v_and_b32 v93, 0xffff0000, v82
    v_lshlrev_b32 v94, 16, v83
    v_and_b32 v95, 0xffff0000, v83
    v_lshlrev_b32 v96, 16, v84
    v_and_b32 v97, 0xffff0000, v84
    v_lshlrev_b32 v98, 16, v85
    v_and_b32 v99, 0xffff0000, v85
    v_lshlrev_b32 v100, 16, v86
    v_and_b32 v101, 0xffff0000, v86
    v_lshlrev_b32 v102, 16, v87
    v_and_b32 v103, 0xffff0000, v87
    v_lshlrev_b32 v104, 16, v16
    v_and_b32 v105, 0xffff0000, v16
    v_add_f32 v88, v88, v104
    v_add_f32 v89, v89, v105
    v_lshlrev_b32 v106, 16, v17
    v_and_b32 v107, 0xffff0000, v17
    v_add_f32 v92, v92, v106
    v_add_f32 v93, v93, v107
    v_lshlrev_b32 v104, 16, v18
    v_and_b32 v105, 0xffff0000, v18
    v_add_f32 v96, v96, v104
    v_add_f32 v97, v97, v105
    v_lshlrev_b32 v106, 16, v19
    v_and_b32 v107, 0xffff0000, v19
    v_add_f32 v100, v100, v106
    v_add_f32 v101, v101, v107
    v_lshlrev_b32 v104, 16, v20
    v_and_b32 v105, 0xffff0000, v20
    v_add_f32 v90, v90, v104
    v_add_f32 v91, v91, v105
    v_lshlrev_b32 v106, 16, v21
    v_and_b32 v107, 0xffff0000, v21
    v_add_f32 v94, v94, v106
    v_add_f32 v95, v95, v107
    v_lshlrev_b32 v104, 16, v22
    v_and_b32 v105, 0xffff0000, v22
    v_add_f32 v98, v98, v104
    v_add_f32 v99, v99, v105
    v_lshlrev_b32 v106, 16, v23
    v_and_b32 v107, 0xffff0000, v23
    v_add_f32 v102, v102, v106
    v_add_f32 v103, v103, v107
    v_lshlrev_b32 v104, 16, v24
    v_and_b32 v105, 0xffff0000, v24
    v_add_f32 v88, v88, v104
    v_add_f32 v89, v89, v105
    v_lshlrev_b32 v106, 16, v25
    v_and_b32 v107, 0xffff0000, v25
    v_add_f32 v92, v92, v106
    v_add_f32 v93, v93, v107
    v_lshlrev_b32 v104, 16, v26
    v_and_b32 v105, 0xffff0000, v26
    v_add_f32 v96, v96, v104
    v_add_f32 v97, v97, v105
    v_lshlrev_b32 v106, 16, v27
    v_and_b32 v107, 0xffff0000, v27
    v_add_f32 v100, v100, v106
    v_add_f32 v101, v101, v107
    v_lshlrev_b32 v104, 16, v28
    v_and_b32 v105, 0xffff0000, v28
    v_add_f32 v90, v90, v104
    v_add_f32 v91, v91, v105
    v_lshlrev_b32 v106, 16, v29
    v_and_b32 v107, 0xffff0000, v29
    v_add_f32 v94, v94, v106
    v_add_f32 v95, v95, v107
    v_lshlrev_b32 v104, 16, v30
    v_and_b32 v105, 0xffff0000, v30
    v_add_f32 v98, v98, v104
    v_add_f32 v99, v99, v105
    v_lshlrev_b32 v106, 16, v31
    v_and_b32 v107, 0xffff0000, v31
    v_add_f32 v102, v102, v106
    v_add_f32 v103, v103, v107
    v_lshlrev_b32 v104, 16, v32
    v_and_b32 v105, 0xffff0000, v32
    v_add_f32 v88, v88, v104
    v_add_f32 v89, v89, v105
    v_lshlrev_b32 v106, 16, v33
    v_and_b32 v107, 0xffff0000, v33
    v_add_f32 v92, v92, v106
    v_add_f32 v93, v93, v107
    v_lshlrev_b32 v104, 16, v34
    v_and_b32 v105, 0xffff0000, v34
    v_add_f32 v96, v96, v104
    v_add_f32 v97, v97, v105
    v_lshlrev_b32 v106, 16, v35
    v_and_b32 v107, 0xffff0000, v35
    v_add_f32 v100, v100, v106
    v_add_f32 v101, v101, v107
    v_lshlrev_b32 v104, 16, v36
    v_and_b32 v105, 0xffff0000, v36
    v_add_f32 v90, v90, v104
    v_add_f32 v91, v91, v105
    v_lshlrev_b32 v106, 16, v37
    v_and_b32 v107, 0xffff0000, v37
    v_add_f32 v94, v94, v106
    v_add_f32 v95, v95, v107
    v_lshlrev_b32 v104, 16, v38
    v_and_b32 v105, 0xffff0000, v38
    v_add_f32 v98, v98, v104
    v_add_f32 v99, v99, v105
    v_lshlrev_b32 v106, 16, v39
    v_and_b32 v107, 0xffff0000, v39
    v_add_f32 v102, v102, v106
    v_add_f32 v103, v103, v107
    v_lshlrev_b32 v104, 16, v40
    v_and_b32 v105, 0xffff0000, v40
    v_add_f32 v88, v88, v104
    v_add_f32 v89, v89, v105
    v_lshlrev_b32 v106, 16, v41
    v_and_b32 v107, 0xffff0000, v41
    v_add_f32 v92, v92, v106
    v_add_f32 v93, v93, v107
    v_lshlrev_b32 v104, 16, v42
    v_and_b32 v105, 0xffff0000, v42
    v_add_f32 v96, v96, v104
    v_add_f32 v97, v97, v105
    v_lshlrev_b32 v106, 16, v43
    v_and_b32 v107, 0xffff0000, v43
    v_add_f32 v100, v100, v106
    v_add_f32 v101, v101, v107
    v_lshlrev_b32 v104, 16, v44
    v_and_b32 v105, 0xffff0000, v44
    v_add_f32 v90, v90, v104
    v_add_f32 v91, v91, v105
    v_lshlrev_b32 v106, 16, v45
    v_and_b32 v107, 0xffff0000, v45
    v_add_f32 v94, v94, v106
    v_add_f32 v95, v95, v107
    v_lshlrev_b32 v104, 16, v46
    v_and_b32 v105, 0xffff0000, v46
    v_add_f32 v98, v98, v104
    v_add_f32 v99, v99, v105
    v_lshlrev_b32 v106, 16, v47
    v_and_b32 v107, 0xffff0000, v47
    v_add_f32 v102, v102, v106
    v_add_f32 v103, v103, v107
    v_lshlrev_b32 v104, 16, v48
    v_and_b32 v105, 0xffff0000, v48
    v_add_f32 v88, v88, v104
    v_add_f32 v89, v89, v105
    v_lshlrev_b32 v106, 16, v49
    v_and_b32 v107, 0xffff0000, v49
    v_add_f32 v92, v92, v106
    v_add_f32 v93, v93, v107
    v_lshlrev_b32 v104, 16, v50
    v_and_b32 v105, 0xffff0000, v50
    v_add_f32 v96, v96, v104
    v_add_f32 v97, v97, v105
    v_lshlrev_b32 v106, 16, v51
    v_and_b32 v107, 0xffff0000, v51
    v_add_f32 v100, v100, v106
    v_add_f32 v101, v101, v107
    v_lshlrev_b32 v104, 16, v52
    v_and_b32 v105, 0xffff0000, v52
    v_add_f32 v90, v90, v104
    v_add_f32 v91, v91, v105
    v_lshlrev_b32 v106, 16, v53
    v_and_b32 v107, 0xffff0000, v53
    v_add_f32 v94, v94, v106
    v_add_f32 v95, v95, v107
    v_lshlrev_b32 v104, 16, v54
    v_and_b32 v105, 0xffff0000, v54
    v_add_f32 v98, v98, v104
    v_add_f32 v99, v99, v105
    v_lshlrev_b32 v106, 16, v55
    v_and_b32 v107, 0xffff0000, v55
    v_add_f32 v102, v102, v106
    v_add_f32 v103, v103, v107
    v_lshlrev_b32 v104, 16, v56
    v_and_b32 v105, 0xffff0000, v56
    v_add_f32 v88, v88, v104
    v_add_f32 v89, v89, v105
    v_lshlrev_b32 v106, 16, v57
    v_and_b32 v107, 0xffff0000, v57
    v_add_f32 v92, v92, v106
    v_add_f32 v93, v93, v107
    v_lshlrev_b32 v104, 16, v58
    v_and_b32 v105, 0xffff0000, v58
    v_add_f32 v96, v96, v104
    v_add_f32 v97, v97, v105
    v_lshlrev_b32 v106, 16, v59
    v_and_b32 v107, 0xffff0000, v59
    v_add_f32 v100, v100, v106
    v_add_f32 v101, v101, v107
    v_lshlrev_b32 v104, 16, v60
    v_and_b32 v105, 0xffff0000, v60
    v_add_f32 v90, v90, v104
    v_add_f32 v91, v91, v105
    v_lshlrev_b32 v106, 16, v61
    v_and_b32 v107, 0xffff0000, v61
    v_add_f32 v94, v94, v106
    v_add_f32 v95, v95, v107
    v_lshlrev_b32 v104, 16, v62
    v_and_b32 v105, 0xffff0000, v62
    v_add_f32 v98, v98, v104
    v_add_f32 v99, v99, v105
    v_lshlrev_b32 v106, 16, v63
    v_and_b32 v107, 0xffff0000, v63
    v_add_f32 v102, v102, v106
    v_add_f32 v103, v103, v107
    v_lshlrev_b32 v104, 16, v64
    v_and_b32 v105, 0xffff0000, v64
    v_add_f32 v88, v88, v104
    v_add_f32 v89, v89, v105
    v_lshlrev_b32 v106, 16, v65
    v_and_b32 v107, 0xffff0000, v65
    v_add_f32 v92, v92, v106
    v_add_f32 v93, v93, v107
    v_lshlrev_b32 v104, 16, v66
    v_and_b32 v105, 0xffff0000, v66
    v_add_f32 v96, v96, v104
    v_add_f32 v97, v97, v105
    v_lshlrev_b32 v106, 16, v67
    v_and_b32 v107, 0xffff0000, v67
    v_add_f32 v100, v100, v106
    v_add_f32 v101, v101, v107
    v_lshlrev_b32 v104, 16, v68
    v_and_b32 v105, 0xffff0000, v68
    v_add_f32 v90, v90, v104
    v_add_f32 v91, v91, v105
    v_lshlrev_b32 v106, 16, v69
    v_and_b32 v107, 0xffff0000, v69
    v_add_f32 v94, v94, v106
    v_add_f32 v95, v95, v107
    v_lshlrev_b32 v104, 16, v70
    v_and_b32 v105, 0xffff0000, v70
    v_add_f32 v98, v98, v104
    v_add_f32 v99, v99, v105
    v_lshlrev_b32 v106, 16, v71
    v_and_b32 v107, 0xffff0000, v71
    v_add_f32 v102, v102, v106
    v_add_f32 v103, v103, v107
    v_lshlrev_b32 v104, 16, v72
    v_and_b32 v105, 0xffff0000, v72
    v_add_f32 v88, v88, v104
    v_add_f32 v89, v89, v105
    v_lshlrev_b32 v106, 16, v73
    v_and_b32 v107, 0xffff0000, v73
    v_add_f32 v92, v92, v106
    v_add_f32 v93, v93, v107
    v_lshlrev_b32 v104, 16, v74
    v_and_b32 v105, 0xffff0000, v74
    v_add_f32 v96, v96, v104
    v_add_f32 v97, v97, v105
    v_lshlrev_b32 v106, 16, v75
    v_and_b32 v107, 0xffff0000, v75
    v_add_f32 v100, v100, v106
    v_add_f32 v101, v101, v107
    v_lshlrev_b32 v104, 16, v76
    v_and_b32 v105, 0xffff0000, v76
    v_add_f32 v90, v90, v104
    v_add_f32 v91, v91, v105
    v_lshlrev_b32 v106, 16, v77
    v_and_b32 v107, 0xffff0000, v77
    v_add_f32 v94, v94, v106
    v_add_f32 v95, v95, v107
    v_lshlrev_b32 v104, 16, v78
    v_and_b32 v105, 0xffff0000, v78
    v_add_f32 v98, v98, v104
    v_add_f32 v99, v99, v105
    v_lshlrev_b32 v106, 16, v79
    v_and_b32 v107, 0xffff0000, v79
    v_add_f32 v102, v102, v106
    v_add_f32 v103, v103, v107
    v_cvt_pk_bf16_f32 v16, v88, v89
    v_cvt_pk_bf16_f32 v17, v90, v91
    v_cvt_pk_bf16_f32 v18, v92, v93
    v_cvt_pk_bf16_f32 v19, v94, v95
    v_cvt_pk_bf16_f32 v20, v96, v97
    v_cvt_pk_bf16_f32 v21, v98, v99
    v_cvt_pk_bf16_f32 v22, v100, v101
    v_cvt_pk_bf16_f32 v23, v102, v103
    buffer_store_dwordx4 v[16:19], v7, s[44:47], s54 offen
    buffer_store_dwordx4 v[20:23], v7, s[44:47], s54 offen offset:16
    s_branch p4_end
p4_s:
    s_cmp_ge_u32 s26, 5
    s_cbranch_scc1 p4_end
    s_mul_i32 s53, s51, 73728
    s_lshl_b32 s54, s50, 8
    s_add_u32 s53, s53, s54
    s_add_u32 s53, s53, 65536
    v_add_u32 v4, 4096, v3
    buffer_load_dword v16, v3, s[36:39], s53 offen offset:0
    buffer_load_dword v17, v3, s[36:39], s53 offen offset:2048
    buffer_load_dword v18, v4, s[36:39], s53 offen offset:0
    buffer_load_dword v19, v4, s[36:39], s53 offen offset:2048
    s_add_u32 s53, s53, 2359296
    buffer_load_dword v20, v3, s[36:39], s53 offen offset:0
    buffer_load_dword v21, v3, s[36:39], s53 offen offset:2048
    buffer_load_dword v22, v4, s[36:39], s53 offen offset:0
    buffer_load_dword v23, v4, s[36:39], s53 offen offset:2048
    s_add_u32 s53, s53, 2359296
    buffer_load_dword v24, v3, s[36:39], s53 offen offset:0
    buffer_load_dword v25, v3, s[36:39], s53 offen offset:2048
    buffer_load_dword v26, v4, s[36:39], s53 offen offset:0
    buffer_load_dword v27, v4, s[36:39], s53 offen offset:2048
    s_add_u32 s53, s53, 2359296
    buffer_load_dword v28, v3, s[36:39], s53 offen offset:0
    buffer_load_dword v29, v3, s[36:39], s53 offen offset:2048
    buffer_load_dword v30, v4, s[36:39], s53 offen offset:0
    buffer_load_dword v31, v4, s[36:39], s53 offen offset:2048
    s_add_u32 s53, s53, 2359296
    buffer_load_dword v32, v3, s[36:39], s53 offen offset:0
    buffer_load_dword v33, v3, s[36:39], s53 offen offset:2048
    buffer_load_dword v34, v4, s[36:39], s53 offen offset:0
    buffer_load_dword v35, v4, s[36:39], s53 offen offset:2048
    s_add_u32 s53, s53, 2359296
    buffer_load_dword v36, v3, s[36:39], s53 offen offset:0
    buffer_load_dword v37, v3, s[36:39], s53 offen offset:2048
    buffer_load_dword v38, v4, s[36:39], s53 offen offset:0
    buffer_load_dword v39, v4, s[36:39], s53 offen offset:2048
    s_add_u32 s53, s53, 2359296
    buffer_load_dword v40, v3, s[36:39], s53 offen offset:0
    buffer_load_dword v41, v3, s[36:39], s53 offen offset:2048
    buffer_load_dword v42, v4, s[36:39], s53 offen offset:0
    buffer_load_dword v43, v4, s[36:39], s53 offen offset:2048
    s_add_u32 s53, s53, 2359296
    buffer_load_dword v44, v3, s[36:39], s53 offen offset:0
    buffer_load_dword v45, v3, s[36:39], s53 offen offset:2048
    buffer_load_dword v46, v4, s[36:39], s53 offen offset:0
    buffer_load_dword v47, v4, s[36:39], s53 offen offset:2048
    v_and_b32 v5, 15, v1
    v_lshrrev_b32 v6, 4, v1
    v_mul_u32_u24 v7, 1152, v5
    v_lshl_add_u32 v7, v6, 5, v7
    s_lshl_b32 s54, s51, 6
    s_lshr_b32 s55, s50, 1
    s_lshl_b32 s55, s55, 4
    s_add_u32 s54, s54, s55
    s_mul_i32 s54, s54, 1152
    s_and_b32 s55, s50, 1
    s_lshl_b32 s55, s55, 4
    s_add_u32 s54, s54, s55
    s_add_u32 s54, s54, 1024
    buffer_load_dwordx4 v[80:83], v7, s[40:43], s54 offen
    s_waitcnt vmcnt(0)
    v_lshlrev_b32 v88, 16, v80
    v_and_b32 v89, 0xffff0000, v80
    v_lshlrev_b32 v90, 16, v81
    v_and_b32 v91, 0xffff0000, v81
    v_lshlrev_b32 v92, 16, v82
    v_and_b32 v93, 0xffff0000, v82
    v_lshlrev_b32 v94, 16, v83
    v_and_b32 v95, 0xffff0000, v83
    v_lshlrev_b32 v104, 16, v16
    v_and_b32 v105, 0xffff0000, v16
    v_add_f32 v88, v88, v104
    v_add_f32 v92, v92, v105
    v_lshlrev_b32 v106, 16, v17
    v_and_b32 v107, 0xffff0000, v17
    v_add_f32 v89, v89, v106
    v_add_f32 v93, v93, v107
    v_lshlrev_b32 v104, 16, v18
    v_and_b32 v105, 0xffff0000, v18
    v_add_f32 v90, v90, v104
    v_add_f32 v94, v94, v105
    v_lshlrev_b32 v106, 16, v19
    v_and_b32 v107, 0xffff0000, v19
    v_add_f32 v91, v91, v106
    v_add_f32 v95, v95, v107
    v_lshlrev_b32 v104, 16, v20
    v_and_b32 v105, 0xffff0000, v20
    v_add_f32 v88, v88, v104
    v_add_f32 v92, v92, v105
    v_lshlrev_b32 v106, 16, v21
    v_and_b32 v107, 0xffff0000, v21
    v_add_f32 v89, v89, v106
    v_add_f32 v93, v93, v107
    v_lshlrev_b32 v104, 16, v22
    v_and_b32 v105, 0xffff0000, v22
    v_add_f32 v90, v90, v104
    v_add_f32 v94, v94, v105
    v_lshlrev_b32 v106, 16, v23
    v_and_b32 v107, 0xffff0000, v23
    v_add_f32 v91, v91, v106
    v_add_f32 v95, v95, v107
    v_lshlrev_b32 v104, 16, v24
    v_and_b32 v105, 0xffff0000, v24
    v_add_f32 v88, v88, v104
    v_add_f32 v92, v92, v105
    v_lshlrev_b32 v106, 16, v25
    v_and_b32 v107, 0xffff0000, v25
    v_add_f32 v89, v89, v106
    v_add_f32 v93, v93, v107
    v_lshlrev_b32 v104, 16, v26
    v_and_b32 v105, 0xffff0000, v26
    v_add_f32 v90, v90, v104
    v_add_f32 v94, v94, v105
    v_lshlrev_b32 v106, 16, v27
    v_and_b32 v107, 0xffff0000, v27
    v_add_f32 v91, v91, v106
    v_add_f32 v95, v95, v107
    v_lshlrev_b32 v104, 16, v28
    v_and_b32 v105, 0xffff0000, v28
    v_add_f32 v88, v88, v104
    v_add_f32 v92, v92, v105
    v_lshlrev_b32 v106, 16, v29
    v_and_b32 v107, 0xffff0000, v29
    v_add_f32 v89, v89, v106
    v_add_f32 v93, v93, v107
    v_lshlrev_b32 v104, 16, v30
    v_and_b32 v105, 0xffff0000, v30
    v_add_f32 v90, v90, v104
    v_add_f32 v94, v94, v105
    v_lshlrev_b32 v106, 16, v31
    v_and_b32 v107, 0xffff0000, v31
    v_add_f32 v91, v91, v106
    v_add_f32 v95, v95, v107
    v_lshlrev_b32 v104, 16, v32
    v_and_b32 v105, 0xffff0000, v32
    v_add_f32 v88, v88, v104
    v_add_f32 v92, v92, v105
    v_lshlrev_b32 v106, 16, v33
    v_and_b32 v107, 0xffff0000, v33
    v_add_f32 v89, v89, v106
    v_add_f32 v93, v93, v107
    v_lshlrev_b32 v104, 16, v34
    v_and_b32 v105, 0xffff0000, v34
    v_add_f32 v90, v90, v104
    v_add_f32 v94, v94, v105
    v_lshlrev_b32 v106, 16, v35
    v_and_b32 v107, 0xffff0000, v35
    v_add_f32 v91, v91, v106
    v_add_f32 v95, v95, v107
    v_lshlrev_b32 v104, 16, v36
    v_and_b32 v105, 0xffff0000, v36
    v_add_f32 v88, v88, v104
    v_add_f32 v92, v92, v105
    v_lshlrev_b32 v106, 16, v37
    v_and_b32 v107, 0xffff0000, v37
    v_add_f32 v89, v89, v106
    v_add_f32 v93, v93, v107
    v_lshlrev_b32 v104, 16, v38
    v_and_b32 v105, 0xffff0000, v38
    v_add_f32 v90, v90, v104
    v_add_f32 v94, v94, v105
    v_lshlrev_b32 v106, 16, v39
    v_and_b32 v107, 0xffff0000, v39
    v_add_f32 v91, v91, v106
    v_add_f32 v95, v95, v107
    v_lshlrev_b32 v104, 16, v40
    v_and_b32 v105, 0xffff0000, v40
    v_add_f32 v88, v88, v104
    v_add_f32 v92, v92, v105
    v_lshlrev_b32 v106, 16, v41
    v_and_b32 v107, 0xffff0000, v41
    v_add_f32 v89, v89, v106
    v_add_f32 v93, v93, v107
    v_lshlrev_b32 v104, 16, v42
    v_and_b32 v105, 0xffff0000, v42
    v_add_f32 v90, v90, v104
    v_add_f32 v94, v94, v105
    v_lshlrev_b32 v106, 16, v43
    v_and_b32 v107, 0xffff0000, v43
    v_add_f32 v91, v91, v106
    v_add_f32 v95, v95, v107
    v_lshlrev_b32 v104, 16, v44
    v_and_b32 v105, 0xffff0000, v44
    v_add_f32 v88, v88, v104
    v_add_f32 v92, v92, v105
    v_lshlrev_b32 v106, 16, v45
    v_and_b32 v107, 0xffff0000, v45
    v_add_f32 v89, v89, v106
    v_add_f32 v93, v93, v107
    v_lshlrev_b32 v104, 16, v46
    v_and_b32 v105, 0xffff0000, v46
    v_add_f32 v90, v90, v104
    v_add_f32 v94, v94, v105
    v_lshlrev_b32 v106, 16, v47
    v_and_b32 v107, 0xffff0000, v47
    v_add_f32 v91, v91, v106
    v_add_f32 v95, v95, v107
    v_cvt_pk_bf16_f32 v16, v88, v89
    v_cvt_pk_bf16_f32 v17, v90, v91
    v_cvt_pk_bf16_f32 v18, v92, v93
    v_cvt_pk_bf16_f32 v19, v94, v95
    buffer_store_dwordx4 v[16:19], v7, s[44:47], s54 offen
p4_end:
k_done:
    s_endpgm
k_code_end:
.section .rodata,"a"
.p2align 6
.amdhsa_kernel sequential_preLN__linear_kernel_hedgehog__geglu_ffn__prompt_kernel
  .amdhsa_next_free_vgpr 256
  .amdhsa_next_free_sgpr 102
  .amdhsa_accum_offset 256
  .amdhsa_group_segment_fixed_size 0
  .amdhsa_kernarg_size 88
  .amdhsa_user_sgpr_count 2
  .amdhsa_user_sgpr_kernarg_segment_ptr 1
  .amdhsa_system_sgpr_workgroup_id_x 1
.end_amdhsa_kernel
```
